```python
import torch

def _softmax(x, axis=-1):
    return torch.softmax(x, dim=axis)
def _gelu(x):
    return torch.nn.functional.gelu(x, approximate="tanh")
def _silu(x):
    return torch.nn.functional.silu(x)
def _sigmoid(x):
    return torch.sigmoid(x)
def _layernorm(x, axis=-1, eps=1e-5):
    m = x.mean(dim=axis, keepdim=True)
    v = x.var(dim=axis, keepdim=True, unbiased=False)
    return (x - m) / torch.sqrt(v + eps)
def _scatter_add(tgt, idx, src, axis=0):
    return tgt.clone().index_add_(axis, idx, src)
def _segment_sum(src, seg, n):
    out = torch.zeros((n,) + src.shape[1:], dtype=src.dtype)
    return out.index_add_(0, seg, src)
def _pad(x, pw):
    flat = tuple(v for pair in reversed(pw) for v in pair)
    return torch.nn.functional.pad(x, flat)

kernel_name = 'parallel_sum__softmax_full_mha__mixer_channel_mlp__prompt'

def setup_inputs():

    _w = (lambda a: (lambda t: t.to(torch.bfloat16) if t.is_floating_point() else t)(torch.as_tensor(a)))
    def _A_setup():
        B, S, D = 1, 2048, 1024
        return {
            "x": _w((lambda *s: torch.randn(*s, dtype=torch.bfloat16) * 0.05)(B, S, D)),
            "wqkv": _w((lambda *s: torch.randn(*s, dtype=torch.bfloat16) * 0.05)(D, 3 * D)),
            "wo": _w((lambda *s: torch.randn(*s, dtype=torch.bfloat16) * 0.05)(D, D)),
        }
    _A_in = _A_setup()

    def _B_setup():
        B, S, D, F = 1, 2048, 1024, 3584
        return {
            "x": _w((lambda *s: torch.randn(*s, dtype=torch.bfloat16) * 0.05)(B, S, D)),
            "w1": _w((lambda *s: torch.randn(*s, dtype=torch.bfloat16) * 3.2)(D, F) * (D ** -0.5)),
            "b1": _w((lambda *s: torch.randn(*s, dtype=torch.bfloat16) * 1.6)(F)),
            "w2": _w((lambda *s: torch.randn(*s, dtype=torch.bfloat16) * 0.4)(F, D) * (F ** -0.5)),
            "b2": _w((lambda *s: torch.randn(*s, dtype=torch.bfloat16) * 0.8)(D)),
        }
    _B_in = _B_setup()

    return {
        "A_x": _A_in["x"],
        "A_wqkv": _A_in["wqkv"],
        "A_wo": _A_in["wo"],
        "B_x": _B_in["x"],
        "B_w1": _B_in["w1"],
        "B_b1": _B_in["b1"],
        "B_w2": _B_in["w2"],
        "B_b2": _B_in["b2"],
    }

def reference(A_x, A_wqkv, A_wo, B_x, B_w1, B_b1, B_w2, B_b2):
    def _A_ref(x, wqkv, wo):
        B, S, D = x.shape
        H = 32; Dh = D // H
        qkv = (lambda x, *d: x.permute(*d))((x @ wqkv).reshape(B, S, 3, H, Dh), 2, 0, 3, 1, 4)
        q, k, v = qkv[0], qkv[1], qkv[2]
        scale = Dh ** -0.5
        scores = torch.einsum("bhqd,bhkd->bhqk", q, k) * scale
        p = _softmax(scores, axis=-1)
        o = torch.einsum("bhqk,bhkd->bhqd", p, v)
        return (lambda x, *d: x.permute(*d))(o, 0, 2, 1, 3).reshape(B, S, D) @ wo

    def _B_ref(x, w1, b1, w2, b2):
        y = _layernorm(x, axis=-1)
        h = _gelu(torch.einsum("bsd,df->bsf", y, w1) + b1)
        return torch.einsum("bsf,fd->bsd", h, w2) + b2

    x = A_x
    xn = _layernorm(x, axis=-1)
    return x + _A_ref(xn, A_wqkv, A_wo) + _B_ref(xn, B_w1, B_b1, B_w2, B_b2)
```

```asm
; @launch kernel=gemm1_kernel grid=(256,1,1) block=(256,1,1) lds=147968
; @launch kernel=fused_kernel grid=(256,1,1) block=(512,1,1) lds=135232
.amdgcn_target "amdgcn-amd-amdhsa--gfx950"
.text
.globl gemm1_kernel
.p2align 8
.type gemm1_kernel,@function
gemm1_kernel:
    s_cmp_ge_u32 s2, 256
    s_cbranch_scc0 g1_go
    s_endpgm
g1_go:
    s_load_dwordx2 s[4:5], s[0:1], 8
    s_load_dwordx2 s[6:7], s[0:1], 32
    s_load_dwordx2 s[34:35], s[0:1], 40
    s_load_dwordx2 s[28:29], s[0:1], 80
    s_load_dwordx2 s[56:57], s[0:1], 0
    s_load_dwordx2 s[48:49], s[0:1], 72
    s_load_dwordx2 s[74:75], s[0:1], 48
    s_load_dwordx2 s[76:77], s[0:1], 16
    v_lshrrev_b32 v1, 6, v0
    s_and_b32 s3, s2, 7
    v_readfirstlane_b32 s33, v1
    v_and_b32 v1, 63, v0
    s_lshr_b32 s31, s2, 3
    s_lshr_b32 s32, s31, 3
    s_and_b32 s31, s31, 7
    s_lshl_b32 s3, s3, 1
    s_and_b32 s36, s32, 1
    s_add_u32 s3, s3, s36
    s_lshr_b32 s32, s32, 1
    s_lshl_b32 s32, s32, 4
    s_add_u32 s32, s32, s3
    s_waitcnt lgkmcnt(0)
    s_mov_b32 s50, 256
    s_mov_b32 s51, 0x20000
    s_or_b32 s36, s2, s33
    s_cmp_lg_u32 s36, 0
    s_cbranch_scc1 g1_notag
    s_memrealtime s[36:37]
    v_mov_b32 v8, 0
    s_waitcnt lgkmcnt(0)
    s_or_b32 s36, s36, 1
    v_mov_b32 v9, s36
    s_mov_b64 exec, 1
    buffer_store_dword v9, v8, s[48:51], 0 offen sc1
    s_mov_b64 exec, -1
g1_notag:
    s_lshl_b32 s36, s31, 8
    s_lshl_b32 s37, s32, 3
    s_add_u32 s36, s36, s37
    v_lshrrev_b32 v56, 5, v0
    v_add_u32 v56, s36, v56
    s_mov_b32 s58, 4194304
    s_mov_b32 s59, 0x20000
    v_and_b32 v57, 31, v1
    v_lshlrev_b32 v58, 11, v56
    v_lshl_add_u32 v58, v57, 4, v58
    buffer_load_dwordx4 v[64:67], v58, s[56:59], 0 offen offset:0
    buffer_load_dwordx4 v[68:71], v58, s[56:59], 0 offen offset:512
    buffer_load_dwordx4 v[72:75], v58, s[56:59], 0 offen offset:1024
    buffer_load_dwordx4 v[76:79], v58, s[56:59], 0 offen offset:1536
    s_add_u32 s60, s28, 0x2900000
    s_addc_u32 s61, s29, 0
    s_mov_b32 s62, 0x440000
    s_mov_b32 s63, 0x20000
    s_mov_b32 s44, s28
    s_mov_b32 s45, s29
    s_mov_b32 s46, 0x800000
    s_mov_b32 s47, 0x20000
    s_add_u32 s64, s28, 0x2810000
    s_addc_u32 s65, s29, 0
    s_mov_b32 s66, 0x22000
    s_mov_b32 s67, 0x20000
    s_cmp_ge_u32 s32, 16
    s_cbranch_scc1 g1_selh
    s_lshl_b32 s30, s32, 6
    s_branch g1_a
g1_selh:
    s_sub_u32 s30, s32, 16
    s_mul_i32 s30, s30, 224
    s_add_u32 s41, s30, 192
    s_add_u32 s36, s30, 32
    s_bitcmp1_b32 s32, 0
    s_cselect_b32 s41, s30, s41
    s_cselect_b32 s30, s36, s30
g1_h:
    s_mov_b32 s8, s6
    s_mov_b32 s9, s7
    s_mov_b32 s10, 0x700000
    s_mov_b32 s11, 0x20000
    s_mov_b32 s20, s34
    s_mov_b32 s21, s35
    s_mov_b32 s22, 0x1c00
    s_mov_b32 s23, 0x20000
    s_lshl_b32 s36, s31, 3
    s_lshl_b32 s37, s33, 1
    s_add_u32 s36, s36, s37
    s_lshl_b32 s37, s36, 16
    s_add_u32 s37, s37, 0x400000
    s_add_u32 s12, s28, s37
    s_addc_u32 s13, s29, 0
    s_mov_b32 s14, 0x10000
    s_mov_b32 s15, 0x20000
    s_add_u32 s16, s12, 0x10000
    s_addc_u32 s17, s13, 0
    s_mov_b32 s18, 0x10000
    s_mov_b32 s19, 0x20000
    v_lshlrev_b32 v2, 4, v1
    v_lshrrev_b32 v3, 5, v1
    v_lshlrev_b32 v3, 2, v3
    v_bfe_u32 v4, v1, 2, 2
    v_add_u32 v3, v3, v4
    s_lshl_b32 s37, s33, 4
    v_add_u32 v3, s37, v3
    v_mul_u32_u24 v3, 7168, v3
    v_bfe_u32 v4, v1, 4, 1
    v_lshl_add_u32 v3, v4, 6, v3
    v_and_b32 v4, 3, v1
    v_lshl_add_u32 v3, v4, 4, v3
    s_lshl_b32 s39, s30, 1
    v_add_u32 v3, s39, v3
    v_add_u32 v4, 57344, v3
    v_bfe_u32 v7, v1, 2, 2
    v_lshlrev_b32 v5, 6, v7
    v_bfe_u32 v7, v1, 4, 1
    v_lshl_add_u32 v5, v7, 5, v5
    v_and_b32 v7, 3, v1
    v_lshl_add_u32 v5, v7, 3, v5
    v_lshrrev_b32 v7, 5, v1
    v_lshl_add_u32 v60, v7, 9, v5
    v_add_u32 v61, 57344, v60
    v_lshrrev_b32 v6, 2, v1
    v_add_u32 v6, s37, v6
    v_mul_u32_u24 v6, 7168, v6
    v_and_b32 v62, 3, v1
    v_lshl_add_u32 v6, v62, 4, v6
    s_lshl_b32 s42, s41, 1
    v_add_u32 v6, s42, v6
    v_mul_u32_u24 v7, 3072, v7
    v_add_u32 v5, v5, v7
    v_add_u32 v7, 57344, v5
    s_mul_i32 s38, s33, 7168
    s_mov_b32 s24, 0
    s_mov_b32 s25, 0
    s_lshl_b32 s3, s31, 2
    s_add_u32 s3, s3, s33
    s_lshl_b32 s3, s3, 1
    s_add_u32 s3, s3, 128
    v_bfe_u32 v44, v1, 2, 1
    v_add_u32 v44, s3, v44
    v_mul_u32_u24 v44, 7168, v44
    v_and_b32 v45, 3, v1
    v_lshlrev_b32 v46, 7, v45
    v_add_u32 v46, s39, v46
    v_mov_b32 v47, s42
    v_cmp_eq_u32 vcc, 3, v45
    s_nop 1
    v_cndmask_b32 v46, v46, v47, vcc
    v_add_u32 v44, v44, v46
    v_lshrrev_b32 v47, 2, v1
    v_mul_u32_u24 v47, 7168, v47
    v_add_u32 v47, v47, v46
    v_lshlrev_b32 v62, 2, v1
    v_and_b32 v63, 63, v62
    v_add_u32 v63, s42, v63
    v_add_u32 v62, s39, v62
    v_add_u32 v8, 256, v62
    v_cmp_gt_u32 vcc, 32, v1
    s_mov_b32 m0, 147456
    v_cndmask_b32 v63, v63, v8, vcc
    buffer_load_dword v62, s[20:23], 0 offen lds
    s_mov_b32 m0, 147712
    s_nop 0
    buffer_load_dword v63, s[20:23], 0 offen lds
    s_add_u32 m0, s38, 0
    s_nop 0
    buffer_load_dwordx4 v3, s[8:11], s24 offen offset:0 lds
    s_add_u32 m0, s38, 896
    s_nop 0
    buffer_load_dwordx4 v3, s[8:11], s24 offen offset:128 lds
    s_add_u32 m0, s38, 1792
    s_nop 0
    buffer_load_dwordx4 v3, s[8:11], s24 offen offset:256 lds
    s_waitcnt vmcnt(5)
    s_add_u32 m0, s38, 3072
    s_nop 0
    buffer_load_dwordx4 v4, s[8:11], s24 offen offset:0 lds
    s_add_u32 m0, s38, 3968
    s_nop 0
    buffer_load_dwordx4 v4, s[8:11], s24 offen offset:128 lds
    s_add_u32 m0, s38, 4864
    s_nop 0
    buffer_load_dwordx4 v4, s[8:11], s24 offen offset:256 lds
    s_add_u32 m0, s38, 6144
    s_nop 0
    buffer_load_dwordx4 v6, s[8:11], s24 offen lds
    s_add_u32 s24, s24, 458752
    v_lshrrev_b32 v144, 5, v56
    v_lshlrev_b32 v144, 16, v144
    v_lshrrev_b32 v145, 1, v57
    v_lshl_add_u32 v144, v145, 10, v144
    v_and_b32 v145, 1, v57
    v_lshl_add_u32 v144, v145, 9, v144
    v_and_b32 v145, 31, v56
    v_lshl_add_u32 v144, v145, 4, v144
    s_mov_b32 s52, 0xffff0000
    s_mov_b32 s53, 0x3a800000
    s_mov_b32 s54, 0x3727c5ac
    v_add_u32 v144, v56, v57
    v_and_b32 v144, 7, v144
    v_lshlrev_b32 v144, 4, v144
    v_lshl_add_u32 v144, v57, 7, v144
    v_add_u32 v144, 114688, v144
    v_lshlrev_b32 v80, 16, v64
    v_and_b32 v81, s52, v64
    v_lshlrev_b32 v82, 16, v65
    v_and_b32 v83, s52, v65
    v_lshlrev_b32 v84, 16, v66
    v_and_b32 v85, s52, v66
    v_lshlrev_b32 v86, 16, v67
    v_and_b32 v87, s52, v67
    v_lshlrev_b32 v88, 16, v68
    v_and_b32 v89, s52, v68
    v_lshlrev_b32 v90, 16, v69
    v_and_b32 v91, s52, v69
    v_lshlrev_b32 v92, 16, v70
    v_and_b32 v93, s52, v70
    v_lshlrev_b32 v94, 16, v71
    v_and_b32 v95, s52, v71
    v_lshlrev_b32 v96, 16, v72
    v_and_b32 v97, s52, v72
    v_lshlrev_b32 v98, 16, v73
    v_and_b32 v99, s52, v73
    v_lshlrev_b32 v100, 16, v74
    v_and_b32 v101, s52, v74
    v_lshlrev_b32 v102, 16, v75
    v_and_b32 v103, s52, v75
    v_lshlrev_b32 v104, 16, v76
    v_and_b32 v105, s52, v76
    v_lshlrev_b32 v106, 16, v77
    v_and_b32 v107, s52, v77
    v_lshlrev_b32 v108, 16, v78
    v_and_b32 v109, s52, v78
    v_lshlrev_b32 v110, 16, v79
    v_and_b32 v111, s52, v79
    v_pk_add_f32 v[112:113], v[80:81], v[82:83]
    v_pk_add_f32 v[114:115], v[84:85], v[86:87]
    v_pk_add_f32 v[116:117], v[88:89], v[90:91]
    v_pk_add_f32 v[118:119], v[92:93], v[94:95]
    v_pk_add_f32 v[120:121], v[96:97], v[98:99]
    v_pk_add_f32 v[122:123], v[100:101], v[102:103]
    v_pk_add_f32 v[124:125], v[104:105], v[106:107]
    v_pk_add_f32 v[126:127], v[108:109], v[110:111]
    v_pk_add_f32 v[112:113], v[112:113], v[114:115]
    v_pk_add_f32 v[114:115], v[116:117], v[118:119]
    v_pk_add_f32 v[116:117], v[120:121], v[122:123]
    v_pk_add_f32 v[118:119], v[124:125], v[126:127]
    v_pk_add_f32 v[112:113], v[112:113], v[114:115]
    v_pk_add_f32 v[114:115], v[116:117], v[118:119]
    v_pk_add_f32 v[112:113], v[112:113], v[114:115]
    v_add_f32 v112, v112, v113
    s_nop 1
    v_add_f32_dpp v112, v112, v112 row_ror:8 row_mask:0xf bank_mask:0xf
    s_nop 1
    v_add_f32_dpp v112, v112, v112 row_ror:4 row_mask:0xf bank_mask:0xf
    s_nop 1
    v_add_f32_dpp v112, v112, v112 row_ror:2 row_mask:0xf bank_mask:0xf
    s_nop 1
    v_add_f32_dpp v112, v112, v112 row_ror:1 row_mask:0xf bank_mask:0xf
    v_mov_b32 v113, v112
    s_nop 1
    v_permlane16_swap_b32 v113, v112
    s_nop 1
    v_add_f32 v112, v112, v113
    v_mul_f32 v146, s53, v112
    v_mov_b32 v147, v146
    v_pk_add_f32 v[150:151], v[80:81], v[146:147] neg_lo:[0,1] neg_hi:[0,1]
    v_pk_add_f32 v[152:153], v[82:83], v[146:147] neg_lo:[0,1] neg_hi:[0,1]
    v_pk_add_f32 v[154:155], v[84:85], v[146:147] neg_lo:[0,1] neg_hi:[0,1]
    v_pk_add_f32 v[156:157], v[86:87], v[146:147] neg_lo:[0,1] neg_hi:[0,1]
    v_pk_add_f32 v[158:159], v[88:89], v[146:147] neg_lo:[0,1] neg_hi:[0,1]
    v_pk_add_f32 v[160:161], v[90:91], v[146:147] neg_lo:[0,1] neg_hi:[0,1]
    v_pk_add_f32 v[162:163], v[92:93], v[146:147] neg_lo:[0,1] neg_hi:[0,1]
    v_pk_add_f32 v[164:165], v[94:95], v[146:147] neg_lo:[0,1] neg_hi:[0,1]
    v_pk_add_f32 v[166:167], v[96:97], v[146:147] neg_lo:[0,1] neg_hi:[0,1]
    v_pk_add_f32 v[168:169], v[98:99], v[146:147] neg_lo:[0,1] neg_hi:[0,1]
    v_pk_add_f32 v[170:171], v[100:101], v[146:147] neg_lo:[0,1] neg_hi:[0,1]
    v_pk_add_f32 v[172:173], v[102:103], v[146:147] neg_lo:[0,1] neg_hi:[0,1]
    v_pk_add_f32 v[174:175], v[104:105], v[146:147] neg_lo:[0,1] neg_hi:[0,1]
    v_pk_add_f32 v[176:177], v[106:107], v[146:147] neg_lo:[0,1] neg_hi:[0,1]
    v_pk_add_f32 v[178:179], v[108:109], v[146:147] neg_lo:[0,1] neg_hi:[0,1]
    v_pk_add_f32 v[180:181], v[110:111], v[146:147] neg_lo:[0,1] neg_hi:[0,1]
    v_pk_mul_f32 v[112:113], v[150:151], v[150:151]
    v_pk_mul_f32 v[114:115], v[152:153], v[152:153]
    v_pk_mul_f32 v[116:117], v[154:155], v[154:155]
    v_pk_mul_f32 v[118:119], v[156:157], v[156:157]
    v_pk_fma_f32 v[112:113], v[158:159], v[158:159], v[112:113]
    v_pk_fma_f32 v[114:115], v[160:161], v[160:161], v[114:115]
    v_pk_fma_f32 v[116:117], v[162:163], v[162:163], v[116:117]
    v_pk_fma_f32 v[118:119], v[164:165], v[164:165], v[118:119]
    v_pk_fma_f32 v[112:113], v[166:167], v[166:167], v[112:113]
    v_pk_fma_f32 v[114:115], v[168:169], v[168:169], v[114:115]
    v_pk_fma_f32 v[116:117], v[170:171], v[170:171], v[116:117]
    v_pk_fma_f32 v[118:119], v[172:173], v[172:173], v[118:119]
    v_pk_fma_f32 v[112:113], v[174:175], v[174:175], v[112:113]
    v_pk_fma_f32 v[114:115], v[176:177], v[176:177], v[114:115]
    v_pk_fma_f32 v[116:117], v[178:179], v[178:179], v[116:117]
    v_pk_fma_f32 v[118:119], v[180:181], v[180:181], v[118:119]
    v_pk_add_f32 v[112:113], v[112:113], v[114:115]
    v_pk_add_f32 v[114:115], v[116:117], v[118:119]
    v_pk_add_f32 v[112:113], v[112:113], v[114:115]
    v_add_f32 v112, v112, v113
    s_nop 1
    v_add_f32_dpp v112, v112, v112 row_ror:8 row_mask:0xf bank_mask:0xf
    s_nop 1
    v_add_f32_dpp v112, v112, v112 row_ror:4 row_mask:0xf bank_mask:0xf
    s_nop 1
    v_add_f32_dpp v112, v112, v112 row_ror:2 row_mask:0xf bank_mask:0xf
    s_nop 1
    v_add_f32_dpp v112, v112, v112 row_ror:1 row_mask:0xf bank_mask:0xf
    v_mov_b32 v113, v112
    s_nop 1
    v_permlane16_swap_b32 v113, v112
    s_nop 1
    v_add_f32 v112, v112, v113
    v_mul_f32 v148, s53, v112
    v_cvt_pk_bf16_f32 v148, v148, v148
    v_lshlrev_b32 v148, 16, v148
    v_add_f32 v148, s54, v148
    v_cvt_pk_bf16_f32 v148, v148, v148
    v_lshlrev_b32 v148, 16, v148
    v_sqrt_f32 v148, v148
    s_nop 0
    v_cvt_pk_bf16_f32 v148, v148, v148
    v_lshlrev_b32 v148, 16, v148
    v_rcp_f32 v148, v148
    v_cvt_pk_bf16_f32 v146, v146, v146
    v_lshlrev_b32 v146, 16, v146
    v_mov_b32 v147, v146
    v_mov_b32 v149, v148
    v_pk_add_f32 v[80:81], v[80:81], v[146:147] neg_lo:[0,1] neg_hi:[0,1]
    v_pk_add_f32 v[82:83], v[82:83], v[146:147] neg_lo:[0,1] neg_hi:[0,1]
    v_pk_add_f32 v[84:85], v[84:85], v[146:147] neg_lo:[0,1] neg_hi:[0,1]
    v_pk_add_f32 v[86:87], v[86:87], v[146:147] neg_lo:[0,1] neg_hi:[0,1]
    v_pk_add_f32 v[88:89], v[88:89], v[146:147] neg_lo:[0,1] neg_hi:[0,1]
    v_pk_add_f32 v[90:91], v[90:91], v[146:147] neg_lo:[0,1] neg_hi:[0,1]
    v_pk_add_f32 v[92:93], v[92:93], v[146:147] neg_lo:[0,1] neg_hi:[0,1]
    v_pk_add_f32 v[94:95], v[94:95], v[146:147] neg_lo:[0,1] neg_hi:[0,1]
    v_pk_add_f32 v[96:97], v[96:97], v[146:147] neg_lo:[0,1] neg_hi:[0,1]
    v_pk_add_f32 v[98:99], v[98:99], v[146:147] neg_lo:[0,1] neg_hi:[0,1]
    v_pk_add_f32 v[100:101], v[100:101], v[146:147] neg_lo:[0,1] neg_hi:[0,1]
    v_pk_add_f32 v[102:103], v[102:103], v[146:147] neg_lo:[0,1] neg_hi:[0,1]
    v_pk_add_f32 v[104:105], v[104:105], v[146:147] neg_lo:[0,1] neg_hi:[0,1]
    v_pk_add_f32 v[106:107], v[106:107], v[146:147] neg_lo:[0,1] neg_hi:[0,1]
    v_pk_add_f32 v[108:109], v[108:109], v[146:147] neg_lo:[0,1] neg_hi:[0,1]
    v_pk_add_f32 v[110:111], v[110:111], v[146:147] neg_lo:[0,1] neg_hi:[0,1]
    v_cvt_pk_bf16_f32 v64, v80, v81
    v_cvt_pk_bf16_f32 v65, v82, v83
    v_cvt_pk_bf16_f32 v66, v84, v85
    v_cvt_pk_bf16_f32 v67, v86, v87
    v_cvt_pk_bf16_f32 v68, v88, v89
    v_cvt_pk_bf16_f32 v69, v90, v91
    v_cvt_pk_bf16_f32 v70, v92, v93
    v_cvt_pk_bf16_f32 v71, v94, v95
    v_cvt_pk_bf16_f32 v72, v96, v97
    v_cvt_pk_bf16_f32 v73, v98, v99
    v_cvt_pk_bf16_f32 v74, v100, v101
    v_cvt_pk_bf16_f32 v75, v102, v103
    v_cvt_pk_bf16_f32 v76, v104, v105
    v_cvt_pk_bf16_f32 v77, v106, v107
    v_cvt_pk_bf16_f32 v78, v108, v109
    v_cvt_pk_bf16_f32 v79, v110, v111
    v_lshlrev_b32 v80, 16, v64
    v_and_b32 v81, s52, v64
    v_lshlrev_b32 v82, 16, v65
    v_and_b32 v83, s52, v65
    v_lshlrev_b32 v84, 16, v66
    v_and_b32 v85, s52, v66
    v_lshlrev_b32 v86, 16, v67
    v_and_b32 v87, s52, v67
    v_lshlrev_b32 v88, 16, v68
    v_and_b32 v89, s52, v68
    v_lshlrev_b32 v90, 16, v69
    v_and_b32 v91, s52, v69
    v_lshlrev_b32 v92, 16, v70
    v_and_b32 v93, s52, v70
    v_lshlrev_b32 v94, 16, v71
    v_and_b32 v95, s52, v71
    v_lshlrev_b32 v96, 16, v72
    v_and_b32 v97, s52, v72
    v_lshlrev_b32 v98, 16, v73
    v_and_b32 v99, s52, v73
    v_lshlrev_b32 v100, 16, v74
    v_and_b32 v101, s52, v74
    v_lshlrev_b32 v102, 16, v75
    v_and_b32 v103, s52, v75
    v_lshlrev_b32 v104, 16, v76
    v_and_b32 v105, s52, v76
    v_lshlrev_b32 v106, 16, v77
    v_and_b32 v107, s52, v77
    v_lshlrev_b32 v108, 16, v78
    v_and_b32 v109, s52, v78
    v_lshlrev_b32 v110, 16, v79
    v_and_b32 v111, s52, v79
    v_pk_mul_f32 v[80:81], v[80:81], v[148:149]
    v_pk_mul_f32 v[82:83], v[82:83], v[148:149]
    v_pk_mul_f32 v[84:85], v[84:85], v[148:149]
    v_pk_mul_f32 v[86:87], v[86:87], v[148:149]
    v_pk_mul_f32 v[88:89], v[88:89], v[148:149]
    v_pk_mul_f32 v[90:91], v[90:91], v[148:149]
    v_pk_mul_f32 v[92:93], v[92:93], v[148:149]
    v_pk_mul_f32 v[94:95], v[94:95], v[148:149]
    v_pk_mul_f32 v[96:97], v[96:97], v[148:149]
    v_pk_mul_f32 v[98:99], v[98:99], v[148:149]
    v_pk_mul_f32 v[100:101], v[100:101], v[148:149]
    v_pk_mul_f32 v[102:103], v[102:103], v[148:149]
    v_pk_mul_f32 v[104:105], v[104:105], v[148:149]
    v_pk_mul_f32 v[106:107], v[106:107], v[148:149]
    v_pk_mul_f32 v[108:109], v[108:109], v[148:149]
    v_pk_mul_f32 v[110:111], v[110:111], v[148:149]
    v_cvt_pk_bf16_f32 v184, v80, v81
    v_cvt_pk_bf16_f32 v185, v82, v83
    v_cvt_pk_bf16_f32 v186, v84, v85
    v_cvt_pk_bf16_f32 v187, v86, v87
    v_cvt_pk_bf16_f32 v188, v88, v89
    v_cvt_pk_bf16_f32 v189, v90, v91
    v_cvt_pk_bf16_f32 v190, v92, v93
    v_cvt_pk_bf16_f32 v191, v94, v95
    v_cvt_pk_bf16_f32 v192, v96, v97
    v_cvt_pk_bf16_f32 v193, v98, v99
    v_cvt_pk_bf16_f32 v194, v100, v101
    v_cvt_pk_bf16_f32 v195, v102, v103
    v_cvt_pk_bf16_f32 v196, v104, v105
    v_cvt_pk_bf16_f32 v197, v106, v107
    v_cvt_pk_bf16_f32 v198, v108, v109
    v_cvt_pk_bf16_f32 v199, v110, v111
    ds_write_b128 v144, v[184:187] offset:0
    ds_write_b128 v144, v[188:191] offset:4096
    ds_write_b128 v144, v[192:195] offset:8192
    ds_write_b128 v144, v[196:199] offset:12288
    v_mov_b32 v20, 0
    buffer_load_dword v21, v20, s[48:51], 0 offen
    v_lshlrev_b32 v80, 16, v184
    v_and_b32 v81, s52, v184
    v_lshlrev_b32 v82, 16, v185
    v_and_b32 v83, s52, v185
    v_lshlrev_b32 v84, 16, v186
    v_and_b32 v85, s52, v186
    v_lshlrev_b32 v86, 16, v187
    v_and_b32 v87, s52, v187
    v_lshlrev_b32 v88, 16, v188
    v_and_b32 v89, s52, v188
    v_lshlrev_b32 v90, 16, v189
    v_and_b32 v91, s52, v189
    v_lshlrev_b32 v92, 16, v190
    v_and_b32 v93, s52, v190
    v_lshlrev_b32 v94, 16, v191
    v_and_b32 v95, s52, v191
    v_lshlrev_b32 v96, 16, v192
    v_and_b32 v97, s52, v192
    v_lshlrev_b32 v98, 16, v193
    v_and_b32 v99, s52, v193
    v_lshlrev_b32 v100, 16, v194
    v_and_b32 v101, s52, v194
    v_lshlrev_b32 v102, 16, v195
    v_and_b32 v103, s52, v195
    v_lshlrev_b32 v104, 16, v196
    v_and_b32 v105, s52, v196
    v_lshlrev_b32 v106, 16, v197
    v_and_b32 v107, s52, v197
    v_lshlrev_b32 v108, 16, v198
    v_and_b32 v109, s52, v198
    v_lshlrev_b32 v110, 16, v199
    v_and_b32 v111, s52, v199
    v_pk_add_f32 v[112:113], v[80:81], v[82:83]
    v_pk_add_f32 v[114:115], v[84:85], v[86:87]
    v_pk_add_f32 v[116:117], v[88:89], v[90:91]
    v_pk_add_f32 v[118:119], v[92:93], v[94:95]
    v_pk_add_f32 v[120:121], v[96:97], v[98:99]
    v_pk_add_f32 v[122:123], v[100:101], v[102:103]
    v_pk_add_f32 v[124:125], v[104:105], v[106:107]
    v_pk_add_f32 v[126:127], v[108:109], v[110:111]
    v_pk_add_f32 v[112:113], v[112:113], v[114:115]
    v_pk_add_f32 v[114:115], v[116:117], v[118:119]
    v_pk_add_f32 v[116:117], v[120:121], v[122:123]
    v_pk_add_f32 v[118:119], v[124:125], v[126:127]
    v_pk_add_f32 v[112:113], v[112:113], v[114:115]
    v_pk_add_f32 v[114:115], v[116:117], v[118:119]
    v_pk_add_f32 v[112:113], v[112:113], v[114:115]
    v_add_f32 v112, v112, v113
    s_nop 1
    v_add_f32_dpp v112, v112, v112 row_ror:8 row_mask:0xf bank_mask:0xf
    s_nop 1
    v_add_f32_dpp v112, v112, v112 row_ror:4 row_mask:0xf bank_mask:0xf
    s_nop 1
    v_add_f32_dpp v112, v112, v112 row_ror:2 row_mask:0xf bank_mask:0xf
    s_nop 1
    v_add_f32_dpp v112, v112, v112 row_ror:1 row_mask:0xf bank_mask:0xf
    v_mov_b32 v113, v112
    s_nop 1
    v_permlane16_swap_b32 v113, v112
    s_nop 1
    v_add_f32 v112, v112, v113
    v_mul_f32 v146, s53, v112
    v_mov_b32 v147, v146
    v_pk_add_f32 v[150:151], v[80:81], v[146:147] neg_lo:[0,1] neg_hi:[0,1]
    v_pk_add_f32 v[152:153], v[82:83], v[146:147] neg_lo:[0,1] neg_hi:[0,1]
    v_pk_add_f32 v[154:155], v[84:85], v[146:147] neg_lo:[0,1] neg_hi:[0,1]
    v_pk_add_f32 v[156:157], v[86:87], v[146:147] neg_lo:[0,1] neg_hi:[0,1]
    v_pk_add_f32 v[158:159], v[88:89], v[146:147] neg_lo:[0,1] neg_hi:[0,1]
    v_pk_add_f32 v[160:161], v[90:91], v[146:147] neg_lo:[0,1] neg_hi:[0,1]
    v_pk_add_f32 v[162:163], v[92:93], v[146:147] neg_lo:[0,1] neg_hi:[0,1]
    v_pk_add_f32 v[164:165], v[94:95], v[146:147] neg_lo:[0,1] neg_hi:[0,1]
    v_pk_add_f32 v[166:167], v[96:97], v[146:147] neg_lo:[0,1] neg_hi:[0,1]
    v_pk_add_f32 v[168:169], v[98:99], v[146:147] neg_lo:[0,1] neg_hi:[0,1]
    v_pk_add_f32 v[170:171], v[100:101], v[146:147] neg_lo:[0,1] neg_hi:[0,1]
    v_pk_add_f32 v[172:173], v[102:103], v[146:147] neg_lo:[0,1] neg_hi:[0,1]
    v_pk_add_f32 v[174:175], v[104:105], v[146:147] neg_lo:[0,1] neg_hi:[0,1]
    v_pk_add_f32 v[176:177], v[106:107], v[146:147] neg_lo:[0,1] neg_hi:[0,1]
    v_pk_add_f32 v[178:179], v[108:109], v[146:147] neg_lo:[0,1] neg_hi:[0,1]
    v_pk_add_f32 v[180:181], v[110:111], v[146:147] neg_lo:[0,1] neg_hi:[0,1]
    v_pk_mul_f32 v[112:113], v[150:151], v[150:151]
    v_pk_mul_f32 v[114:115], v[152:153], v[152:153]
    v_pk_mul_f32 v[116:117], v[154:155], v[154:155]
    v_pk_mul_f32 v[118:119], v[156:157], v[156:157]
    v_pk_fma_f32 v[112:113], v[158:159], v[158:159], v[112:113]
    v_pk_fma_f32 v[114:115], v[160:161], v[160:161], v[114:115]
    v_pk_fma_f32 v[116:117], v[162:163], v[162:163], v[116:117]
    v_pk_fma_f32 v[118:119], v[164:165], v[164:165], v[118:119]
    v_pk_fma_f32 v[112:113], v[166:167], v[166:167], v[112:113]
    v_pk_fma_f32 v[114:115], v[168:169], v[168:169], v[114:115]
    v_pk_fma_f32 v[116:117], v[170:171], v[170:171], v[116:117]
    v_pk_fma_f32 v[118:119], v[172:173], v[172:173], v[118:119]
    v_pk_fma_f32 v[112:113], v[174:175], v[174:175], v[112:113]
    v_pk_fma_f32 v[114:115], v[176:177], v[176:177], v[114:115]
    v_pk_fma_f32 v[116:117], v[178:179], v[178:179], v[116:117]
    v_pk_fma_f32 v[118:119], v[180:181], v[180:181], v[118:119]
    v_pk_add_f32 v[112:113], v[112:113], v[114:115]
    v_pk_add_f32 v[114:115], v[116:117], v[118:119]
    v_pk_add_f32 v[112:113], v[112:113], v[114:115]
    v_add_f32 v112, v112, v113
    s_nop 1
    v_add_f32_dpp v112, v112, v112 row_ror:8 row_mask:0xf bank_mask:0xf
    s_nop 1
    v_add_f32_dpp v112, v112, v112 row_ror:4 row_mask:0xf bank_mask:0xf
    s_nop 1
    v_add_f32_dpp v112, v112, v112 row_ror:2 row_mask:0xf bank_mask:0xf
    s_nop 1
    v_add_f32_dpp v112, v112, v112 row_ror:1 row_mask:0xf bank_mask:0xf
    v_mov_b32 v113, v112
    s_nop 1
    v_permlane16_swap_b32 v113, v112
    s_nop 1
    v_add_f32 v112, v112, v113
    v_mul_f32 v148, s53, v112
    v_cvt_pk_bf16_f32 v148, v148, v148
    v_lshlrev_b32 v148, 16, v148
    v_add_f32 v148, s54, v148
    v_cvt_pk_bf16_f32 v148, v148, v148
    v_lshlrev_b32 v148, 16, v148
    v_sqrt_f32 v148, v148
    s_nop 0
    v_cvt_pk_bf16_f32 v148, v148, v148
    v_lshlrev_b32 v148, 16, v148
    v_rcp_f32 v148, v148
    v_cvt_pk_bf16_f32 v146, v146, v146
    v_lshlrev_b32 v146, 16, v146
    v_mov_b32 v147, v146
    v_mov_b32 v149, v148
    v_pk_add_f32 v[80:81], v[80:81], v[146:147] neg_lo:[0,1] neg_hi:[0,1]
    v_pk_add_f32 v[82:83], v[82:83], v[146:147] neg_lo:[0,1] neg_hi:[0,1]
    v_pk_add_f32 v[84:85], v[84:85], v[146:147] neg_lo:[0,1] neg_hi:[0,1]
    v_pk_add_f32 v[86:87], v[86:87], v[146:147] neg_lo:[0,1] neg_hi:[0,1]
    v_pk_add_f32 v[88:89], v[88:89], v[146:147] neg_lo:[0,1] neg_hi:[0,1]
    v_pk_add_f32 v[90:91], v[90:91], v[146:147] neg_lo:[0,1] neg_hi:[0,1]
    v_pk_add_f32 v[92:93], v[92:93], v[146:147] neg_lo:[0,1] neg_hi:[0,1]
    v_pk_add_f32 v[94:95], v[94:95], v[146:147] neg_lo:[0,1] neg_hi:[0,1]
    v_pk_add_f32 v[96:97], v[96:97], v[146:147] neg_lo:[0,1] neg_hi:[0,1]
    v_pk_add_f32 v[98:99], v[98:99], v[146:147] neg_lo:[0,1] neg_hi:[0,1]
    v_pk_add_f32 v[100:101], v[100:101], v[146:147] neg_lo:[0,1] neg_hi:[0,1]
    v_pk_add_f32 v[102:103], v[102:103], v[146:147] neg_lo:[0,1] neg_hi:[0,1]
    v_pk_add_f32 v[104:105], v[104:105], v[146:147] neg_lo:[0,1] neg_hi:[0,1]
    v_pk_add_f32 v[106:107], v[106:107], v[146:147] neg_lo:[0,1] neg_hi:[0,1]
    v_pk_add_f32 v[108:109], v[108:109], v[146:147] neg_lo:[0,1] neg_hi:[0,1]
    v_pk_add_f32 v[110:111], v[110:111], v[146:147] neg_lo:[0,1] neg_hi:[0,1]
    v_cvt_pk_bf16_f32 v64, v80, v81
    v_cvt_pk_bf16_f32 v65, v82, v83
    v_cvt_pk_bf16_f32 v66, v84, v85
    v_cvt_pk_bf16_f32 v67, v86, v87
    v_cvt_pk_bf16_f32 v68, v88, v89
    v_cvt_pk_bf16_f32 v69, v90, v91
    v_cvt_pk_bf16_f32 v70, v92, v93
    v_cvt_pk_bf16_f32 v71, v94, v95
    v_cvt_pk_bf16_f32 v72, v96, v97
    v_cvt_pk_bf16_f32 v73, v98, v99
    v_cvt_pk_bf16_f32 v74, v100, v101
    v_cvt_pk_bf16_f32 v75, v102, v103
    v_cvt_pk_bf16_f32 v76, v104, v105
    v_cvt_pk_bf16_f32 v77, v106, v107
    v_cvt_pk_bf16_f32 v78, v108, v109
    v_cvt_pk_bf16_f32 v79, v110, v111
    v_lshlrev_b32 v80, 16, v64
    v_and_b32 v81, s52, v64
    v_lshlrev_b32 v82, 16, v65
    v_and_b32 v83, s52, v65
    v_lshlrev_b32 v84, 16, v66
    v_and_b32 v85, s52, v66
    v_lshlrev_b32 v86, 16, v67
    v_and_b32 v87, s52, v67
    v_lshlrev_b32 v88, 16, v68
    v_and_b32 v89, s52, v68
    v_lshlrev_b32 v90, 16, v69
    v_and_b32 v91, s52, v69
    v_lshlrev_b32 v92, 16, v70
    v_and_b32 v93, s52, v70
    v_lshlrev_b32 v94, 16, v71
    v_and_b32 v95, s52, v71
    v_lshlrev_b32 v96, 16, v72
    v_and_b32 v97, s52, v72
    v_lshlrev_b32 v98, 16, v73
    v_and_b32 v99, s52, v73
    v_lshlrev_b32 v100, 16, v74
    v_and_b32 v101, s52, v74
    v_lshlrev_b32 v102, 16, v75
    v_and_b32 v103, s52, v75
    v_lshlrev_b32 v104, 16, v76
    v_and_b32 v105, s52, v76
    v_lshlrev_b32 v106, 16, v77
    v_and_b32 v107, s52, v77
    v_lshlrev_b32 v108, 16, v78
    v_and_b32 v109, s52, v78
    v_lshlrev_b32 v110, 16, v79
    v_and_b32 v111, s52, v79
    v_pk_mul_f32 v[80:81], v[80:81], v[148:149]
    v_pk_mul_f32 v[82:83], v[82:83], v[148:149]
    v_pk_mul_f32 v[84:85], v[84:85], v[148:149]
    v_pk_mul_f32 v[86:87], v[86:87], v[148:149]
    v_pk_mul_f32 v[88:89], v[88:89], v[148:149]
    v_pk_mul_f32 v[90:91], v[90:91], v[148:149]
    v_pk_mul_f32 v[92:93], v[92:93], v[148:149]
    v_pk_mul_f32 v[94:95], v[94:95], v[148:149]
    v_pk_mul_f32 v[96:97], v[96:97], v[148:149]
    v_pk_mul_f32 v[98:99], v[98:99], v[148:149]
    v_pk_mul_f32 v[100:101], v[100:101], v[148:149]
    v_pk_mul_f32 v[102:103], v[102:103], v[148:149]
    v_pk_mul_f32 v[104:105], v[104:105], v[148:149]
    v_pk_mul_f32 v[106:107], v[106:107], v[148:149]
    v_pk_mul_f32 v[108:109], v[108:109], v[148:149]
    v_pk_mul_f32 v[110:111], v[110:111], v[148:149]
    v_cvt_pk_bf16_f32 v64, v80, v81
    v_cvt_pk_bf16_f32 v65, v82, v83
    v_cvt_pk_bf16_f32 v66, v84, v85
    v_cvt_pk_bf16_f32 v67, v86, v87
    v_cvt_pk_bf16_f32 v68, v88, v89
    v_cvt_pk_bf16_f32 v69, v90, v91
    v_cvt_pk_bf16_f32 v70, v92, v93
    v_cvt_pk_bf16_f32 v71, v94, v95
    v_cvt_pk_bf16_f32 v72, v96, v97
    v_cvt_pk_bf16_f32 v73, v98, v99
    v_cvt_pk_bf16_f32 v74, v100, v101
    v_cvt_pk_bf16_f32 v75, v102, v103
    v_cvt_pk_bf16_f32 v76, v104, v105
    v_cvt_pk_bf16_f32 v77, v106, v107
    v_cvt_pk_bf16_f32 v78, v108, v109
    v_cvt_pk_bf16_f32 v79, v110, v111
    ds_write_b128 v144, v[64:67] offset:16384
    ds_write_b128 v144, v[68:71] offset:20480
    ds_write_b128 v144, v[72:75] offset:24576
    ds_write_b128 v144, v[76:79] offset:28672
    v_lshrrev_b32 v146, 3, v1
    v_add_u32 v144, v146, v1
    v_and_b32 v144, 7, v144
    v_lshlrev_b32 v144, 4, v144
    v_lshl_add_u32 v144, v146, 7, v144
    s_lshl_b32 s52, s33, 12
    s_add_u32 s52, s52, 114688
    v_add_u32 v144, s52, v144
    v_lshrrev_b32 v145, 5, v56
    v_lshlrev_b32 v145, 16, v145
    v_lshl_add_u32 v145, v146, 9, v145
    v_and_b32 v146, 24, v56
    v_and_b32 v148, 7, v1
    v_add_u32 v146, v146, v148
    v_lshl_add_u32 v145, v146, 4, v145
    s_lshl_b32 s52, s33, 14
    s_waitcnt lgkmcnt(0)
    s_barrier
    ds_read_b128 v[80:83], v144 offset:0
    ds_read_b128 v[84:87], v144 offset:1024
    ds_read_b128 v[88:91], v144 offset:2048
    ds_read_b128 v[92:95], v144 offset:3072
    ds_read_b128 v[96:99], v144 offset:16384
    ds_read_b128 v[100:103], v144 offset:17408
    ds_read_b128 v[104:107], v144 offset:18432
    ds_read_b128 v[108:111], v144 offset:19456
    s_add_u32 s55, s52, 0x0
    s_waitcnt lgkmcnt(7)
    buffer_store_dwordx4 v[80:83], v145, s[44:47], s55 offen sc1
    s_add_u32 s55, s52, 0x1000
    s_waitcnt lgkmcnt(6)
    buffer_store_dwordx4 v[84:87], v145, s[44:47], s55 offen sc1
    s_add_u32 s55, s52, 0x2000
    s_waitcnt lgkmcnt(5)
    buffer_store_dwordx4 v[88:91], v145, s[44:47], s55 offen sc1
    s_add_u32 s55, s52, 0x3000
    s_waitcnt lgkmcnt(4)
    buffer_store_dwordx4 v[92:95], v145, s[44:47], s55 offen sc1
    s_add_u32 s55, s52, 0x400000
    s_waitcnt lgkmcnt(3)
    buffer_store_dwordx4 v[96:99], v145, s[44:47], s55 offen sc1
    s_add_u32 s55, s52, 0x401000
    s_waitcnt lgkmcnt(2)
    buffer_store_dwordx4 v[100:103], v145, s[44:47], s55 offen sc1
    s_add_u32 s55, s52, 0x402000
    s_waitcnt lgkmcnt(1)
    buffer_store_dwordx4 v[104:107], v145, s[44:47], s55 offen sc1
    s_add_u32 s55, s52, 0x403000
    s_waitcnt lgkmcnt(0)
    buffer_store_dwordx4 v[108:111], v145, s[44:47], s55 offen sc1
    v_lshrrev_b32 v8, 4, v0
    v_lshl_add_u32 v8, v8, 8, s2
    v_mul_u32_u24 v8, 4352, v8
    v_and_b32 v9, 15, v0
    v_lshl_add_u32 v8, v9, 2, v8
    v_mov_b32 v9, 0
    buffer_store_dword v9, v8, s[60:63], 0 offen
    s_mul_i32 s37, s31, 4
    v_add_u32 v22, s37, v1
    v_mul_u32_u24 v22, 4352, v22
    s_lshl_b32 s39, s32, 2
    v_add_u32 v22, s39, v22
    s_and_b32 s39, s32, 3
    s_add_u32 s37, s37, s39
    s_mul_i32 s37, s37, 4352
    v_and_b32 v23, 31, v1
    v_lshlrev_b32 v23, 2, v23
    v_add_u32 v23, s37, v23
    s_mov_b32 s43, 0
    s_waitcnt vmcnt(0)
    s_barrier
    s_cmp_lg_u32 s33, 0
    s_cbranch_scc1 g1_h_pub
    v_cmp_eq_u32 vcc, 0, v21
    s_cbranch_vccz g1_h_tag
g1_h_tagpoll:
    buffer_load_dword v21, v20, s[48:51], 0 offen sc1
    s_add_u32 s43, s43, 1
    s_waitcnt vmcnt(0)
    v_cmp_eq_u32 vcc, 0, v21
    s_cmp_ge_u32 s43, 0x8000
    s_cbranch_scc1 g1_h_tag
    s_cbranch_vccnz g1_h_tagpoll
g1_h_tag:
    s_mov_b64 exec, 15
    buffer_store_dword v21, v22, s[64:67], 0 offen sc1
    s_mov_b64 exec, -1
g1_h_pub:
    s_add_u32 m0, s38, 28672
    s_nop 0
    buffer_load_dwordx4 v3, s[8:11], s24 offen offset:0 lds
    s_add_u32 m0, s38, 29568
    s_nop 0
    buffer_load_dwordx4 v3, s[8:11], s24 offen offset:128 lds
    s_add_u32 m0, s38, 30464
    s_nop 0
    buffer_load_dwordx4 v3, s[8:11], s24 offen offset:256 lds
    s_add_u32 m0, s38, 31744
    s_nop 0
    buffer_load_dwordx4 v4, s[8:11], s24 offen offset:0 lds
    s_add_u32 m0, s38, 32640
    s_nop 0
    buffer_load_dwordx4 v4, s[8:11], s24 offen offset:128 lds
    s_add_u32 m0, s38, 33536
    s_nop 0
    buffer_load_dwordx4 v4, s[8:11], s24 offen offset:256 lds
    s_add_u32 m0, s38, 34816
    s_nop 0
    buffer_load_dwordx4 v6, s[8:11], s24 offen lds
    s_add_u32 s24, s24, 458752
    s_add_u32 m0, s38, 57344
    s_nop 0
    buffer_load_dwordx4 v3, s[8:11], s24 offen offset:0 lds
    s_add_u32 m0, s38, 58240
    s_nop 0
    buffer_load_dwordx4 v3, s[8:11], s24 offen offset:128 lds
    s_add_u32 m0, s38, 59136
    s_nop 0
    buffer_load_dwordx4 v3, s[8:11], s24 offen offset:256 lds
    s_mov_b32 s3, 458752
    buffer_load_dword v45, v44, s[8:11], s3 offen
    s_mov_b32 s3, 917504
    buffer_load_dword v45, v44, s[8:11], s3 offen
    s_mov_b32 s37, 0xffff0000
    v_lshrrev_b32 v62, 5, v1
    v_lshlrev_b32 v62, 3, v62
    v_add_u32 v62, 147456, v62
    ds_read_b64 v[24:25], v62 offset:0
    ds_read_b64 v[26:27], v62 offset:16
    ds_read_b64 v[28:29], v62 offset:32
    ds_read_b64 v[30:31], v62 offset:48
    ds_read_b64 v[32:33], v62 offset:64
    ds_read_b64 v[34:35], v62 offset:80
    ds_read_b64 v[36:37], v62 offset:96
    ds_read_b64 v[38:39], v62 offset:112
    s_waitcnt lgkmcnt(4)
    v_lshlrev_b32 v64, 16, v24
    v_and_b32 v65, s37, v24
    v_lshlrev_b32 v66, 16, v25
    v_and_b32 v67, s37, v25
    v_lshlrev_b32 v68, 16, v26
    v_and_b32 v69, s37, v26
    v_lshlrev_b32 v70, 16, v27
    v_and_b32 v71, s37, v27
    v_lshlrev_b32 v72, 16, v28
    v_and_b32 v73, s37, v28
    v_lshlrev_b32 v74, 16, v29
    v_and_b32 v75, s37, v29
    v_lshlrev_b32 v76, 16, v30
    v_and_b32 v77, s37, v30
    v_lshlrev_b32 v78, 16, v31
    v_and_b32 v79, s37, v31
    v_lshlrev_b32 v80, 16, v24
    v_and_b32 v81, s37, v24
    v_lshlrev_b32 v82, 16, v25
    v_and_b32 v83, s37, v25
    v_lshlrev_b32 v84, 16, v26
    v_and_b32 v85, s37, v26
    v_lshlrev_b32 v86, 16, v27
    v_and_b32 v87, s37, v27
    v_lshlrev_b32 v88, 16, v28
    v_and_b32 v89, s37, v28
    v_lshlrev_b32 v90, 16, v29
    v_and_b32 v91, s37, v29
    v_lshlrev_b32 v92, 16, v30
    v_and_b32 v93, s37, v30
    v_lshlrev_b32 v94, 16, v31
    v_and_b32 v95, s37, v31
    ds_read_b64 v[24:25], v62 offset:128
    ds_read_b64 v[26:27], v62 offset:144
    ds_read_b64 v[28:29], v62 offset:160
    ds_read_b64 v[30:31], v62 offset:176
    s_waitcnt lgkmcnt(4)
    v_lshlrev_b32 v96, 16, v32
    v_and_b32 v97, s37, v32
    v_lshlrev_b32 v98, 16, v33
    v_and_b32 v99, s37, v33
    v_lshlrev_b32 v100, 16, v34
    v_and_b32 v101, s37, v34
    v_lshlrev_b32 v102, 16, v35
    v_and_b32 v103, s37, v35
    v_lshlrev_b32 v104, 16, v36
    v_and_b32 v105, s37, v36
    v_lshlrev_b32 v106, 16, v37
    v_and_b32 v107, s37, v37
    v_lshlrev_b32 v108, 16, v38
    v_and_b32 v109, s37, v38
    v_lshlrev_b32 v110, 16, v39
    v_and_b32 v111, s37, v39
    v_lshlrev_b32 v112, 16, v32
    v_and_b32 v113, s37, v32
    v_lshlrev_b32 v114, 16, v33
    v_and_b32 v115, s37, v33
    v_lshlrev_b32 v116, 16, v34
    v_and_b32 v117, s37, v34
    v_lshlrev_b32 v118, 16, v35
    v_and_b32 v119, s37, v35
    v_lshlrev_b32 v120, 16, v36
    v_and_b32 v121, s37, v36
    v_lshlrev_b32 v122, 16, v37
    v_and_b32 v123, s37, v37
    v_lshlrev_b32 v124, 16, v38
    v_and_b32 v125, s37, v38
    v_lshlrev_b32 v126, 16, v39
    v_and_b32 v127, s37, v39
    ds_read_b64 v[32:33], v62 offset:192
    ds_read_b64 v[34:35], v62 offset:208
    ds_read_b64 v[36:37], v62 offset:224
    ds_read_b64 v[38:39], v62 offset:240
    s_waitcnt lgkmcnt(4)
    v_lshlrev_b32 v128, 16, v24
    v_and_b32 v129, s37, v24
    v_lshlrev_b32 v130, 16, v25
    v_and_b32 v131, s37, v25
    v_lshlrev_b32 v132, 16, v26
    v_and_b32 v133, s37, v26
    v_lshlrev_b32 v134, 16, v27
    v_and_b32 v135, s37, v27
    v_lshlrev_b32 v136, 16, v28
    v_and_b32 v137, s37, v28
    v_lshlrev_b32 v138, 16, v29
    v_and_b32 v139, s37, v29
    v_lshlrev_b32 v140, 16, v30
    v_and_b32 v141, s37, v30
    v_lshlrev_b32 v142, 16, v31
    v_and_b32 v143, s37, v31
    v_lshlrev_b32 v144, 16, v24
    v_and_b32 v145, s37, v24
    v_lshlrev_b32 v146, 16, v25
    v_and_b32 v147, s37, v25
    v_lshlrev_b32 v148, 16, v26
    v_and_b32 v149, s37, v26
    v_lshlrev_b32 v150, 16, v27
    v_and_b32 v151, s37, v27
    v_lshlrev_b32 v152, 16, v28
    v_and_b32 v153, s37, v28
    v_lshlrev_b32 v154, 16, v29
    v_and_b32 v155, s37, v29
    v_lshlrev_b32 v156, 16, v30
    v_and_b32 v157, s37, v30
    v_lshlrev_b32 v158, 16, v31
    v_and_b32 v159, s37, v31
    ds_read_b64 v[24:25], v62 offset:256
    ds_read_b64 v[26:27], v62 offset:272
    ds_read_b64 v[28:29], v62 offset:288
    ds_read_b64 v[30:31], v62 offset:304
    s_waitcnt lgkmcnt(4)
    v_lshlrev_b32 v160, 16, v32
    v_and_b32 v161, s37, v32
    v_lshlrev_b32 v162, 16, v33
    v_and_b32 v163, s37, v33
    v_lshlrev_b32 v164, 16, v34
    v_and_b32 v165, s37, v34
    v_lshlrev_b32 v166, 16, v35
    v_and_b32 v167, s37, v35
    v_lshlrev_b32 v168, 16, v36
    v_and_b32 v169, s37, v36
    v_lshlrev_b32 v170, 16, v37
    v_and_b32 v171, s37, v37
    v_lshlrev_b32 v172, 16, v38
    v_and_b32 v173, s37, v38
    v_lshlrev_b32 v174, 16, v39
    v_and_b32 v175, s37, v39
    v_lshlrev_b32 v176, 16, v32
    v_and_b32 v177, s37, v32
    v_lshlrev_b32 v178, 16, v33
    v_and_b32 v179, s37, v33
    v_lshlrev_b32 v180, 16, v34
    v_and_b32 v181, s37, v34
    v_lshlrev_b32 v182, 16, v35
    v_and_b32 v183, s37, v35
    v_lshlrev_b32 v184, 16, v36
    v_and_b32 v185, s37, v36
    v_lshlrev_b32 v186, 16, v37
    v_and_b32 v187, s37, v37
    v_lshlrev_b32 v188, 16, v38
    v_and_b32 v189, s37, v38
    v_lshlrev_b32 v190, 16, v39
    v_and_b32 v191, s37, v39
    ds_read_b64 v[32:33], v62 offset:320
    ds_read_b64 v[34:35], v62 offset:336
    ds_read_b64 v[36:37], v62 offset:352
    ds_read_b64 v[38:39], v62 offset:368
    s_waitcnt lgkmcnt(4)
    v_lshlrev_b32 v192, 16, v24
    v_and_b32 v193, s37, v24
    v_lshlrev_b32 v194, 16, v25
    v_and_b32 v195, s37, v25
    v_lshlrev_b32 v196, 16, v26
    v_and_b32 v197, s37, v26
    v_lshlrev_b32 v198, 16, v27
    v_and_b32 v199, s37, v27
    v_lshlrev_b32 v200, 16, v28
    v_and_b32 v201, s37, v28
    v_lshlrev_b32 v202, 16, v29
    v_and_b32 v203, s37, v29
    v_lshlrev_b32 v204, 16, v30
    v_and_b32 v205, s37, v30
    v_lshlrev_b32 v206, 16, v31
    v_and_b32 v207, s37, v31
    v_lshlrev_b32 v208, 16, v24
    v_and_b32 v209, s37, v24
    v_lshlrev_b32 v210, 16, v25
    v_and_b32 v211, s37, v25
    v_lshlrev_b32 v212, 16, v26
    v_and_b32 v213, s37, v26
    v_lshlrev_b32 v214, 16, v27
    v_and_b32 v215, s37, v27
    v_lshlrev_b32 v216, 16, v28
    v_and_b32 v217, s37, v28
    v_lshlrev_b32 v218, 16, v29
    v_and_b32 v219, s37, v29
    v_lshlrev_b32 v220, 16, v30
    v_and_b32 v221, s37, v30
    v_lshlrev_b32 v222, 16, v31
    v_and_b32 v223, s37, v31
    ds_read_b64 v[24:25], v62 offset:384
    ds_read_b64 v[26:27], v62 offset:400
    ds_read_b64 v[28:29], v62 offset:416
    ds_read_b64 v[30:31], v62 offset:432
    s_waitcnt lgkmcnt(4)
    v_lshlrev_b32 v224, 16, v32
    v_and_b32 v225, s37, v32
    v_lshlrev_b32 v226, 16, v33
    v_and_b32 v227, s37, v33
    v_lshlrev_b32 v228, 16, v34
    v_and_b32 v229, s37, v34
    v_lshlrev_b32 v230, 16, v35
    v_and_b32 v231, s37, v35
    v_lshlrev_b32 v232, 16, v36
    v_and_b32 v233, s37, v36
    v_lshlrev_b32 v234, 16, v37
    v_and_b32 v235, s37, v37
    v_lshlrev_b32 v236, 16, v38
    v_and_b32 v237, s37, v38
    v_lshlrev_b32 v238, 16, v39
    v_and_b32 v239, s37, v39
    v_lshlrev_b32 v240, 16, v32
    v_and_b32 v241, s37, v32
    v_lshlrev_b32 v242, 16, v33
    v_and_b32 v243, s37, v33
    v_lshlrev_b32 v244, 16, v34
    v_and_b32 v245, s37, v34
    v_lshlrev_b32 v246, 16, v35
    v_and_b32 v247, s37, v35
    v_lshlrev_b32 v248, 16, v36
    v_and_b32 v249, s37, v36
    v_lshlrev_b32 v250, 16, v37
    v_and_b32 v251, s37, v37
    v_lshlrev_b32 v252, 16, v38
    v_and_b32 v253, s37, v38
    v_lshlrev_b32 v254, 16, v39
    v_and_b32 v255, s37, v39
    s_waitcnt lgkmcnt(0)
    v_lshlrev_b32 v16, 16, v24
    v_and_b32 v17, s37, v24
    v_accvgpr_write_b32 a96, v16
    v_accvgpr_write_b32 a97, v17
    v_lshlrev_b32 v16, 16, v25
    v_and_b32 v17, s37, v25
    v_accvgpr_write_b32 a98, v16
    v_accvgpr_write_b32 a99, v17
    v_lshlrev_b32 v16, 16, v26
    v_and_b32 v17, s37, v26
    v_accvgpr_write_b32 a100, v16
    v_accvgpr_write_b32 a101, v17
    v_lshlrev_b32 v16, 16, v27
    v_and_b32 v17, s37, v27
    v_accvgpr_write_b32 a102, v16
    v_accvgpr_write_b32 a103, v17
    v_lshlrev_b32 v16, 16, v28
    v_and_b32 v17, s37, v28
    v_accvgpr_write_b32 a104, v16
    v_accvgpr_write_b32 a105, v17
    v_lshlrev_b32 v16, 16, v29
    v_and_b32 v17, s37, v29
    v_accvgpr_write_b32 a106, v16
    v_accvgpr_write_b32 a107, v17
    v_lshlrev_b32 v16, 16, v30
    v_and_b32 v17, s37, v30
    v_accvgpr_write_b32 a108, v16
    v_accvgpr_write_b32 a109, v17
    v_lshlrev_b32 v16, 16, v31
    v_and_b32 v17, s37, v31
    v_accvgpr_write_b32 a110, v16
    v_accvgpr_write_b32 a111, v17
    v_lshlrev_b32 v16, 16, v24
    v_and_b32 v17, s37, v24
    v_accvgpr_write_b32 a112, v16
    v_accvgpr_write_b32 a113, v17
    v_lshlrev_b32 v16, 16, v25
    v_and_b32 v17, s37, v25
    v_accvgpr_write_b32 a114, v16
    v_accvgpr_write_b32 a115, v17
    v_lshlrev_b32 v16, 16, v26
    v_and_b32 v17, s37, v26
    v_accvgpr_write_b32 a116, v16
    v_accvgpr_write_b32 a117, v17
    v_lshlrev_b32 v16, 16, v27
    v_and_b32 v17, s37, v27
    v_accvgpr_write_b32 a118, v16
    v_accvgpr_write_b32 a119, v17
    v_lshlrev_b32 v16, 16, v28
    v_and_b32 v17, s37, v28
    v_accvgpr_write_b32 a120, v16
    v_accvgpr_write_b32 a121, v17
    v_lshlrev_b32 v16, 16, v29
    v_and_b32 v17, s37, v29
    v_accvgpr_write_b32 a122, v16
    v_accvgpr_write_b32 a123, v17
    v_lshlrev_b32 v16, 16, v30
    v_and_b32 v17, s37, v30
    v_accvgpr_write_b32 a124, v16
    v_accvgpr_write_b32 a125, v17
    v_lshlrev_b32 v16, 16, v31
    v_and_b32 v17, s37, v31
    v_accvgpr_write_b32 a126, v16
    v_accvgpr_write_b32 a127, v17
    s_cmp_lg_u32 s33, 0
    s_cbranch_scc1 g1_h_rdy
g1_h_poll:
    s_add_u32 s43, s43, 1
    s_cmp_ge_u32 s43, 0x8000
    s_cbranch_scc1 g1_h_rdy
    buffer_load_dword v40, v23, s[64:67], 0 offen sc1
    s_waitcnt vmcnt(0)
    v_cmp_ne_u32 vcc, v21, v40
    s_cbranch_vccz g1_h_rdy
    s_branch g1_h_poll
g1_h_rdy:
    s_barrier
    buffer_load_dwordx4 a[0:3], v2, s[12:15], s25 offen offset:0
    buffer_load_dwordx4 a[4:7], v2, s[16:19], s25 offen offset:0
    buffer_load_dwordx4 a[8:11], v2, s[12:15], s25 offen offset:1024
    buffer_load_dwordx4 a[12:15], v2, s[16:19], s25 offen offset:1024
    buffer_load_dwordx4 a[16:19], v2, s[12:15], s25 offen offset:2048
    buffer_load_dwordx4 a[20:23], v2, s[16:19], s25 offen offset:2048
    buffer_load_dwordx4 a[24:27], v2, s[12:15], s25 offen offset:3072
    buffer_load_dwordx4 a[28:31], v2, s[16:19], s25 offen offset:3072
    s_add_u32 s25, s25, 4096
    buffer_load_dwordx4 a[32:35], v2, s[12:15], s25 offen offset:0
    buffer_load_dwordx4 a[36:39], v2, s[16:19], s25 offen offset:0
    buffer_load_dwordx4 a[40:43], v2, s[12:15], s25 offen offset:1024
    buffer_load_dwordx4 a[44:47], v2, s[16:19], s25 offen offset:1024
    buffer_load_dwordx4 a[48:51], v2, s[12:15], s25 offen offset:2048
    buffer_load_dwordx4 a[52:55], v2, s[16:19], s25 offen offset:2048
    ds_read_b64_tr_b16 a[64:65], v5 offset:0
    ds_read_b64_tr_b16 a[66:67], v5 offset:512
    ds_read_b64_tr_b16 a[68:69], v5 offset:256
    ds_read_b64_tr_b16 a[70:71], v5 offset:768
    ds_read_b64_tr_b16 a[72:73], v5 offset:1024
    ds_read_b64_tr_b16 a[74:75], v5 offset:1536
    ds_read_b64_tr_b16 a[76:77], v5 offset:1280
    ds_read_b64_tr_b16 a[78:79], v5 offset:1792
    ds_read_b64_tr_b16 a[80:81], v5 offset:2048
    ds_read_b64_tr_b16 a[82:83], v5 offset:2560
    ds_read_b64_tr_b16 a[84:85], v5 offset:2304
    ds_read_b64_tr_b16 a[86:87], v5 offset:2816
    ds_read_b64_tr_b16 a[88:89], v60 offset:6144
    ds_read_b64_tr_b16 a[90:91], v60 offset:6400
    s_waitcnt vmcnt(10)
    s_add_u32 s60, s28, 0x1400000
    s_addc_u32 s61, s29, 0
    s_mov_b32 s62, 0x1200000
    s_mov_b32 s63, 0x20000
    s_mul_i32 s71, s36, 294912
    s_add_u32 s71, s71, 0x10000
    s_lshl_b32 s70, s41, 6
    s_add_u32 s72, s71, s70
    s_lshl_b32 s70, s30, 6
    s_add_u32 s71, s71, s70
    v_mov_b32 v14, v60
    v_mov_b32 v15, v61
    v_mov_b32 v8, 0xc0135761
    v_mov_b32 v9, 0xc0135761
    v_mov_b32 v10, 0xbdd2d3e8
    v_mov_b32 v11, 0xbdd2d3e8
    v_mov_b32 v12, 0x3f800000
    v_mov_b32 v13, 0x3f800000
    s_mov_b32 s26, 0
g1_h_loop:
    s_waitcnt vmcnt(24)
    s_waitcnt lgkmcnt(12)
    v_mfma_f32_32x32x16_bf16 v[64:79], a[64:67], a[0:3], v[64:79]
    v_mfma_f32_32x32x16_bf16 v[80:95], a[64:67], a[4:7], v[80:95]
    ds_read_b64_tr_b16 a[64:65], v5 offset:7168
    ds_read_b64_tr_b16 a[66:67], v5 offset:7680
    s_waitcnt lgkmcnt(12)
    v_mfma_f32_32x32x16_bf16 v[96:111], a[68:71], a[0:3], v[96:111]
    v_mfma_f32_32x32x16_bf16 v[112:127], a[68:71], a[4:7], v[112:127]
    ds_read_b64_tr_b16 a[68:69], v5 offset:7424
    ds_read_b64_tr_b16 a[70:71], v5 offset:7936
    buffer_load_dwordx4 a[56:59], v2, s[12:15], s25 offen offset:3072
    buffer_load_dwordx4 a[60:63], v2, s[16:19], s25 offen offset:3072
    s_add_u32 s25, s25, 4096
    s_waitcnt lgkmcnt(12)
    v_mfma_f32_32x32x16_bf16 v[128:143], a[72:75], a[0:3], v[128:143]
    v_mfma_f32_32x32x16_bf16 v[144:159], a[72:75], a[4:7], v[144:159]
    ds_read_b64_tr_b16 a[72:73], v5 offset:8192
    ds_read_b64_tr_b16 a[74:75], v5 offset:8704
    s_add_u32 m0, s38, 60416
    s_nop 0
    buffer_load_dwordx4 v4, s[8:11], s24 offen offset:0 lds
    s_waitcnt lgkmcnt(12)
    v_mfma_f32_32x32x16_bf16 v[160:175], a[76:79], a[0:3], v[160:175]
    v_mfma_f32_32x32x16_bf16 v[176:191], a[76:79], a[4:7], v[176:191]
    ds_read_b64_tr_b16 a[76:77], v5 offset:8448
    ds_read_b64_tr_b16 a[78:79], v5 offset:8960
    s_add_u32 m0, s38, 61312
    s_nop 0
    buffer_load_dwordx4 v4, s[8:11], s24 offen offset:128 lds
    s_waitcnt lgkmcnt(12)
    v_mfma_f32_32x32x16_bf16 v[192:207], a[80:83], a[0:3], v[192:207]
    v_mfma_f32_32x32x16_bf16 v[208:223], a[80:83], a[4:7], v[208:223]
    ds_read_b64_tr_b16 a[80:81], v5 offset:9216
    ds_read_b64_tr_b16 a[82:83], v5 offset:9728
    s_add_u32 m0, s38, 62208
    s_nop 0
    buffer_load_dwordx4 v4, s[8:11], s24 offen offset:256 lds
    s_waitcnt lgkmcnt(12)
    v_mfma_f32_32x32x16_bf16 v[224:239], a[84:87], a[0:3], v[224:239]
    v_mfma_f32_32x32x16_bf16 v[240:255], a[84:87], a[4:7], v[240:255]
    ds_read_b64_tr_b16 a[84:85], v5 offset:9472
    ds_read_b64_tr_b16 a[86:87], v5 offset:9984
    s_add_u32 m0, s38, 63488
    s_nop 0
    buffer_load_dwordx4 v6, s[8:11], s24 offen lds
    s_add_u32 s24, s24, 458752
    s_waitcnt lgkmcnt(12)
    v_mfma_f32_32x32x16_bf16 a[96:111], a[88:91], a[0:3], a[96:111]
    v_mfma_f32_32x32x16_bf16 a[112:127], a[88:91], a[4:7], a[112:127]
    ds_read_b64_tr_b16 a[88:89], v60 offset:13312
    ds_read_b64_tr_b16 a[90:91], v60 offset:13568
    s_waitcnt vmcnt(27)
    s_waitcnt lgkmcnt(12)
    v_mfma_f32_32x32x16_bf16 v[64:79], a[64:67], a[8:11], v[64:79]
    v_mfma_f32_32x32x16_bf16 v[80:95], a[64:67], a[12:15], v[80:95]
    ds_read_b64_tr_b16 a[64:65], v5 offset:14336
    ds_read_b64_tr_b16 a[66:67], v5 offset:14848
    s_waitcnt lgkmcnt(12)
    v_mfma_f32_32x32x16_bf16 v[96:111], a[68:71], a[8:11], v[96:111]
    v_mfma_f32_32x32x16_bf16 v[112:127], a[68:71], a[12:15], v[112:127]
    ds_read_b64_tr_b16 a[68:69], v5 offset:14592
    ds_read_b64_tr_b16 a[70:71], v5 offset:15104
    buffer_load_dwordx4 a[0:3], v2, s[12:15], s25 offen offset:0
    buffer_load_dwordx4 a[4:7], v2, s[16:19], s25 offen offset:0
    s_waitcnt lgkmcnt(12)
    v_mfma_f32_32x32x16_bf16 v[128:143], a[72:75], a[8:11], v[128:143]
    v_mfma_f32_32x32x16_bf16 v[144:159], a[72:75], a[12:15], v[144:159]
    ds_read_b64_tr_b16 a[72:73], v5 offset:15360
    ds_read_b64_tr_b16 a[74:75], v5 offset:15872
    buffer_load_dword v45, v44, s[8:11], s24 offen
    s_waitcnt lgkmcnt(12)
    v_mfma_f32_32x32x16_bf16 v[160:175], a[76:79], a[8:11], v[160:175]
    v_mfma_f32_32x32x16_bf16 v[176:191], a[76:79], a[12:15], v[176:191]
    ds_read_b64_tr_b16 a[76:77], v5 offset:15616
    ds_read_b64_tr_b16 a[78:79], v5 offset:16128
    s_waitcnt lgkmcnt(12)
    v_mfma_f32_32x32x16_bf16 v[192:207], a[80:83], a[8:11], v[192:207]
    v_mfma_f32_32x32x16_bf16 v[208:223], a[80:83], a[12:15], v[208:223]
    ds_read_b64_tr_b16 a[80:81], v5 offset:16384
    ds_read_b64_tr_b16 a[82:83], v5 offset:16896
    s_waitcnt lgkmcnt(12)
    v_mfma_f32_32x32x16_bf16 v[224:239], a[84:87], a[8:11], v[224:239]
    v_mfma_f32_32x32x16_bf16 v[240:255], a[84:87], a[12:15], v[240:255]
    ds_read_b64_tr_b16 a[84:85], v5 offset:16640
    ds_read_b64_tr_b16 a[86:87], v5 offset:17152
    s_waitcnt lgkmcnt(12)
    v_mfma_f32_32x32x16_bf16 a[96:111], a[88:91], a[8:11], a[96:111]
    v_mfma_f32_32x32x16_bf16 a[112:127], a[88:91], a[12:15], a[112:127]
    ds_read_b64_tr_b16 a[88:89], v60 offset:20480
    ds_read_b64_tr_b16 a[90:91], v60 offset:20736
    s_waitcnt vmcnt(17)
    s_waitcnt lgkmcnt(12)
    v_mfma_f32_32x32x16_bf16 v[64:79], a[64:67], a[16:19], v[64:79]
    v_mfma_f32_32x32x16_bf16 v[80:95], a[64:67], a[20:23], v[80:95]
    ds_read_b64_tr_b16 a[64:65], v5 offset:21504
    ds_read_b64_tr_b16 a[66:67], v5 offset:22016
    s_waitcnt lgkmcnt(12)
    v_mfma_f32_32x32x16_bf16 v[96:111], a[68:71], a[16:19], v[96:111]
    v_mfma_f32_32x32x16_bf16 v[112:127], a[68:71], a[20:23], v[112:127]
    ds_read_b64_tr_b16 a[68:69], v5 offset:21760
    ds_read_b64_tr_b16 a[70:71], v5 offset:22272
    buffer_load_dwordx4 a[8:11], v2, s[12:15], s25 offen offset:1024
    buffer_load_dwordx4 a[12:15], v2, s[16:19], s25 offen offset:1024
    s_waitcnt lgkmcnt(12)
    v_mfma_f32_32x32x16_bf16 v[128:143], a[72:75], a[16:19], v[128:143]
    v_mfma_f32_32x32x16_bf16 v[144:159], a[72:75], a[20:23], v[144:159]
    ds_read_b64_tr_b16 a[72:73], v5 offset:22528
    ds_read_b64_tr_b16 a[74:75], v5 offset:23040
    s_waitcnt lgkmcnt(12)
    v_mfma_f32_32x32x16_bf16 v[160:175], a[76:79], a[16:19], v[160:175]
    v_mfma_f32_32x32x16_bf16 v[176:191], a[76:79], a[20:23], v[176:191]
    ds_read_b64_tr_b16 a[76:77], v5 offset:22784
    ds_read_b64_tr_b16 a[78:79], v5 offset:23296
    s_waitcnt lgkmcnt(12)
    v_mfma_f32_32x32x16_bf16 v[192:207], a[80:83], a[16:19], v[192:207]
    v_mfma_f32_32x32x16_bf16 v[208:223], a[80:83], a[20:23], v[208:223]
    ds_read_b64_tr_b16 a[80:81], v5 offset:23552
    ds_read_b64_tr_b16 a[82:83], v5 offset:24064
    s_waitcnt lgkmcnt(12)
    v_mfma_f32_32x32x16_bf16 v[224:239], a[84:87], a[16:19], v[224:239]
    v_mfma_f32_32x32x16_bf16 v[240:255], a[84:87], a[20:23], v[240:255]
    ds_read_b64_tr_b16 a[84:85], v5 offset:23808
    ds_read_b64_tr_b16 a[86:87], v5 offset:24320
    s_waitcnt lgkmcnt(12)
    v_mfma_f32_32x32x16_bf16 a[96:111], a[88:91], a[16:19], a[96:111]
    v_mfma_f32_32x32x16_bf16 a[112:127], a[88:91], a[20:23], a[112:127]
    ds_read_b64_tr_b16 a[88:89], v60 offset:27648
    ds_read_b64_tr_b16 a[90:91], v60 offset:27904
    s_waitcnt vmcnt(17)
    s_waitcnt lgkmcnt(12)
    v_mfma_f32_32x32x16_bf16 v[64:79], a[64:67], a[24:27], v[64:79]
    v_mfma_f32_32x32x16_bf16 v[80:95], a[64:67], a[28:31], v[80:95]
    s_waitcnt vmcnt(21)
    s_barrier
    ds_read_b64_tr_b16 a[64:65], v5 offset:28672
    ds_read_b64_tr_b16 a[66:67], v5 offset:29184
    s_waitcnt lgkmcnt(12)
    v_mfma_f32_32x32x16_bf16 v[96:111], a[68:71], a[24:27], v[96:111]
    v_mfma_f32_32x32x16_bf16 v[112:127], a[68:71], a[28:31], v[112:127]
    ds_read_b64_tr_b16 a[68:69], v5 offset:28928
    ds_read_b64_tr_b16 a[70:71], v5 offset:29440
    buffer_load_dwordx4 a[16:19], v2, s[12:15], s25 offen offset:2048
    buffer_load_dwordx4 a[20:23], v2, s[16:19], s25 offen offset:2048
    s_waitcnt lgkmcnt(12)
    v_mfma_f32_32x32x16_bf16 v[128:143], a[72:75], a[24:27], v[128:143]
    v_mfma_f32_32x32x16_bf16 v[144:159], a[72:75], a[28:31], v[144:159]
    ds_read_b64_tr_b16 a[72:73], v5 offset:29696
    ds_read_b64_tr_b16 a[74:75], v5 offset:30208
    s_add_u32 m0, s38, 86016
    s_nop 0
    buffer_load_dwordx4 v3, s[8:11], s24 offen offset:0 lds
    s_waitcnt lgkmcnt(12)
    v_mfma_f32_32x32x16_bf16 v[160:175], a[76:79], a[24:27], v[160:175]
    v_mfma_f32_32x32x16_bf16 v[176:191], a[76:79], a[28:31], v[176:191]
    ds_read_b64_tr_b16 a[76:77], v5 offset:29952
    ds_read_b64_tr_b16 a[78:79], v5 offset:30464
    s_add_u32 m0, s38, 86912
    s_nop 0
    buffer_load_dwordx4 v3, s[8:11], s24 offen offset:128 lds
    s_waitcnt lgkmcnt(12)
    v_mfma_f32_32x32x16_bf16 v[192:207], a[80:83], a[24:27], v[192:207]
    v_mfma_f32_32x32x16_bf16 v[208:223], a[80:83], a[28:31], v[208:223]
    ds_read_b64_tr_b16 a[80:81], v5 offset:30720
    ds_read_b64_tr_b16 a[82:83], v5 offset:31232
    s_add_u32 m0, s38, 87808
    s_nop 0
    buffer_load_dwordx4 v3, s[8:11], s24 offen offset:256 lds
    s_waitcnt lgkmcnt(12)
    v_mfma_f32_32x32x16_bf16 v[224:239], a[84:87], a[24:27], v[224:239]
    v_mfma_f32_32x32x16_bf16 v[240:255], a[84:87], a[28:31], v[240:255]
    ds_read_b64_tr_b16 a[84:85], v5 offset:30976
    ds_read_b64_tr_b16 a[86:87], v5 offset:31488
    s_waitcnt lgkmcnt(12)
    v_mfma_f32_32x32x16_bf16 a[96:111], a[88:91], a[24:27], a[96:111]
    v_mfma_f32_32x32x16_bf16 a[112:127], a[88:91], a[28:31], a[112:127]
    ds_read_b64_tr_b16 a[88:89], v60 offset:34816
    ds_read_b64_tr_b16 a[90:91], v60 offset:35072
    s_waitcnt vmcnt(20)
    s_waitcnt lgkmcnt(12)
    v_mfma_f32_32x32x16_bf16 v[64:79], a[64:67], a[32:35], v[64:79]
    v_mfma_f32_32x32x16_bf16 v[80:95], a[64:67], a[36:39], v[80:95]
    ds_read_b64_tr_b16 a[64:65], v5 offset:35840
    ds_read_b64_tr_b16 a[66:67], v5 offset:36352
    s_waitcnt lgkmcnt(12)
    v_mfma_f32_32x32x16_bf16 v[96:111], a[68:71], a[32:35], v[96:111]
    v_mfma_f32_32x32x16_bf16 v[112:127], a[68:71], a[36:39], v[112:127]
    ds_read_b64_tr_b16 a[68:69], v5 offset:36096
    ds_read_b64_tr_b16 a[70:71], v5 offset:36608
    buffer_load_dwordx4 a[24:27], v2, s[12:15], s25 offen offset:3072
    buffer_load_dwordx4 a[28:31], v2, s[16:19], s25 offen offset:3072
    s_add_u32 s25, s25, 4096
    s_waitcnt lgkmcnt(12)
    v_mfma_f32_32x32x16_bf16 v[128:143], a[72:75], a[32:35], v[128:143]
    v_mfma_f32_32x32x16_bf16 v[144:159], a[72:75], a[36:39], v[144:159]
    ds_read_b64_tr_b16 a[72:73], v5 offset:36864
    ds_read_b64_tr_b16 a[74:75], v5 offset:37376
    s_add_u32 m0, s38, 89088
    s_nop 0
    buffer_load_dwordx4 v4, s[8:11], s24 offen offset:0 lds
    s_waitcnt lgkmcnt(12)
    v_mfma_f32_32x32x16_bf16 v[160:175], a[76:79], a[32:35], v[160:175]
    v_mfma_f32_32x32x16_bf16 v[176:191], a[76:79], a[36:39], v[176:191]
    ds_read_b64_tr_b16 a[76:77], v5 offset:37120
    ds_read_b64_tr_b16 a[78:79], v5 offset:37632
    s_add_u32 m0, s38, 89984
    s_nop 0
    buffer_load_dwordx4 v4, s[8:11], s24 offen offset:128 lds
    s_waitcnt lgkmcnt(12)
    v_mfma_f32_32x32x16_bf16 v[192:207], a[80:83], a[32:35], v[192:207]
    v_mfma_f32_32x32x16_bf16 v[208:223], a[80:83], a[36:39], v[208:223]
    ds_read_b64_tr_b16 a[80:81], v5 offset:37888
    ds_read_b64_tr_b16 a[82:83], v5 offset:38400
    s_add_u32 m0, s38, 90880
    s_nop 0
    buffer_load_dwordx4 v4, s[8:11], s24 offen offset:256 lds
    s_waitcnt lgkmcnt(12)
    v_mfma_f32_32x32x16_bf16 v[224:239], a[84:87], a[32:35], v[224:239]
    v_mfma_f32_32x32x16_bf16 v[240:255], a[84:87], a[36:39], v[240:255]
    ds_read_b64_tr_b16 a[84:85], v5 offset:38144
    ds_read_b64_tr_b16 a[86:87], v5 offset:38656
    s_add_u32 m0, s38, 92160
    s_nop 0
    buffer_load_dwordx4 v6, s[8:11], s24 offen lds
    s_add_u32 s24, s24, 458752
    s_waitcnt lgkmcnt(12)
    v_mfma_f32_32x32x16_bf16 a[96:111], a[88:91], a[32:35], a[96:111]
    v_mfma_f32_32x32x16_bf16 a[112:127], a[88:91], a[36:39], a[112:127]
    ds_read_b64_tr_b16 a[88:89], v60 offset:41984
    ds_read_b64_tr_b16 a[90:91], v60 offset:42240
    s_waitcnt vmcnt(24)
    s_waitcnt lgkmcnt(12)
    v_mfma_f32_32x32x16_bf16 v[64:79], a[64:67], a[40:43], v[64:79]
    v_mfma_f32_32x32x16_bf16 v[80:95], a[64:67], a[44:47], v[80:95]
    ds_read_b64_tr_b16 a[64:65], v5 offset:43008
    ds_read_b64_tr_b16 a[66:67], v5 offset:43520
    s_waitcnt lgkmcnt(12)
    v_mfma_f32_32x32x16_bf16 v[96:111], a[68:71], a[40:43], v[96:111]
    v_mfma_f32_32x32x16_bf16 v[112:127], a[68:71], a[44:47], v[112:127]
    ds_read_b64_tr_b16 a[68:69], v5 offset:43264
    ds_read_b64_tr_b16 a[70:71], v5 offset:43776
    buffer_load_dwordx4 a[32:35], v2, s[12:15], s25 offen offset:0
    buffer_load_dwordx4 a[36:39], v2, s[16:19], s25 offen offset:0
    s_waitcnt lgkmcnt(12)
    v_mfma_f32_32x32x16_bf16 v[128:143], a[72:75], a[40:43], v[128:143]
    v_mfma_f32_32x32x16_bf16 v[144:159], a[72:75], a[44:47], v[144:159]
    ds_read_b64_tr_b16 a[72:73], v5 offset:44032
    ds_read_b64_tr_b16 a[74:75], v5 offset:44544
    buffer_load_dword v45, v44, s[8:11], s24 offen
    s_waitcnt lgkmcnt(12)
    v_mfma_f32_32x32x16_bf16 v[160:175], a[76:79], a[40:43], v[160:175]
    v_mfma_f32_32x32x16_bf16 v[176:191], a[76:79], a[44:47], v[176:191]
    ds_read_b64_tr_b16 a[76:77], v5 offset:44288
    ds_read_b64_tr_b16 a[78:79], v5 offset:44800
    s_waitcnt lgkmcnt(12)
    v_mfma_f32_32x32x16_bf16 v[192:207], a[80:83], a[40:43], v[192:207]
    v_mfma_f32_32x32x16_bf16 v[208:223], a[80:83], a[44:47], v[208:223]
    ds_read_b64_tr_b16 a[80:81], v5 offset:45056
    ds_read_b64_tr_b16 a[82:83], v5 offset:45568
    s_waitcnt lgkmcnt(12)
    v_mfma_f32_32x32x16_bf16 v[224:239], a[84:87], a[40:43], v[224:239]
    v_mfma_f32_32x32x16_bf16 v[240:255], a[84:87], a[44:47], v[240:255]
    ds_read_b64_tr_b16 a[84:85], v5 offset:45312
    ds_read_b64_tr_b16 a[86:87], v5 offset:45824
    s_waitcnt lgkmcnt(12)
    v_mfma_f32_32x32x16_bf16 a[96:111], a[88:91], a[40:43], a[96:111]
    v_mfma_f32_32x32x16_bf16 a[112:127], a[88:91], a[44:47], a[112:127]
    ds_read_b64_tr_b16 a[88:89], v60 offset:49152
    ds_read_b64_tr_b16 a[90:91], v60 offset:49408
    s_waitcnt vmcnt(25)
    s_waitcnt lgkmcnt(12)
    v_mfma_f32_32x32x16_bf16 v[64:79], a[64:67], a[48:51], v[64:79]
    v_mfma_f32_32x32x16_bf16 v[80:95], a[64:67], a[52:55], v[80:95]
    ds_read_b64_tr_b16 a[64:65], v5 offset:50176
    ds_read_b64_tr_b16 a[66:67], v5 offset:50688
    s_waitcnt lgkmcnt(12)
    v_mfma_f32_32x32x16_bf16 v[96:111], a[68:71], a[48:51], v[96:111]
    v_mfma_f32_32x32x16_bf16 v[112:127], a[68:71], a[52:55], v[112:127]
    ds_read_b64_tr_b16 a[68:69], v5 offset:50432
    ds_read_b64_tr_b16 a[70:71], v5 offset:50944
    buffer_load_dwordx4 a[40:43], v2, s[12:15], s25 offen offset:1024
    buffer_load_dwordx4 a[44:47], v2, s[16:19], s25 offen offset:1024
    s_waitcnt lgkmcnt(12)
    v_mfma_f32_32x32x16_bf16 v[128:143], a[72:75], a[48:51], v[128:143]
    v_mfma_f32_32x32x16_bf16 v[144:159], a[72:75], a[52:55], v[144:159]
    ds_read_b64_tr_b16 a[72:73], v5 offset:51200
    ds_read_b64_tr_b16 a[74:75], v5 offset:51712
    s_waitcnt lgkmcnt(12)
    v_mfma_f32_32x32x16_bf16 v[160:175], a[76:79], a[48:51], v[160:175]
    v_mfma_f32_32x32x16_bf16 v[176:191], a[76:79], a[52:55], v[176:191]
    ds_read_b64_tr_b16 a[76:77], v5 offset:51456
    ds_read_b64_tr_b16 a[78:79], v5 offset:51968
    s_waitcnt lgkmcnt(12)
    v_mfma_f32_32x32x16_bf16 v[192:207], a[80:83], a[48:51], v[192:207]
    v_mfma_f32_32x32x16_bf16 v[208:223], a[80:83], a[52:55], v[208:223]
    ds_read_b64_tr_b16 a[80:81], v5 offset:52224
    ds_read_b64_tr_b16 a[82:83], v5 offset:52736
    s_waitcnt lgkmcnt(12)
    v_mfma_f32_32x32x16_bf16 v[224:239], a[84:87], a[48:51], v[224:239]
    v_mfma_f32_32x32x16_bf16 v[240:255], a[84:87], a[52:55], v[240:255]
    ds_read_b64_tr_b16 a[84:85], v5 offset:52480
    ds_read_b64_tr_b16 a[86:87], v5 offset:52992
    s_waitcnt lgkmcnt(12)
    v_mfma_f32_32x32x16_bf16 a[96:111], a[88:91], a[48:51], a[96:111]
    v_mfma_f32_32x32x16_bf16 a[112:127], a[88:91], a[52:55], a[112:127]
    ds_read_b64_tr_b16 a[88:89], v60 offset:56320
    ds_read_b64_tr_b16 a[90:91], v60 offset:56576
    s_waitcnt vmcnt(25)
    s_waitcnt lgkmcnt(12)
    v_mfma_f32_32x32x16_bf16 v[64:79], a[64:67], a[56:59], v[64:79]
    v_mfma_f32_32x32x16_bf16 v[80:95], a[64:67], a[60:63], v[80:95]
    s_waitcnt vmcnt(21)
    s_barrier
    ds_read_b64_tr_b16 a[64:65], v7 offset:0
    ds_read_b64_tr_b16 a[66:67], v7 offset:512
    s_waitcnt lgkmcnt(12)
    v_mfma_f32_32x32x16_bf16 v[96:111], a[68:71], a[56:59], v[96:111]
    v_mfma_f32_32x32x16_bf16 v[112:127], a[68:71], a[60:63], v[112:127]
    ds_read_b64_tr_b16 a[68:69], v7 offset:256
    ds_read_b64_tr_b16 a[70:71], v7 offset:768
    buffer_load_dwordx4 a[48:51], v2, s[12:15], s25 offen offset:2048
    buffer_load_dwordx4 a[52:55], v2, s[16:19], s25 offen offset:2048
    s_waitcnt lgkmcnt(12)
    v_mfma_f32_32x32x16_bf16 v[128:143], a[72:75], a[56:59], v[128:143]
    v_mfma_f32_32x32x16_bf16 v[144:159], a[72:75], a[60:63], v[144:159]
    ds_read_b64_tr_b16 a[72:73], v7 offset:1024
    ds_read_b64_tr_b16 a[74:75], v7 offset:1536
    s_add_u32 m0, s38, 0
    s_nop 0
    buffer_load_dwordx4 v3, s[8:11], s24 offen offset:0 lds
    s_waitcnt lgkmcnt(12)
    v_mfma_f32_32x32x16_bf16 v[160:175], a[76:79], a[56:59], v[160:175]
    v_mfma_f32_32x32x16_bf16 v[176:191], a[76:79], a[60:63], v[176:191]
    ds_read_b64_tr_b16 a[76:77], v7 offset:1280
    ds_read_b64_tr_b16 a[78:79], v7 offset:1792
    s_add_u32 m0, s38, 896
    s_nop 0
    buffer_load_dwordx4 v3, s[8:11], s24 offen offset:128 lds
    s_waitcnt lgkmcnt(12)
    v_mfma_f32_32x32x16_bf16 v[192:207], a[80:83], a[56:59], v[192:207]
    v_mfma_f32_32x32x16_bf16 v[208:223], a[80:83], a[60:63], v[208:223]
    ds_read_b64_tr_b16 a[80:81], v7 offset:2048
    ds_read_b64_tr_b16 a[82:83], v7 offset:2560
    s_add_u32 m0, s38, 1792
    s_nop 0
    buffer_load_dwordx4 v3, s[8:11], s24 offen offset:256 lds
    s_waitcnt lgkmcnt(12)
    v_mfma_f32_32x32x16_bf16 v[224:239], a[84:87], a[56:59], v[224:239]
    v_mfma_f32_32x32x16_bf16 v[240:255], a[84:87], a[60:63], v[240:255]
    ds_read_b64_tr_b16 a[84:85], v7 offset:2304
    ds_read_b64_tr_b16 a[86:87], v7 offset:2816
    s_waitcnt lgkmcnt(12)
    v_mfma_f32_32x32x16_bf16 a[96:111], a[88:91], a[56:59], a[96:111]
    v_mfma_f32_32x32x16_bf16 a[112:127], a[88:91], a[60:63], a[112:127]
    ds_read_b64_tr_b16 a[88:89], v61 offset:6144
    ds_read_b64_tr_b16 a[90:91], v61 offset:6400
    s_waitcnt vmcnt(24)
    s_waitcnt lgkmcnt(12)
    v_mfma_f32_32x32x16_bf16 v[64:79], a[64:67], a[0:3], v[64:79]
    v_mfma_f32_32x32x16_bf16 v[80:95], a[64:67], a[4:7], v[80:95]
    ds_read_b64_tr_b16 a[64:65], v7 offset:7168
    ds_read_b64_tr_b16 a[66:67], v7 offset:7680
    s_waitcnt lgkmcnt(12)
    v_mfma_f32_32x32x16_bf16 v[96:111], a[68:71], a[0:3], v[96:111]
    v_mfma_f32_32x32x16_bf16 v[112:127], a[68:71], a[4:7], v[112:127]
    ds_read_b64_tr_b16 a[68:69], v7 offset:7424
    ds_read_b64_tr_b16 a[70:71], v7 offset:7936
    buffer_load_dwordx4 a[56:59], v2, s[12:15], s25 offen offset:3072
    buffer_load_dwordx4 a[60:63], v2, s[16:19], s25 offen offset:3072
    s_add_u32 s25, s25, 4096
    s_waitcnt lgkmcnt(12)
    v_mfma_f32_32x32x16_bf16 v[128:143], a[72:75], a[0:3], v[128:143]
    v_mfma_f32_32x32x16_bf16 v[144:159], a[72:75], a[4:7], v[144:159]
    ds_read_b64_tr_b16 a[72:73], v7 offset:8192
    ds_read_b64_tr_b16 a[74:75], v7 offset:8704
    s_add_u32 m0, s38, 3072
    s_nop 0
    buffer_load_dwordx4 v4, s[8:11], s24 offen offset:0 lds
    s_waitcnt lgkmcnt(12)
    v_mfma_f32_32x32x16_bf16 v[160:175], a[76:79], a[0:3], v[160:175]
    v_mfma_f32_32x32x16_bf16 v[176:191], a[76:79], a[4:7], v[176:191]
    ds_read_b64_tr_b16 a[76:77], v7 offset:8448
    ds_read_b64_tr_b16 a[78:79], v7 offset:8960
    s_add_u32 m0, s38, 3968
    s_nop 0
    buffer_load_dwordx4 v4, s[8:11], s24 offen offset:128 lds
    s_waitcnt lgkmcnt(12)
    v_mfma_f32_32x32x16_bf16 v[192:207], a[80:83], a[0:3], v[192:207]
    v_mfma_f32_32x32x16_bf16 v[208:223], a[80:83], a[4:7], v[208:223]
    ds_read_b64_tr_b16 a[80:81], v7 offset:9216
    ds_read_b64_tr_b16 a[82:83], v7 offset:9728
    s_add_u32 m0, s38, 4864
    s_nop 0
    buffer_load_dwordx4 v4, s[8:11], s24 offen offset:256 lds
    s_waitcnt lgkmcnt(12)
    v_mfma_f32_32x32x16_bf16 v[224:239], a[84:87], a[0:3], v[224:239]
    v_mfma_f32_32x32x16_bf16 v[240:255], a[84:87], a[4:7], v[240:255]
    ds_read_b64_tr_b16 a[84:85], v7 offset:9472
    ds_read_b64_tr_b16 a[86:87], v7 offset:9984
    s_add_u32 m0, s38, 6144
    s_nop 0
    buffer_load_dwordx4 v6, s[8:11], s24 offen lds
    s_add_u32 s24, s24, 458752
    s_waitcnt lgkmcnt(12)
    v_mfma_f32_32x32x16_bf16 a[96:111], a[88:91], a[0:3], a[96:111]
    v_mfma_f32_32x32x16_bf16 a[112:127], a[88:91], a[4:7], a[112:127]
    ds_read_b64_tr_b16 a[88:89], v61 offset:13312
    ds_read_b64_tr_b16 a[90:91], v61 offset:13568
    s_waitcnt vmcnt(27)
    s_waitcnt lgkmcnt(12)
    v_mfma_f32_32x32x16_bf16 v[64:79], a[64:67], a[8:11], v[64:79]
    v_mfma_f32_32x32x16_bf16 v[80:95], a[64:67], a[12:15], v[80:95]
    ds_read_b64_tr_b16 a[64:65], v7 offset:14336
    ds_read_b64_tr_b16 a[66:67], v7 offset:14848
    s_waitcnt lgkmcnt(12)
    v_mfma_f32_32x32x16_bf16 v[96:111], a[68:71], a[8:11], v[96:111]
    v_mfma_f32_32x32x16_bf16 v[112:127], a[68:71], a[12:15], v[112:127]
    ds_read_b64_tr_b16 a[68:69], v7 offset:14592
    ds_read_b64_tr_b16 a[70:71], v7 offset:15104
    buffer_load_dwordx4 a[0:3], v2, s[12:15], s25 offen offset:0
    buffer_load_dwordx4 a[4:7], v2, s[16:19], s25 offen offset:0
    s_waitcnt lgkmcnt(12)
    v_mfma_f32_32x32x16_bf16 v[128:143], a[72:75], a[8:11], v[128:143]
    v_mfma_f32_32x32x16_bf16 v[144:159], a[72:75], a[12:15], v[144:159]
    ds_read_b64_tr_b16 a[72:73], v7 offset:15360
    ds_read_b64_tr_b16 a[74:75], v7 offset:15872
    buffer_load_dword v45, v44, s[8:11], s24 offen
    s_waitcnt lgkmcnt(12)
    v_mfma_f32_32x32x16_bf16 v[160:175], a[76:79], a[8:11], v[160:175]
    v_mfma_f32_32x32x16_bf16 v[176:191], a[76:79], a[12:15], v[176:191]
    ds_read_b64_tr_b16 a[76:77], v7 offset:15616
    ds_read_b64_tr_b16 a[78:79], v7 offset:16128
    s_waitcnt lgkmcnt(12)
    v_mfma_f32_32x32x16_bf16 v[192:207], a[80:83], a[8:11], v[192:207]
    v_mfma_f32_32x32x16_bf16 v[208:223], a[80:83], a[12:15], v[208:223]
    ds_read_b64_tr_b16 a[80:81], v7 offset:16384
    ds_read_b64_tr_b16 a[82:83], v7 offset:16896
    s_waitcnt lgkmcnt(12)
    v_mfma_f32_32x32x16_bf16 v[224:239], a[84:87], a[8:11], v[224:239]
    v_mfma_f32_32x32x16_bf16 v[240:255], a[84:87], a[12:15], v[240:255]
    ds_read_b64_tr_b16 a[84:85], v7 offset:16640
    ds_read_b64_tr_b16 a[86:87], v7 offset:17152
    s_waitcnt lgkmcnt(12)
    v_mfma_f32_32x32x16_bf16 a[96:111], a[88:91], a[8:11], a[96:111]
    v_mfma_f32_32x32x16_bf16 a[112:127], a[88:91], a[12:15], a[112:127]
    ds_read_b64_tr_b16 a[88:89], v61 offset:20480
    ds_read_b64_tr_b16 a[90:91], v61 offset:20736
    s_waitcnt vmcnt(28)
    s_waitcnt lgkmcnt(12)
    v_mfma_f32_32x32x16_bf16 v[64:79], a[64:67], a[16:19], v[64:79]
    v_mfma_f32_32x32x16_bf16 v[80:95], a[64:67], a[20:23], v[80:95]
    ds_read_b64_tr_b16 a[64:65], v7 offset:21504
    ds_read_b64_tr_b16 a[66:67], v7 offset:22016
    s_waitcnt lgkmcnt(12)
    v_mfma_f32_32x32x16_bf16 v[96:111], a[68:71], a[16:19], v[96:111]
    v_mfma_f32_32x32x16_bf16 v[112:127], a[68:71], a[20:23], v[112:127]
    ds_read_b64_tr_b16 a[68:69], v7 offset:21760
    ds_read_b64_tr_b16 a[70:71], v7 offset:22272
    buffer_load_dwordx4 a[8:11], v2, s[12:15], s25 offen offset:1024
    buffer_load_dwordx4 a[12:15], v2, s[16:19], s25 offen offset:1024
    s_waitcnt lgkmcnt(12)
    v_mfma_f32_32x32x16_bf16 v[128:143], a[72:75], a[16:19], v[128:143]
    v_mfma_f32_32x32x16_bf16 v[144:159], a[72:75], a[20:23], v[144:159]
    ds_read_b64_tr_b16 a[72:73], v7 offset:22528
    ds_read_b64_tr_b16 a[74:75], v7 offset:23040
    s_waitcnt lgkmcnt(12)
    v_mfma_f32_32x32x16_bf16 v[160:175], a[76:79], a[16:19], v[160:175]
    v_mfma_f32_32x32x16_bf16 v[176:191], a[76:79], a[20:23], v[176:191]
    ds_read_b64_tr_b16 a[76:77], v7 offset:22784
    ds_read_b64_tr_b16 a[78:79], v7 offset:23296
    s_waitcnt lgkmcnt(12)
    v_mfma_f32_32x32x16_bf16 v[192:207], a[80:83], a[16:19], v[192:207]
    v_mfma_f32_32x32x16_bf16 v[208:223], a[80:83], a[20:23], v[208:223]
    ds_read_b64_tr_b16 a[80:81], v7 offset:23552
    ds_read_b64_tr_b16 a[82:83], v7 offset:24064
    s_waitcnt lgkmcnt(12)
    v_mfma_f32_32x32x16_bf16 v[224:239], a[84:87], a[16:19], v[224:239]
    v_mfma_f32_32x32x16_bf16 v[240:255], a[84:87], a[20:23], v[240:255]
    ds_read_b64_tr_b16 a[84:85], v7 offset:23808
    ds_read_b64_tr_b16 a[86:87], v7 offset:24320
    s_waitcnt lgkmcnt(12)
    v_mfma_f32_32x32x16_bf16 a[96:111], a[88:91], a[16:19], a[96:111]
    v_mfma_f32_32x32x16_bf16 a[112:127], a[88:91], a[20:23], a[112:127]
    ds_read_b64_tr_b16 a[88:89], v61 offset:27648
    ds_read_b64_tr_b16 a[90:91], v61 offset:27904
    s_waitcnt vmcnt(25)
    s_waitcnt lgkmcnt(12)
    v_mfma_f32_32x32x16_bf16 v[64:79], a[64:67], a[24:27], v[64:79]
    v_mfma_f32_32x32x16_bf16 v[80:95], a[64:67], a[28:31], v[80:95]
    s_waitcnt vmcnt(21)
    s_barrier
    ds_read_b64_tr_b16 a[64:65], v7 offset:28672
    ds_read_b64_tr_b16 a[66:67], v7 offset:29184
    s_waitcnt lgkmcnt(12)
    v_mfma_f32_32x32x16_bf16 v[96:111], a[68:71], a[24:27], v[96:111]
    v_mfma_f32_32x32x16_bf16 v[112:127], a[68:71], a[28:31], v[112:127]
    ds_read_b64_tr_b16 a[68:69], v7 offset:28928
    ds_read_b64_tr_b16 a[70:71], v7 offset:29440
    buffer_load_dwordx4 a[16:19], v2, s[12:15], s25 offen offset:2048
    buffer_load_dwordx4 a[20:23], v2, s[16:19], s25 offen offset:2048
    s_waitcnt lgkmcnt(12)
    v_mfma_f32_32x32x16_bf16 v[128:143], a[72:75], a[24:27], v[128:143]
    v_mfma_f32_32x32x16_bf16 v[144:159], a[72:75], a[28:31], v[144:159]
    ds_read_b64_tr_b16 a[72:73], v7 offset:29696
    ds_read_b64_tr_b16 a[74:75], v7 offset:30208
    s_add_u32 m0, s38, 28672
    s_nop 0
    buffer_load_dwordx4 v3, s[8:11], s24 offen offset:0 lds
    s_waitcnt lgkmcnt(12)
    v_mfma_f32_32x32x16_bf16 v[160:175], a[76:79], a[24:27], v[160:175]
    v_mfma_f32_32x32x16_bf16 v[176:191], a[76:79], a[28:31], v[176:191]
    ds_read_b64_tr_b16 a[76:77], v7 offset:29952
    ds_read_b64_tr_b16 a[78:79], v7 offset:30464
    s_add_u32 m0, s38, 29568
    s_nop 0
    buffer_load_dwordx4 v3, s[8:11], s24 offen offset:128 lds
    s_waitcnt lgkmcnt(12)
    v_mfma_f32_32x32x16_bf16 v[192:207], a[80:83], a[24:27], v[192:207]
    v_mfma_f32_32x32x16_bf16 v[208:223], a[80:83], a[28:31], v[208:223]
    ds_read_b64_tr_b16 a[80:81], v7 offset:30720
    ds_read_b64_tr_b16 a[82:83], v7 offset:31232
    s_add_u32 m0, s38, 30464
    s_nop 0
    buffer_load_dwordx4 v3, s[8:11], s24 offen offset:256 lds
    s_waitcnt lgkmcnt(12)
    v_mfma_f32_32x32x16_bf16 v[224:239], a[84:87], a[24:27], v[224:239]
    v_mfma_f32_32x32x16_bf16 v[240:255], a[84:87], a[28:31], v[240:255]
    ds_read_b64_tr_b16 a[84:85], v7 offset:30976
    ds_read_b64_tr_b16 a[86:87], v7 offset:31488
    s_waitcnt lgkmcnt(12)
    v_mfma_f32_32x32x16_bf16 a[96:111], a[88:91], a[24:27], a[96:111]
    v_mfma_f32_32x32x16_bf16 a[112:127], a[88:91], a[28:31], a[112:127]
    ds_read_b64_tr_b16 a[88:89], v61 offset:34816
    ds_read_b64_tr_b16 a[90:91], v61 offset:35072
    s_waitcnt vmcnt(24)
    s_waitcnt lgkmcnt(12)
    v_mfma_f32_32x32x16_bf16 v[64:79], a[64:67], a[32:35], v[64:79]
    v_mfma_f32_32x32x16_bf16 v[80:95], a[64:67], a[36:39], v[80:95]
    ds_read_b64_tr_b16 a[64:65], v7 offset:35840
    ds_read_b64_tr_b16 a[66:67], v7 offset:36352
    s_waitcnt lgkmcnt(12)
    v_mfma_f32_32x32x16_bf16 v[96:111], a[68:71], a[32:35], v[96:111]
    v_mfma_f32_32x32x16_bf16 v[112:127], a[68:71], a[36:39], v[112:127]
    ds_read_b64_tr_b16 a[68:69], v7 offset:36096
    ds_read_b64_tr_b16 a[70:71], v7 offset:36608
    buffer_load_dwordx4 a[24:27], v2, s[12:15], s25 offen offset:3072
    buffer_load_dwordx4 a[28:31], v2, s[16:19], s25 offen offset:3072
    s_add_u32 s25, s25, 4096
    s_waitcnt lgkmcnt(12)
    v_mfma_f32_32x32x16_bf16 v[128:143], a[72:75], a[32:35], v[128:143]
    v_mfma_f32_32x32x16_bf16 v[144:159], a[72:75], a[36:39], v[144:159]
    ds_read_b64_tr_b16 a[72:73], v7 offset:36864
    ds_read_b64_tr_b16 a[74:75], v7 offset:37376
    s_add_u32 m0, s38, 31744
    s_nop 0
    buffer_load_dwordx4 v4, s[8:11], s24 offen offset:0 lds
    s_waitcnt lgkmcnt(12)
    v_mfma_f32_32x32x16_bf16 v[160:175], a[76:79], a[32:35], v[160:175]
    v_mfma_f32_32x32x16_bf16 v[176:191], a[76:79], a[36:39], v[176:191]
    ds_read_b64_tr_b16 a[76:77], v7 offset:37120
    ds_read_b64_tr_b16 a[78:79], v7 offset:37632
    s_add_u32 m0, s38, 32640
    s_nop 0
    buffer_load_dwordx4 v4, s[8:11], s24 offen offset:128 lds
    s_waitcnt lgkmcnt(12)
    v_mfma_f32_32x32x16_bf16 v[192:207], a[80:83], a[32:35], v[192:207]
    v_mfma_f32_32x32x16_bf16 v[208:223], a[80:83], a[36:39], v[208:223]
    ds_read_b64_tr_b16 a[80:81], v7 offset:37888
    ds_read_b64_tr_b16 a[82:83], v7 offset:38400
    s_add_u32 m0, s38, 33536
    s_nop 0
    buffer_load_dwordx4 v4, s[8:11], s24 offen offset:256 lds
    s_waitcnt lgkmcnt(12)
    v_mfma_f32_32x32x16_bf16 v[224:239], a[84:87], a[32:35], v[224:239]
    v_mfma_f32_32x32x16_bf16 v[240:255], a[84:87], a[36:39], v[240:255]
    ds_read_b64_tr_b16 a[84:85], v7 offset:38144
    ds_read_b64_tr_b16 a[86:87], v7 offset:38656
    s_add_u32 m0, s38, 34816
    s_nop 0
    buffer_load_dwordx4 v6, s[8:11], s24 offen lds
    s_add_u32 s24, s24, 458752
    s_waitcnt lgkmcnt(12)
    v_mfma_f32_32x32x16_bf16 a[96:111], a[88:91], a[32:35], a[96:111]
    v_mfma_f32_32x32x16_bf16 a[112:127], a[88:91], a[36:39], a[112:127]
    ds_read_b64_tr_b16 a[88:89], v61 offset:41984
    ds_read_b64_tr_b16 a[90:91], v61 offset:42240
    s_waitcnt vmcnt(27)
    s_waitcnt lgkmcnt(12)
    v_mfma_f32_32x32x16_bf16 v[64:79], a[64:67], a[40:43], v[64:79]
    v_mfma_f32_32x32x16_bf16 v[80:95], a[64:67], a[44:47], v[80:95]
    ds_read_b64_tr_b16 a[64:65], v7 offset:43008
    ds_read_b64_tr_b16 a[66:67], v7 offset:43520
    s_waitcnt lgkmcnt(12)
    v_mfma_f32_32x32x16_bf16 v[96:111], a[68:71], a[40:43], v[96:111]
    v_mfma_f32_32x32x16_bf16 v[112:127], a[68:71], a[44:47], v[112:127]
    ds_read_b64_tr_b16 a[68:69], v7 offset:43264
    ds_read_b64_tr_b16 a[70:71], v7 offset:43776
    buffer_load_dwordx4 a[32:35], v2, s[12:15], s25 offen offset:0
    buffer_load_dwordx4 a[36:39], v2, s[16:19], s25 offen offset:0
    s_waitcnt lgkmcnt(12)
    v_mfma_f32_32x32x16_bf16 v[128:143], a[72:75], a[40:43], v[128:143]
    v_mfma_f32_32x32x16_bf16 v[144:159], a[72:75], a[44:47], v[144:159]
    ds_read_b64_tr_b16 a[72:73], v7 offset:44032
    ds_read_b64_tr_b16 a[74:75], v7 offset:44544
    buffer_load_dword v45, v44, s[8:11], s24 offen
    s_waitcnt lgkmcnt(12)
    v_mfma_f32_32x32x16_bf16 v[160:175], a[76:79], a[40:43], v[160:175]
    v_mfma_f32_32x32x16_bf16 v[176:191], a[76:79], a[44:47], v[176:191]
    ds_read_b64_tr_b16 a[76:77], v7 offset:44288
    ds_read_b64_tr_b16 a[78:79], v7 offset:44800
    s_waitcnt lgkmcnt(12)
    v_mfma_f32_32x32x16_bf16 v[192:207], a[80:83], a[40:43], v[192:207]
    v_mfma_f32_32x32x16_bf16 v[208:223], a[80:83], a[44:47], v[208:223]
    ds_read_b64_tr_b16 a[80:81], v7 offset:45056
    ds_read_b64_tr_b16 a[82:83], v7 offset:45568
    s_waitcnt lgkmcnt(12)
    v_mfma_f32_32x32x16_bf16 v[224:239], a[84:87], a[40:43], v[224:239]
    v_mfma_f32_32x32x16_bf16 v[240:255], a[84:87], a[44:47], v[240:255]
    ds_read_b64_tr_b16 a[84:85], v7 offset:45312
    ds_read_b64_tr_b16 a[86:87], v7 offset:45824
    s_waitcnt lgkmcnt(12)
    v_mfma_f32_32x32x16_bf16 a[96:111], a[88:91], a[40:43], a[96:111]
    v_mfma_f32_32x32x16_bf16 a[112:127], a[88:91], a[44:47], a[112:127]
    ds_read_b64_tr_b16 a[88:89], v61 offset:49152
    ds_read_b64_tr_b16 a[90:91], v61 offset:49408
    s_waitcnt vmcnt(28)
    s_waitcnt lgkmcnt(12)
    v_mfma_f32_32x32x16_bf16 v[64:79], a[64:67], a[48:51], v[64:79]
    v_mfma_f32_32x32x16_bf16 v[80:95], a[64:67], a[52:55], v[80:95]
    ds_read_b64_tr_b16 a[64:65], v7 offset:50176
    ds_read_b64_tr_b16 a[66:67], v7 offset:50688
    s_waitcnt lgkmcnt(12)
    v_mfma_f32_32x32x16_bf16 v[96:111], a[68:71], a[48:51], v[96:111]
    v_mfma_f32_32x32x16_bf16 v[112:127], a[68:71], a[52:55], v[112:127]
    ds_read_b64_tr_b16 a[68:69], v7 offset:50432
    ds_read_b64_tr_b16 a[70:71], v7 offset:50944
    buffer_load_dwordx4 a[40:43], v2, s[12:15], s25 offen offset:1024
    buffer_load_dwordx4 a[44:47], v2, s[16:19], s25 offen offset:1024
    s_waitcnt lgkmcnt(12)
    v_mfma_f32_32x32x16_bf16 v[128:143], a[72:75], a[48:51], v[128:143]
    v_mfma_f32_32x32x16_bf16 v[144:159], a[72:75], a[52:55], v[144:159]
    ds_read_b64_tr_b16 a[72:73], v7 offset:51200
    ds_read_b64_tr_b16 a[74:75], v7 offset:51712
    s_waitcnt lgkmcnt(12)
    v_mfma_f32_32x32x16_bf16 v[160:175], a[76:79], a[48:51], v[160:175]
    v_mfma_f32_32x32x16_bf16 v[176:191], a[76:79], a[52:55], v[176:191]
    ds_read_b64_tr_b16 a[76:77], v7 offset:51456
    ds_read_b64_tr_b16 a[78:79], v7 offset:51968
    s_waitcnt lgkmcnt(12)
    v_mfma_f32_32x32x16_bf16 v[192:207], a[80:83], a[48:51], v[192:207]
    v_mfma_f32_32x32x16_bf16 v[208:223], a[80:83], a[52:55], v[208:223]
    ds_read_b64_tr_b16 a[80:81], v7 offset:52224
    ds_read_b64_tr_b16 a[82:83], v7 offset:52736
    s_waitcnt lgkmcnt(12)
    v_mfma_f32_32x32x16_bf16 v[224:239], a[84:87], a[48:51], v[224:239]
    v_mfma_f32_32x32x16_bf16 v[240:255], a[84:87], a[52:55], v[240:255]
    ds_read_b64_tr_b16 a[84:85], v7 offset:52480
    ds_read_b64_tr_b16 a[86:87], v7 offset:52992
    s_waitcnt lgkmcnt(12)
    v_mfma_f32_32x32x16_bf16 a[96:111], a[88:91], a[48:51], a[96:111]
    v_mfma_f32_32x32x16_bf16 a[112:127], a[88:91], a[52:55], a[112:127]
    ds_read_b64_tr_b16 a[88:89], v61 offset:56320
    ds_read_b64_tr_b16 a[90:91], v61 offset:56576
    s_waitcnt vmcnt(25)
    s_waitcnt lgkmcnt(12)
    v_mfma_f32_32x32x16_bf16 v[64:79], a[64:67], a[56:59], v[64:79]
    v_mfma_f32_32x32x16_bf16 v[80:95], a[64:67], a[60:63], v[80:95]
    s_waitcnt vmcnt(21)
    s_barrier
    ds_read_b64_tr_b16 a[64:65], v5 offset:0
    ds_read_b64_tr_b16 a[66:67], v5 offset:512
    s_waitcnt lgkmcnt(12)
    v_mfma_f32_32x32x16_bf16 v[96:111], a[68:71], a[56:59], v[96:111]
    v_mfma_f32_32x32x16_bf16 v[112:127], a[68:71], a[60:63], v[112:127]
    ds_read_b64_tr_b16 a[68:69], v5 offset:256
    ds_read_b64_tr_b16 a[70:71], v5 offset:768
    buffer_load_dwordx4 a[48:51], v2, s[12:15], s25 offen offset:2048
    buffer_load_dwordx4 a[52:55], v2, s[16:19], s25 offen offset:2048
    s_waitcnt lgkmcnt(12)
    v_mfma_f32_32x32x16_bf16 v[128:143], a[72:75], a[56:59], v[128:143]
    v_mfma_f32_32x32x16_bf16 v[144:159], a[72:75], a[60:63], v[144:159]
    ds_read_b64_tr_b16 a[72:73], v5 offset:1024
    ds_read_b64_tr_b16 a[74:75], v5 offset:1536
    s_add_u32 m0, s38, 57344
    s_nop 0
    buffer_load_dwordx4 v3, s[8:11], s24 offen offset:0 lds
    s_waitcnt lgkmcnt(12)
    v_mfma_f32_32x32x16_bf16 v[160:175], a[76:79], a[56:59], v[160:175]
    v_mfma_f32_32x32x16_bf16 v[176:191], a[76:79], a[60:63], v[176:191]
    ds_read_b64_tr_b16 a[76:77], v5 offset:1280
    ds_read_b64_tr_b16 a[78:79], v5 offset:1792
    s_add_u32 m0, s38, 58240
    s_nop 0
    buffer_load_dwordx4 v3, s[8:11], s24 offen offset:128 lds
    s_waitcnt lgkmcnt(12)
    v_mfma_f32_32x32x16_bf16 v[192:207], a[80:83], a[56:59], v[192:207]
    v_mfma_f32_32x32x16_bf16 v[208:223], a[80:83], a[60:63], v[208:223]
    ds_read_b64_tr_b16 a[80:81], v5 offset:2048
    ds_read_b64_tr_b16 a[82:83], v5 offset:2560
    s_add_u32 m0, s38, 59136
    s_nop 0
    buffer_load_dwordx4 v3, s[8:11], s24 offen offset:256 lds
    s_waitcnt lgkmcnt(12)
    v_mfma_f32_32x32x16_bf16 v[224:239], a[84:87], a[56:59], v[224:239]
    v_mfma_f32_32x32x16_bf16 v[240:255], a[84:87], a[60:63], v[240:255]
    ds_read_b64_tr_b16 a[84:85], v5 offset:2304
    ds_read_b64_tr_b16 a[86:87], v5 offset:2816
    s_waitcnt lgkmcnt(12)
    v_mfma_f32_32x32x16_bf16 a[96:111], a[88:91], a[56:59], a[96:111]
    v_mfma_f32_32x32x16_bf16 a[112:127], a[88:91], a[60:63], a[112:127]
    ds_read_b64_tr_b16 a[88:89], v60 offset:6144
    ds_read_b64_tr_b16 a[90:91], v60 offset:6400
    s_add_u32 s26, s26, 1
    s_cmp_lt_u32 s26, 3
    s_cbranch_scc1 g1_h_loop
    s_waitcnt vmcnt(24)
    s_waitcnt lgkmcnt(12)
    v_mfma_f32_32x32x16_bf16 v[64:79], a[64:67], a[0:3], v[64:79]
    v_mfma_f32_32x32x16_bf16 v[80:95], a[64:67], a[4:7], v[80:95]
    s_barrier
    ds_read_b64_tr_b16 a[64:65], v5 offset:7168
    ds_read_b64_tr_b16 a[66:67], v5 offset:7680
    s_waitcnt lgkmcnt(12)
    v_mfma_f32_32x32x16_bf16 v[96:111], a[68:71], a[0:3], v[96:111]
    v_mfma_f32_32x32x16_bf16 v[112:127], a[68:71], a[4:7], v[112:127]
    ds_read_b64_tr_b16 a[68:69], v5 offset:7424
    ds_read_b64_tr_b16 a[70:71], v5 offset:7936
    s_add_u32 m0, s38, 60416
    s_nop 0
    buffer_load_dwordx4 v4, s[8:11], s24 offen offset:0 lds
    s_waitcnt lgkmcnt(12)
    v_mfma_f32_32x32x16_bf16 v[128:143], a[72:75], a[0:3], v[128:143]
    v_mfma_f32_32x32x16_bf16 v[144:159], a[72:75], a[4:7], v[144:159]
    ds_read_b64_tr_b16 a[72:73], v5 offset:8192
    ds_read_b64_tr_b16 a[74:75], v5 offset:8704
    s_add_u32 m0, s38, 61312
    s_nop 0
    buffer_load_dwordx4 v4, s[8:11], s24 offen offset:128 lds
    s_waitcnt lgkmcnt(12)
    v_mfma_f32_32x32x16_bf16 v[160:175], a[76:79], a[0:3], v[160:175]
    v_mfma_f32_32x32x16_bf16 v[176:191], a[76:79], a[4:7], v[176:191]
    ds_read_b64_tr_b16 a[76:77], v5 offset:8448
    ds_read_b64_tr_b16 a[78:79], v5 offset:8960
    s_add_u32 m0, s38, 62208
    s_nop 0
    buffer_load_dwordx4 v4, s[8:11], s24 offen offset:256 lds
    s_waitcnt lgkmcnt(12)
    v_mfma_f32_32x32x16_bf16 v[192:207], a[80:83], a[0:3], v[192:207]
    v_mfma_f32_32x32x16_bf16 v[208:223], a[80:83], a[4:7], v[208:223]
    ds_read_b64_tr_b16 a[80:81], v5 offset:9216
    ds_read_b64_tr_b16 a[82:83], v5 offset:9728
    s_add_u32 m0, s38, 63488
    s_nop 0
    buffer_load_dwordx4 v6, s[8:11], s24 offen lds
    s_add_u32 s24, s24, 458752
    s_waitcnt lgkmcnt(12)
    v_mfma_f32_32x32x16_bf16 v[224:239], a[84:87], a[0:3], v[224:239]
    v_mfma_f32_32x32x16_bf16 v[240:255], a[84:87], a[4:7], v[240:255]
    ds_read_b64_tr_b16 a[84:85], v5 offset:9472
    ds_read_b64_tr_b16 a[86:87], v5 offset:9984
    buffer_load_dwordx4 a[56:59], v2, s[12:15], s25 offen offset:3072
    buffer_load_dwordx4 a[60:63], v2, s[16:19], s25 offen offset:3072
    s_add_u32 s25, s25, 4096
    s_waitcnt lgkmcnt(12)
    v_mfma_f32_32x32x16_bf16 a[96:111], a[88:91], a[0:3], a[96:111]
    v_mfma_f32_32x32x16_bf16 a[112:127], a[88:91], a[4:7], a[112:127]
    ds_read_b64_tr_b16 a[88:89], v60 offset:13312
    ds_read_b64_tr_b16 a[90:91], v60 offset:13568
    s_add_u32 m0, s38, 86016
    s_nop 0
    buffer_load_dwordx4 v3, s[8:11], s24 offen offset:0 lds
    s_waitcnt vmcnt(28)
    s_waitcnt lgkmcnt(12)
    v_mfma_f32_32x32x16_bf16 v[64:79], a[64:67], a[8:11], v[64:79]
    v_mfma_f32_32x32x16_bf16 v[80:95], a[64:67], a[12:15], v[80:95]
    ds_read_b64_tr_b16 a[64:65], v5 offset:14336
    ds_read_b64_tr_b16 a[66:67], v5 offset:14848
    s_waitcnt lgkmcnt(12)
    v_mfma_f32_32x32x16_bf16 v[96:111], a[68:71], a[8:11], v[96:111]
    v_mfma_f32_32x32x16_bf16 v[112:127], a[68:71], a[12:15], v[112:127]
    ds_read_b64_tr_b16 a[68:69], v5 offset:14592
    ds_read_b64_tr_b16 a[70:71], v5 offset:15104
    s_add_u32 m0, s38, 86912
    s_nop 0
    buffer_load_dwordx4 v3, s[8:11], s24 offen offset:128 lds
    s_waitcnt lgkmcnt(12)
    v_mfma_f32_32x32x16_bf16 v[128:143], a[72:75], a[8:11], v[128:143]
    v_mfma_f32_32x32x16_bf16 v[144:159], a[72:75], a[12:15], v[144:159]
    ds_read_b64_tr_b16 a[72:73], v5 offset:15360
    ds_read_b64_tr_b16 a[74:75], v5 offset:15872
    s_add_u32 m0, s38, 87808
    s_nop 0
    buffer_load_dwordx4 v3, s[8:11], s24 offen offset:256 lds
    s_waitcnt lgkmcnt(12)
    v_mfma_f32_32x32x16_bf16 v[160:175], a[76:79], a[8:11], v[160:175]
    v_mfma_f32_32x32x16_bf16 v[176:191], a[76:79], a[12:15], v[176:191]
    ds_read_b64_tr_b16 a[76:77], v5 offset:15616
    ds_read_b64_tr_b16 a[78:79], v5 offset:16128
    s_add_u32 m0, s38, 89088
    s_nop 0
    buffer_load_dwordx4 v4, s[8:11], s24 offen offset:0 lds
    s_waitcnt lgkmcnt(12)
    v_mfma_f32_32x32x16_bf16 v[192:207], a[80:83], a[8:11], v[192:207]
    v_mfma_f32_32x32x16_bf16 v[208:223], a[80:83], a[12:15], v[208:223]
    ds_read_b64_tr_b16 a[80:81], v5 offset:16384
    ds_read_b64_tr_b16 a[82:83], v5 offset:16896
    s_add_u32 m0, s38, 89984
    s_nop 0
    buffer_load_dwordx4 v4, s[8:11], s24 offen offset:128 lds
    s_waitcnt lgkmcnt(12)
    v_mfma_f32_32x32x16_bf16 v[224:239], a[84:87], a[8:11], v[224:239]
    v_mfma_f32_32x32x16_bf16 v[240:255], a[84:87], a[12:15], v[240:255]
    ds_read_b64_tr_b16 a[84:85], v5 offset:16640
    ds_read_b64_tr_b16 a[86:87], v5 offset:17152
    s_add_u32 m0, s38, 90880
    s_nop 0
    buffer_load_dwordx4 v4, s[8:11], s24 offen offset:256 lds
    s_waitcnt lgkmcnt(12)
    v_mfma_f32_32x32x16_bf16 a[96:111], a[88:91], a[8:11], a[96:111]
    v_mfma_f32_32x32x16_bf16 a[112:127], a[88:91], a[12:15], a[112:127]
    ds_read_b64_tr_b16 a[88:89], v60 offset:20480
    ds_read_b64_tr_b16 a[90:91], v60 offset:20736
    s_add_u32 m0, s38, 92160
    s_nop 0
    buffer_load_dwordx4 v6, s[8:11], s24 offen lds
    buffer_load_dwordx4 a[128:131], v2, s[12:15], s25 offen offset:0
    buffer_load_dwordx4 a[132:135], v2, s[16:19], s25 offen offset:0
    s_waitcnt vmcnt(34)
    s_waitcnt lgkmcnt(12)
    v_mfma_f32_32x32x16_bf16 v[64:79], a[64:67], a[16:19], v[64:79]
    v_mfma_f32_32x32x16_bf16 v[80:95], a[64:67], a[20:23], v[80:95]
    ds_read_b64_tr_b16 a[64:65], v5 offset:21504
    ds_read_b64_tr_b16 a[66:67], v5 offset:22016
    s_waitcnt lgkmcnt(12)
    v_mfma_f32_32x32x16_bf16 v[96:111], a[68:71], a[16:19], v[96:111]
    v_mfma_f32_32x32x16_bf16 v[112:127], a[68:71], a[20:23], v[112:127]
    ds_read_b64_tr_b16 a[68:69], v5 offset:21760
    ds_read_b64_tr_b16 a[70:71], v5 offset:22272
    buffer_load_dwordx4 a[136:139], v2, s[12:15], s25 offen offset:1024
    buffer_load_dwordx4 a[140:143], v2, s[16:19], s25 offen offset:1024
    s_waitcnt lgkmcnt(12)
    v_mfma_f32_32x32x16_bf16 v[128:143], a[72:75], a[16:19], v[128:143]
    v_mfma_f32_32x32x16_bf16 v[144:159], a[72:75], a[20:23], v[144:159]
    ds_read_b64_tr_b16 a[72:73], v5 offset:22528
    ds_read_b64_tr_b16 a[74:75], v5 offset:23040
    buffer_load_dwordx4 a[144:147], v2, s[12:15], s25 offen offset:2048
    buffer_load_dwordx4 a[148:151], v2, s[16:19], s25 offen offset:2048
    s_waitcnt lgkmcnt(12)
    v_mfma_f32_32x32x16_bf16 v[160:175], a[76:79], a[16:19], v[160:175]
    v_mfma_f32_32x32x16_bf16 v[176:191], a[76:79], a[20:23], v[176:191]
    ds_read_b64_tr_b16 a[76:77], v5 offset:22784
    ds_read_b64_tr_b16 a[78:79], v5 offset:23296
    buffer_load_dwordx4 a[152:155], v2, s[12:15], s25 offen offset:3072
    buffer_load_dwordx4 a[156:159], v2, s[16:19], s25 offen offset:3072
    s_add_u32 s25, s25, 4096
    s_waitcnt lgkmcnt(12)
    v_mfma_f32_32x32x16_bf16 v[192:207], a[80:83], a[16:19], v[192:207]
    v_mfma_f32_32x32x16_bf16 v[208:223], a[80:83], a[20:23], v[208:223]
    ds_read_b64_tr_b16 a[80:81], v5 offset:23552
    ds_read_b64_tr_b16 a[82:83], v5 offset:24064
    buffer_load_dwordx4 a[160:163], v2, s[12:15], s25 offen offset:0
    buffer_load_dwordx4 a[164:167], v2, s[16:19], s25 offen offset:0
    s_waitcnt lgkmcnt(12)
    v_mfma_f32_32x32x16_bf16 v[224:239], a[84:87], a[16:19], v[224:239]
    v_mfma_f32_32x32x16_bf16 v[240:255], a[84:87], a[20:23], v[240:255]
    ds_read_b64_tr_b16 a[84:85], v5 offset:23808
    ds_read_b64_tr_b16 a[86:87], v5 offset:24320
    s_waitcnt lgkmcnt(12)
    v_mfma_f32_32x32x16_bf16 a[96:111], a[88:91], a[16:19], a[96:111]
    v_mfma_f32_32x32x16_bf16 a[112:127], a[88:91], a[20:23], a[112:127]
    ds_read_b64_tr_b16 a[88:89], v60 offset:27648
    ds_read_b64_tr_b16 a[90:91], v60 offset:27904
    s_waitcnt vmcnt(37)
    s_waitcnt lgkmcnt(12)
    v_mfma_f32_32x32x16_bf16 v[64:79], a[64:67], a[24:27], v[64:79]
    v_mfma_f32_32x32x16_bf16 v[80:95], a[64:67], a[28:31], v[80:95]
    s_waitcnt vmcnt(19)
    s_barrier
    ds_read_b64_tr_b16 a[64:65], v5 offset:28672
    ds_read_b64_tr_b16 a[66:67], v5 offset:29184
    s_waitcnt lgkmcnt(12)
    v_mfma_f32_32x32x16_bf16 v[96:111], a[68:71], a[24:27], v[96:111]
    v_mfma_f32_32x32x16_bf16 v[112:127], a[68:71], a[28:31], v[112:127]
    ds_read_b64_tr_b16 a[68:69], v5 offset:35840
    ds_read_b64_tr_b16 a[70:71], v5 offset:36352
    buffer_load_dwordx4 a[168:171], v2, s[12:15], s25 offen offset:1024
    buffer_load_dwordx4 a[172:175], v2, s[16:19], s25 offen offset:1024
    s_waitcnt lgkmcnt(12)
    v_mfma_f32_32x32x16_bf16 v[128:143], a[72:75], a[24:27], v[128:143]
    v_mfma_f32_32x32x16_bf16 v[144:159], a[72:75], a[28:31], v[144:159]
    ds_read_b64_tr_b16 a[72:73], v5 offset:43008
    ds_read_b64_tr_b16 a[74:75], v5 offset:43520
    buffer_load_dwordx4 a[176:179], v2, s[12:15], s25 offen offset:2048
    buffer_load_dwordx4 a[180:183], v2, s[16:19], s25 offen offset:2048
    s_waitcnt lgkmcnt(12)
    v_mfma_f32_32x32x16_bf16 v[160:175], a[76:79], a[24:27], v[160:175]
    v_mfma_f32_32x32x16_bf16 v[176:191], a[76:79], a[28:31], v[176:191]
    ds_read_b64_tr_b16 a[76:77], v5 offset:50176
    ds_read_b64_tr_b16 a[78:79], v5 offset:50688
    buffer_load_dwordx4 a[184:187], v2, s[12:15], s25 offen offset:3072
    buffer_load_dwordx4 a[188:191], v2, s[16:19], s25 offen offset:3072
    s_waitcnt lgkmcnt(12)
    v_mfma_f32_32x32x16_bf16 v[192:207], a[80:83], a[24:27], v[192:207]
    v_mfma_f32_32x32x16_bf16 v[208:223], a[80:83], a[28:31], v[208:223]
    ds_read_b64_tr_b16 a[80:81], v7 offset:0
    ds_read_b64_tr_b16 a[82:83], v7 offset:512
    s_waitcnt lgkmcnt(12)
    v_mfma_f32_32x32x16_bf16 v[224:239], a[84:87], a[24:27], v[224:239]
    v_mfma_f32_32x32x16_bf16 v[240:255], a[84:87], a[28:31], v[240:255]
    ds_read_b64_tr_b16 a[84:85], v7 offset:7168
    ds_read_b64_tr_b16 a[86:87], v7 offset:7680
    s_waitcnt lgkmcnt(12)
    v_mfma_f32_32x32x16_bf16 a[96:111], a[88:91], a[24:27], a[96:111]
    v_mfma_f32_32x32x16_bf16 a[112:127], a[88:91], a[28:31], a[112:127]
    ds_read_b64_tr_b16 a[88:89], v7 offset:14336
    ds_read_b64_tr_b16 a[90:91], v7 offset:14848
    s_waitcnt lgkmcnt(12)
    v_mfma_f32_32x32x16_bf16 v[64:79], a[64:67], a[32:35], v[64:79]
    v_mfma_f32_32x32x16_bf16 v[80:95], a[64:67], a[36:39], v[80:95]
    ds_read_b64_tr_b16 a[64:65], v7 offset:21504
    ds_read_b64_tr_b16 a[66:67], v7 offset:22016
    s_waitcnt lgkmcnt(12)
    v_mfma_f32_32x32x16_bf16 v[64:79], a[68:71], a[40:43], v[64:79]
    v_mfma_f32_32x32x16_bf16 v[80:95], a[68:71], a[44:47], v[80:95]
    s_waitcnt vmcnt(16)
    s_barrier
    ds_read_b64_tr_b16 a[68:69], v7 offset:28672
    ds_read_b64_tr_b16 a[70:71], v7 offset:29184
    s_waitcnt lgkmcnt(12)
    v_mfma_f32_32x32x16_bf16 v[64:79], a[72:75], a[48:51], v[64:79]
    v_mfma_f32_32x32x16_bf16 v[80:95], a[72:75], a[52:55], v[80:95]
    ds_read_b64_tr_b16 a[72:73], v7 offset:35840
    ds_read_b64_tr_b16 a[74:75], v7 offset:36352
    s_waitcnt lgkmcnt(12)
    v_mfma_f32_32x32x16_bf16 v[64:79], a[76:79], a[56:59], v[64:79]
    v_mfma_f32_32x32x16_bf16 v[80:95], a[76:79], a[60:63], v[80:95]
    ds_read_b64_tr_b16 a[76:77], v7 offset:43008
    ds_read_b64_tr_b16 a[78:79], v7 offset:43520
    s_waitcnt vmcnt(14)
    s_waitcnt lgkmcnt(12)
    v_mfma_f32_32x32x16_bf16 v[64:79], a[80:83], a[128:131], v[64:79]
    v_mfma_f32_32x32x16_bf16 v[80:95], a[80:83], a[132:135], v[80:95]
    ds_read_b64_tr_b16 a[80:81], v7 offset:50176
    ds_read_b64_tr_b16 a[82:83], v7 offset:50688
    s_waitcnt vmcnt(12)
    s_waitcnt lgkmcnt(12)
    v_mfma_f32_32x32x16_bf16 v[64:79], a[84:87], a[136:139], v[64:79]
    v_mfma_f32_32x32x16_bf16 v[80:95], a[84:87], a[140:143], v[80:95]
    ds_read_b64_tr_b16 a[84:85], v5 offset:28928
    ds_read_b64_tr_b16 a[86:87], v5 offset:29440
    s_waitcnt vmcnt(10)
    s_waitcnt lgkmcnt(12)
    v_mfma_f32_32x32x16_bf16 v[64:79], a[88:91], a[144:147], v[64:79]
    v_mfma_f32_32x32x16_bf16 v[80:95], a[88:91], a[148:151], v[80:95]
    ds_read_b64_tr_b16 a[88:89], v5 offset:36096
    ds_read_b64_tr_b16 a[90:91], v5 offset:36608
    s_waitcnt vmcnt(8)
    s_waitcnt lgkmcnt(12)
    v_mfma_f32_32x32x16_bf16 v[64:79], a[64:67], a[152:155], v[64:79]
    v_mfma_f32_32x32x16_bf16 v[80:95], a[64:67], a[156:159], v[80:95]
    ds_read_b64_tr_b16 a[64:65], v5 offset:43264
    ds_read_b64_tr_b16 a[66:67], v5 offset:43776
    s_waitcnt vmcnt(6)
    s_waitcnt lgkmcnt(12)
    v_mfma_f32_32x32x16_bf16 v[64:79], a[68:71], a[160:163], v[64:79]
    v_mfma_f32_32x32x16_bf16 v[80:95], a[68:71], a[164:167], v[80:95]
    ds_read_b64_tr_b16 a[68:69], v5 offset:50432
    ds_read_b64_tr_b16 a[70:71], v5 offset:50944
    s_waitcnt vmcnt(4)
    s_waitcnt lgkmcnt(12)
    v_mfma_f32_32x32x16_bf16 v[64:79], a[72:75], a[168:171], v[64:79]
    v_mfma_f32_32x32x16_bf16 v[80:95], a[72:75], a[172:175], v[80:95]
    ds_read_b64_tr_b16 a[72:73], v7 offset:256
    ds_read_b64_tr_b16 a[74:75], v7 offset:768
    s_waitcnt vmcnt(2)
    s_waitcnt lgkmcnt(12)
    v_mfma_f32_32x32x16_bf16 v[64:79], a[76:79], a[176:179], v[64:79]
    v_mfma_f32_32x32x16_bf16 v[80:95], a[76:79], a[180:183], v[80:95]
    ds_read_b64_tr_b16 a[76:77], v7 offset:7424
    ds_read_b64_tr_b16 a[78:79], v7 offset:7936
    s_waitcnt vmcnt(0)
    s_waitcnt lgkmcnt(12)
    v_mfma_f32_32x32x16_bf16 v[64:79], a[80:83], a[184:187], v[64:79]
    v_mfma_f32_32x32x16_bf16 v[80:95], a[80:83], a[188:191], v[80:95]
    ds_read_b64_tr_b16 a[80:81], v7 offset:14592
    ds_read_b64_tr_b16 a[82:83], v7 offset:15104
    s_waitcnt lgkmcnt(12)
    v_mfma_f32_32x32x16_bf16 v[96:111], a[84:87], a[32:35], v[96:111]
    v_mfma_f32_32x32x16_bf16 v[112:127], a[84:87], a[36:39], v[112:127]
    ds_read_b64_tr_b16 a[84:85], v7 offset:21760
    ds_read_b64_tr_b16 a[86:87], v7 offset:22272
    s_waitcnt lgkmcnt(12)
    v_mfma_f32_32x32x16_bf16 v[96:111], a[88:91], a[40:43], v[96:111]
    s_nop 15
    v_pk_mul_f32 v[32:33], v[64:65], v[64:65]
    v_pk_mul_f32 v[34:35], v[66:67], v[66:67]
    v_pk_mul_f32 v[36:37], v[68:69], v[68:69]
    v_pk_mul_f32 v[38:39], v[70:71], v[70:71]
    v_pk_mul_f32 v[40:41], v[72:73], v[72:73]
    v_pk_mul_f32 v[42:43], v[74:75], v[74:75]
    v_pk_mul_f32 v[44:45], v[76:77], v[76:77]
    v_pk_mul_f32 v[46:47], v[78:79], v[78:79]
    v_pk_fma_f32 v[32:33], v[32:33], v[10:11], v[8:9]
    v_pk_fma_f32 v[34:35], v[34:35], v[10:11], v[8:9]
    v_pk_fma_f32 v[36:37], v[36:37], v[10:11], v[8:9]
    v_pk_fma_f32 v[38:39], v[38:39], v[10:11], v[8:9]
    v_pk_fma_f32 v[40:41], v[40:41], v[10:11], v[8:9]
    v_pk_fma_f32 v[42:43], v[42:43], v[10:11], v[8:9]
    v_pk_fma_f32 v[44:45], v[44:45], v[10:11], v[8:9]
    v_pk_fma_f32 v[46:47], v[46:47], v[10:11], v[8:9]
    v_pk_mul_f32 v[32:33], v[32:33], v[64:65]
    v_pk_mul_f32 v[34:35], v[34:35], v[66:67]
    v_pk_mul_f32 v[36:37], v[36:37], v[68:69]
    v_pk_mul_f32 v[38:39], v[38:39], v[70:71]
    v_pk_mul_f32 v[40:41], v[40:41], v[72:73]
    v_pk_mul_f32 v[42:43], v[42:43], v[74:75]
    v_pk_mul_f32 v[44:45], v[44:45], v[76:77]
    v_pk_mul_f32 v[46:47], v[46:47], v[78:79]
    v_exp_f32 v48, v32
    v_exp_f32 v49, v33
    v_mfma_f32_32x32x16_bf16 v[112:127], a[88:91], a[44:47], v[112:127]
    v_exp_f32 v50, v34
    v_exp_f32 v51, v35
    ds_read_b64_tr_b16 a[88:89], v7 offset:28928
    ds_read_b64_tr_b16 a[90:91], v7 offset:29440
    v_exp_f32 v52, v36
    s_waitcnt lgkmcnt(12)
    v_mfma_f32_32x32x16_bf16 v[96:111], a[64:67], a[48:51], v[96:111]
    v_exp_f32 v53, v37
    v_exp_f32 v54, v38
    v_mfma_f32_32x32x16_bf16 v[112:127], a[64:67], a[52:55], v[112:127]
    v_exp_f32 v55, v39
    v_exp_f32 v56, v40
    ds_read_b64_tr_b16 a[64:65], v7 offset:36096
    ds_read_b64_tr_b16 a[66:67], v7 offset:36608
    v_exp_f32 v57, v41
    s_waitcnt lgkmcnt(12)
    v_mfma_f32_32x32x16_bf16 v[96:111], a[68:71], a[56:59], v[96:111]
    v_exp_f32 v58, v42
    v_exp_f32 v59, v43
    v_mfma_f32_32x32x16_bf16 v[112:127], a[68:71], a[60:63], v[112:127]
    v_exp_f32 v60, v44
    v_exp_f32 v61, v45
    ds_read_b64_tr_b16 a[68:69], v7 offset:43264
    ds_read_b64_tr_b16 a[70:71], v7 offset:43776
    v_exp_f32 v62, v46
    v_exp_f32 v63, v47
    s_waitcnt lgkmcnt(12)
    v_mfma_f32_32x32x16_bf16 v[96:111], a[72:75], a[128:131], v[96:111]
    v_pk_add_f32 v[48:49], v[48:49], v[12:13]
    v_pk_add_f32 v[50:51], v[50:51], v[12:13]
    v_pk_add_f32 v[52:53], v[52:53], v[12:13]
    v_pk_add_f32 v[54:55], v[54:55], v[12:13]
    v_pk_add_f32 v[56:57], v[56:57], v[12:13]
    v_pk_add_f32 v[58:59], v[58:59], v[12:13]
    v_pk_add_f32 v[60:61], v[60:61], v[12:13]
    v_pk_add_f32 v[62:63], v[62:63], v[12:13]
    v_rcp_f32 v32, v48
    v_rcp_f32 v33, v49
    v_mfma_f32_32x32x16_bf16 v[112:127], a[72:75], a[132:135], v[112:127]
    v_rcp_f32 v34, v50
    v_rcp_f32 v35, v51
    ds_read_b64_tr_b16 a[72:73], v7 offset:50432
    ds_read_b64_tr_b16 a[74:75], v7 offset:50944
    v_rcp_f32 v36, v52
    s_waitcnt lgkmcnt(12)
    v_mfma_f32_32x32x16_bf16 v[96:111], a[76:79], a[136:139], v[96:111]
    v_rcp_f32 v37, v53
    v_rcp_f32 v38, v54
    v_mfma_f32_32x32x16_bf16 v[112:127], a[76:79], a[140:143], v[112:127]
    v_rcp_f32 v39, v55
    v_rcp_f32 v40, v56
    ds_read_b64_tr_b16 a[76:77], v5 offset:29696
    ds_read_b64_tr_b16 a[78:79], v5 offset:30208
    v_rcp_f32 v41, v57
    s_waitcnt lgkmcnt(12)
    v_mfma_f32_32x32x16_bf16 v[96:111], a[80:83], a[144:147], v[96:111]
    v_rcp_f32 v42, v58
    v_rcp_f32 v43, v59
    v_mfma_f32_32x32x16_bf16 v[112:127], a[80:83], a[148:151], v[112:127]
    v_rcp_f32 v44, v60
    v_rcp_f32 v45, v61
    ds_read_b64_tr_b16 a[80:81], v5 offset:36864
    ds_read_b64_tr_b16 a[82:83], v5 offset:37376
    v_rcp_f32 v46, v62
    v_rcp_f32 v47, v63
    s_waitcnt lgkmcnt(12)
    v_mfma_f32_32x32x16_bf16 v[96:111], a[84:87], a[152:155], v[96:111]
    v_pk_mul_f32 v[64:65], v[64:65], v[32:33]
    v_pk_mul_f32 v[66:67], v[66:67], v[34:35]
    v_pk_mul_f32 v[68:69], v[68:69], v[36:37]
    v_pk_mul_f32 v[70:71], v[70:71], v[38:39]
    v_pk_mul_f32 v[72:73], v[72:73], v[40:41]
    v_pk_mul_f32 v[74:75], v[74:75], v[42:43]
    v_pk_mul_f32 v[76:77], v[76:77], v[44:45]
    v_pk_mul_f32 v[78:79], v[78:79], v[46:47]
    s_add_u32 s70, s71, 0
    v_cvt_pk_bf16_f32 v16, v64, v65
    v_cvt_pk_bf16_f32 v17, v66, v67
    v_cvt_pk_bf16_f32 v18, v68, v69
    v_cvt_pk_bf16_f32 v19, v70, v71
    v_cvt_pk_bf16_f32 v20, v72, v73
    v_cvt_pk_bf16_f32 v21, v74, v75
    v_cvt_pk_bf16_f32 v22, v76, v77
    v_cvt_pk_bf16_f32 v23, v78, v79
    buffer_store_dwordx4 v[16:19], v2, s[60:63], s70 offen offset:0 sc1
    buffer_store_dwordx4 v[20:23], v2, s[60:63], s70 offen offset:1024 sc1
    v_pk_mul_f32 v[32:33], v[80:81], v[80:81]
    v_pk_mul_f32 v[34:35], v[82:83], v[82:83]
    v_pk_mul_f32 v[36:37], v[84:85], v[84:85]
    v_pk_mul_f32 v[38:39], v[86:87], v[86:87]
    v_pk_mul_f32 v[40:41], v[88:89], v[88:89]
    v_pk_mul_f32 v[42:43], v[90:91], v[90:91]
    v_pk_mul_f32 v[44:45], v[92:93], v[92:93]
    v_pk_mul_f32 v[46:47], v[94:95], v[94:95]
    v_pk_fma_f32 v[32:33], v[32:33], v[10:11], v[8:9]
    v_pk_fma_f32 v[34:35], v[34:35], v[10:11], v[8:9]
    v_pk_fma_f32 v[36:37], v[36:37], v[10:11], v[8:9]
    v_pk_fma_f32 v[38:39], v[38:39], v[10:11], v[8:9]
    v_pk_fma_f32 v[40:41], v[40:41], v[10:11], v[8:9]
    v_pk_fma_f32 v[42:43], v[42:43], v[10:11], v[8:9]
    v_pk_fma_f32 v[44:45], v[44:45], v[10:11], v[8:9]
    v_pk_fma_f32 v[46:47], v[46:47], v[10:11], v[8:9]
    v_pk_mul_f32 v[32:33], v[32:33], v[80:81]
    v_pk_mul_f32 v[34:35], v[34:35], v[82:83]
    v_pk_mul_f32 v[36:37], v[36:37], v[84:85]
    v_pk_mul_f32 v[38:39], v[38:39], v[86:87]
    v_pk_mul_f32 v[40:41], v[40:41], v[88:89]
    v_pk_mul_f32 v[42:43], v[42:43], v[90:91]
    v_pk_mul_f32 v[44:45], v[44:45], v[92:93]
    v_pk_mul_f32 v[46:47], v[46:47], v[94:95]
    v_exp_f32 v48, v32
    v_exp_f32 v49, v33
    v_mfma_f32_32x32x16_bf16 v[112:127], a[84:87], a[156:159], v[112:127]
    v_exp_f32 v50, v34
    v_exp_f32 v51, v35
    ds_read_b64_tr_b16 a[84:85], v5 offset:44032
    ds_read_b64_tr_b16 a[86:87], v5 offset:44544
    v_exp_f32 v52, v36
    s_waitcnt lgkmcnt(12)
    v_mfma_f32_32x32x16_bf16 v[96:111], a[88:91], a[160:163], v[96:111]
    v_exp_f32 v53, v37
    v_exp_f32 v54, v38
    v_mfma_f32_32x32x16_bf16 v[112:127], a[88:91], a[164:167], v[112:127]
    v_exp_f32 v55, v39
    v_exp_f32 v56, v40
    ds_read_b64_tr_b16 a[88:89], v5 offset:51200
    ds_read_b64_tr_b16 a[90:91], v5 offset:51712
    v_exp_f32 v57, v41
    s_waitcnt lgkmcnt(12)
    v_mfma_f32_32x32x16_bf16 v[96:111], a[64:67], a[168:171], v[96:111]
    v_exp_f32 v58, v42
    v_exp_f32 v59, v43
    v_mfma_f32_32x32x16_bf16 v[112:127], a[64:67], a[172:175], v[112:127]
    v_exp_f32 v60, v44
    v_exp_f32 v61, v45
    ds_read_b64_tr_b16 a[64:65], v7 offset:1024
    ds_read_b64_tr_b16 a[66:67], v7 offset:1536
    v_exp_f32 v62, v46
    v_exp_f32 v63, v47
    s_waitcnt lgkmcnt(12)
    v_mfma_f32_32x32x16_bf16 v[96:111], a[68:71], a[176:179], v[96:111]
    v_pk_add_f32 v[48:49], v[48:49], v[12:13]
    v_pk_add_f32 v[50:51], v[50:51], v[12:13]
    v_pk_add_f32 v[52:53], v[52:53], v[12:13]
    v_pk_add_f32 v[54:55], v[54:55], v[12:13]
    v_pk_add_f32 v[56:57], v[56:57], v[12:13]
    v_pk_add_f32 v[58:59], v[58:59], v[12:13]
    v_pk_add_f32 v[60:61], v[60:61], v[12:13]
    v_pk_add_f32 v[62:63], v[62:63], v[12:13]
    v_rcp_f32 v32, v48
    v_rcp_f32 v33, v49
    v_mfma_f32_32x32x16_bf16 v[112:127], a[68:71], a[180:183], v[112:127]
    v_rcp_f32 v34, v50
    v_rcp_f32 v35, v51
    ds_read_b64_tr_b16 a[68:69], v7 offset:8192
    ds_read_b64_tr_b16 a[70:71], v7 offset:8704
    v_rcp_f32 v36, v52
    s_waitcnt lgkmcnt(12)
    v_mfma_f32_32x32x16_bf16 v[96:111], a[72:75], a[184:187], v[96:111]
    v_rcp_f32 v37, v53
    v_rcp_f32 v38, v54
    v_mfma_f32_32x32x16_bf16 v[112:127], a[72:75], a[188:191], v[112:127]
    v_rcp_f32 v39, v55
    v_rcp_f32 v40, v56
    ds_read_b64_tr_b16 a[72:73], v7 offset:15360
    ds_read_b64_tr_b16 a[74:75], v7 offset:15872
    v_rcp_f32 v41, v57
    s_waitcnt lgkmcnt(12)
    v_mfma_f32_32x32x16_bf16 v[128:143], a[76:79], a[32:35], v[128:143]
    v_rcp_f32 v42, v58
    v_rcp_f32 v43, v59
    v_mfma_f32_32x32x16_bf16 v[144:159], a[76:79], a[36:39], v[144:159]
    v_rcp_f32 v44, v60
    v_rcp_f32 v45, v61
    ds_read_b64_tr_b16 a[76:77], v7 offset:22528
    ds_read_b64_tr_b16 a[78:79], v7 offset:23040
    v_rcp_f32 v46, v62
    v_rcp_f32 v47, v63
    s_waitcnt lgkmcnt(12)
    v_mfma_f32_32x32x16_bf16 v[128:143], a[80:83], a[40:43], v[128:143]
    v_pk_mul_f32 v[80:81], v[80:81], v[32:33]
    v_pk_mul_f32 v[82:83], v[82:83], v[34:35]
    v_pk_mul_f32 v[84:85], v[84:85], v[36:37]
    v_pk_mul_f32 v[86:87], v[86:87], v[38:39]
    v_pk_mul_f32 v[88:89], v[88:89], v[40:41]
    v_pk_mul_f32 v[90:91], v[90:91], v[42:43]
    v_pk_mul_f32 v[92:93], v[92:93], v[44:45]
    v_pk_mul_f32 v[94:95], v[94:95], v[46:47]
    s_add_u32 s70, s71, 294912
    v_cvt_pk_bf16_f32 v24, v80, v81
    v_cvt_pk_bf16_f32 v25, v82, v83
    v_cvt_pk_bf16_f32 v26, v84, v85
    v_cvt_pk_bf16_f32 v27, v86, v87
    v_cvt_pk_bf16_f32 v28, v88, v89
    v_cvt_pk_bf16_f32 v29, v90, v91
    v_cvt_pk_bf16_f32 v30, v92, v93
    v_cvt_pk_bf16_f32 v31, v94, v95
    buffer_store_dwordx4 v[24:27], v2, s[60:63], s70 offen offset:0 sc1
    buffer_store_dwordx4 v[28:31], v2, s[60:63], s70 offen offset:1024 sc1
    s_nop 15
    v_pk_mul_f32 v[32:33], v[96:97], v[96:97]
    v_pk_mul_f32 v[34:35], v[98:99], v[98:99]
    v_pk_mul_f32 v[36:37], v[100:101], v[100:101]
    v_pk_mul_f32 v[38:39], v[102:103], v[102:103]
    v_pk_mul_f32 v[40:41], v[104:105], v[104:105]
    v_pk_mul_f32 v[42:43], v[106:107], v[106:107]
    v_pk_mul_f32 v[44:45], v[108:109], v[108:109]
    v_pk_mul_f32 v[46:47], v[110:111], v[110:111]
    v_pk_fma_f32 v[32:33], v[32:33], v[10:11], v[8:9]
    v_pk_fma_f32 v[34:35], v[34:35], v[10:11], v[8:9]
    v_pk_fma_f32 v[36:37], v[36:37], v[10:11], v[8:9]
    v_pk_fma_f32 v[38:39], v[38:39], v[10:11], v[8:9]
    v_pk_fma_f32 v[40:41], v[40:41], v[10:11], v[8:9]
    v_pk_fma_f32 v[42:43], v[42:43], v[10:11], v[8:9]
    v_pk_fma_f32 v[44:45], v[44:45], v[10:11], v[8:9]
    v_pk_fma_f32 v[46:47], v[46:47], v[10:11], v[8:9]
    v_pk_mul_f32 v[32:33], v[32:33], v[96:97]
    v_pk_mul_f32 v[34:35], v[34:35], v[98:99]
    v_pk_mul_f32 v[36:37], v[36:37], v[100:101]
    v_pk_mul_f32 v[38:39], v[38:39], v[102:103]
    v_pk_mul_f32 v[40:41], v[40:41], v[104:105]
    v_pk_mul_f32 v[42:43], v[42:43], v[106:107]
    v_pk_mul_f32 v[44:45], v[44:45], v[108:109]
    v_pk_mul_f32 v[46:47], v[46:47], v[110:111]
    v_exp_f32 v48, v32
    v_exp_f32 v49, v33
    v_mfma_f32_32x32x16_bf16 v[144:159], a[80:83], a[44:47], v[144:159]
    v_exp_f32 v50, v34
    v_exp_f32 v51, v35
    ds_read_b64_tr_b16 a[80:81], v7 offset:29696
    ds_read_b64_tr_b16 a[82:83], v7 offset:30208
    v_exp_f32 v52, v36
    s_waitcnt lgkmcnt(12)
    v_mfma_f32_32x32x16_bf16 v[128:143], a[84:87], a[48:51], v[128:143]
    v_exp_f32 v53, v37
    v_exp_f32 v54, v38
    v_mfma_f32_32x32x16_bf16 v[144:159], a[84:87], a[52:55], v[144:159]
    v_exp_f32 v55, v39
    v_exp_f32 v56, v40
    ds_read_b64_tr_b16 a[84:85], v7 offset:36864
    ds_read_b64_tr_b16 a[86:87], v7 offset:37376
    v_exp_f32 v57, v41
    s_waitcnt lgkmcnt(12)
    v_mfma_f32_32x32x16_bf16 v[128:143], a[88:91], a[56:59], v[128:143]
    v_exp_f32 v58, v42
    v_exp_f32 v59, v43
    v_mfma_f32_32x32x16_bf16 v[144:159], a[88:91], a[60:63], v[144:159]
    v_exp_f32 v60, v44
    v_exp_f32 v61, v45
    ds_read_b64_tr_b16 a[88:89], v7 offset:44032
    ds_read_b64_tr_b16 a[90:91], v7 offset:44544
    v_exp_f32 v62, v46
    v_exp_f32 v63, v47
    s_waitcnt lgkmcnt(12)
    v_mfma_f32_32x32x16_bf16 v[128:143], a[64:67], a[128:131], v[128:143]
    v_pk_add_f32 v[48:49], v[48:49], v[12:13]
    v_pk_add_f32 v[50:51], v[50:51], v[12:13]
    v_pk_add_f32 v[52:53], v[52:53], v[12:13]
    v_pk_add_f32 v[54:55], v[54:55], v[12:13]
    v_pk_add_f32 v[56:57], v[56:57], v[12:13]
    v_pk_add_f32 v[58:59], v[58:59], v[12:13]
    v_pk_add_f32 v[60:61], v[60:61], v[12:13]
    v_pk_add_f32 v[62:63], v[62:63], v[12:13]
    v_rcp_f32 v32, v48
    v_rcp_f32 v33, v49
    v_mfma_f32_32x32x16_bf16 v[144:159], a[64:67], a[132:135], v[144:159]
    v_rcp_f32 v34, v50
    v_rcp_f32 v35, v51
    ds_read_b64_tr_b16 a[64:65], v7 offset:51200
    ds_read_b64_tr_b16 a[66:67], v7 offset:51712
    v_rcp_f32 v36, v52
    s_waitcnt lgkmcnt(12)
    v_mfma_f32_32x32x16_bf16 v[128:143], a[68:71], a[136:139], v[128:143]
    v_rcp_f32 v37, v53
    v_rcp_f32 v38, v54
    v_mfma_f32_32x32x16_bf16 v[144:159], a[68:71], a[140:143], v[144:159]
    v_rcp_f32 v39, v55
    v_rcp_f32 v40, v56
    ds_read_b64_tr_b16 a[68:69], v5 offset:29952
    ds_read_b64_tr_b16 a[70:71], v5 offset:30464
    v_rcp_f32 v41, v57
    s_waitcnt lgkmcnt(12)
    v_mfma_f32_32x32x16_bf16 v[128:143], a[72:75], a[144:147], v[128:143]
    v_rcp_f32 v42, v58
    v_rcp_f32 v43, v59
    v_mfma_f32_32x32x16_bf16 v[144:159], a[72:75], a[148:151], v[144:159]
    v_rcp_f32 v44, v60
    v_rcp_f32 v45, v61
    ds_read_b64_tr_b16 a[72:73], v5 offset:37120
    ds_read_b64_tr_b16 a[74:75], v5 offset:37632
    v_rcp_f32 v46, v62
    v_rcp_f32 v47, v63
    s_waitcnt lgkmcnt(12)
    v_mfma_f32_32x32x16_bf16 v[128:143], a[76:79], a[152:155], v[128:143]
    v_pk_mul_f32 v[96:97], v[96:97], v[32:33]
    v_pk_mul_f32 v[98:99], v[98:99], v[34:35]
    v_pk_mul_f32 v[100:101], v[100:101], v[36:37]
    v_pk_mul_f32 v[102:103], v[102:103], v[38:39]
    v_pk_mul_f32 v[104:105], v[104:105], v[40:41]
    v_pk_mul_f32 v[106:107], v[106:107], v[42:43]
    v_pk_mul_f32 v[108:109], v[108:109], v[44:45]
    v_pk_mul_f32 v[110:111], v[110:111], v[46:47]
    s_add_u32 s70, s71, 2048
    v_cvt_pk_bf16_f32 v16, v96, v97
    v_cvt_pk_bf16_f32 v17, v98, v99
    v_cvt_pk_bf16_f32 v18, v100, v101
    v_cvt_pk_bf16_f32 v19, v102, v103
    v_cvt_pk_bf16_f32 v20, v104, v105
    v_cvt_pk_bf16_f32 v21, v106, v107
    v_cvt_pk_bf16_f32 v22, v108, v109
    v_cvt_pk_bf16_f32 v23, v110, v111
    buffer_store_dwordx4 v[16:19], v2, s[60:63], s70 offen offset:0 sc1
    buffer_store_dwordx4 v[20:23], v2, s[60:63], s70 offen offset:1024 sc1
    v_pk_mul_f32 v[32:33], v[112:113], v[112:113]
    v_pk_mul_f32 v[34:35], v[114:115], v[114:115]
    v_pk_mul_f32 v[36:37], v[116:117], v[116:117]
    v_pk_mul_f32 v[38:39], v[118:119], v[118:119]
    v_pk_mul_f32 v[40:41], v[120:121], v[120:121]
    v_pk_mul_f32 v[42:43], v[122:123], v[122:123]
    v_pk_mul_f32 v[44:45], v[124:125], v[124:125]
    v_pk_mul_f32 v[46:47], v[126:127], v[126:127]
    v_pk_fma_f32 v[32:33], v[32:33], v[10:11], v[8:9]
    v_pk_fma_f32 v[34:35], v[34:35], v[10:11], v[8:9]
    v_pk_fma_f32 v[36:37], v[36:37], v[10:11], v[8:9]
    v_pk_fma_f32 v[38:39], v[38:39], v[10:11], v[8:9]
    v_pk_fma_f32 v[40:41], v[40:41], v[10:11], v[8:9]
    v_pk_fma_f32 v[42:43], v[42:43], v[10:11], v[8:9]
    v_pk_fma_f32 v[44:45], v[44:45], v[10:11], v[8:9]
    v_pk_fma_f32 v[46:47], v[46:47], v[10:11], v[8:9]
    v_pk_mul_f32 v[32:33], v[32:33], v[112:113]
    v_pk_mul_f32 v[34:35], v[34:35], v[114:115]
    v_pk_mul_f32 v[36:37], v[36:37], v[116:117]
    v_pk_mul_f32 v[38:39], v[38:39], v[118:119]
    v_pk_mul_f32 v[40:41], v[40:41], v[120:121]
    v_pk_mul_f32 v[42:43], v[42:43], v[122:123]
    v_pk_mul_f32 v[44:45], v[44:45], v[124:125]
    v_pk_mul_f32 v[46:47], v[46:47], v[126:127]
    v_exp_f32 v48, v32
    v_exp_f32 v49, v33
    v_mfma_f32_32x32x16_bf16 v[144:159], a[76:79], a[156:159], v[144:159]
    v_exp_f32 v50, v34
    v_exp_f32 v51, v35
    ds_read_b64_tr_b16 a[76:77], v5 offset:44288
    ds_read_b64_tr_b16 a[78:79], v5 offset:44800
    v_exp_f32 v52, v36
    s_waitcnt lgkmcnt(12)
    v_mfma_f32_32x32x16_bf16 v[128:143], a[80:83], a[160:163], v[128:143]
    v_exp_f32 v53, v37
    v_exp_f32 v54, v38
    v_mfma_f32_32x32x16_bf16 v[144:159], a[80:83], a[164:167], v[144:159]
    v_exp_f32 v55, v39
    v_exp_f32 v56, v40
    ds_read_b64_tr_b16 a[80:81], v5 offset:51456
    ds_read_b64_tr_b16 a[82:83], v5 offset:51968
    v_exp_f32 v57, v41
    s_waitcnt lgkmcnt(12)
    v_mfma_f32_32x32x16_bf16 v[128:143], a[84:87], a[168:171], v[128:143]
    v_exp_f32 v58, v42
    v_exp_f32 v59, v43
    v_mfma_f32_32x32x16_bf16 v[144:159], a[84:87], a[172:175], v[144:159]
    v_exp_f32 v60, v44
    v_exp_f32 v61, v45
    ds_read_b64_tr_b16 a[84:85], v7 offset:1280
    ds_read_b64_tr_b16 a[86:87], v7 offset:1792
    v_exp_f32 v62, v46
    v_exp_f32 v63, v47
    s_waitcnt lgkmcnt(12)
    v_mfma_f32_32x32x16_bf16 v[128:143], a[88:91], a[176:179], v[128:143]
    v_pk_add_f32 v[48:49], v[48:49], v[12:13]
    v_pk_add_f32 v[50:51], v[50:51], v[12:13]
    v_pk_add_f32 v[52:53], v[52:53], v[12:13]
    v_pk_add_f32 v[54:55], v[54:55], v[12:13]
    v_pk_add_f32 v[56:57], v[56:57], v[12:13]
    v_pk_add_f32 v[58:59], v[58:59], v[12:13]
    v_pk_add_f32 v[60:61], v[60:61], v[12:13]
    v_pk_add_f32 v[62:63], v[62:63], v[12:13]
    v_rcp_f32 v32, v48
    v_rcp_f32 v33, v49
    v_mfma_f32_32x32x16_bf16 v[144:159], a[88:91], a[180:183], v[144:159]
    v_rcp_f32 v34, v50
    v_rcp_f32 v35, v51
    ds_read_b64_tr_b16 a[88:89], v7 offset:8448
    ds_read_b64_tr_b16 a[90:91], v7 offset:8960
    v_rcp_f32 v36, v52
    s_waitcnt lgkmcnt(12)
    v_mfma_f32_32x32x16_bf16 v[128:143], a[64:67], a[184:187], v[128:143]
    v_rcp_f32 v37, v53
    v_rcp_f32 v38, v54
    v_mfma_f32_32x32x16_bf16 v[144:159], a[64:67], a[188:191], v[144:159]
    v_rcp_f32 v39, v55
    v_rcp_f32 v40, v56
    ds_read_b64_tr_b16 a[64:65], v7 offset:15616
    ds_read_b64_tr_b16 a[66:67], v7 offset:16128
    v_rcp_f32 v41, v57
    s_waitcnt lgkmcnt(12)
    v_mfma_f32_32x32x16_bf16 v[160:175], a[68:71], a[32:35], v[160:175]
    v_rcp_f32 v42, v58
    v_rcp_f32 v43, v59
    v_mfma_f32_32x32x16_bf16 v[176:191], a[68:71], a[36:39], v[176:191]
    v_rcp_f32 v44, v60
    v_rcp_f32 v45, v61
    ds_read_b64_tr_b16 a[68:69], v7 offset:22784
    ds_read_b64_tr_b16 a[70:71], v7 offset:23296
    v_rcp_f32 v46, v62
    v_rcp_f32 v47, v63
    s_waitcnt lgkmcnt(12)
    v_mfma_f32_32x32x16_bf16 v[160:175], a[72:75], a[40:43], v[160:175]
    v_pk_mul_f32 v[112:113], v[112:113], v[32:33]
    v_pk_mul_f32 v[114:115], v[114:115], v[34:35]
    v_pk_mul_f32 v[116:117], v[116:117], v[36:37]
    v_pk_mul_f32 v[118:119], v[118:119], v[38:39]
    v_pk_mul_f32 v[120:121], v[120:121], v[40:41]
    v_pk_mul_f32 v[122:123], v[122:123], v[42:43]
    v_pk_mul_f32 v[124:125], v[124:125], v[44:45]
    v_pk_mul_f32 v[126:127], v[126:127], v[46:47]
    s_add_u32 s70, s71, 296960
    v_cvt_pk_bf16_f32 v24, v112, v113
    v_cvt_pk_bf16_f32 v25, v114, v115
    v_cvt_pk_bf16_f32 v26, v116, v117
    v_cvt_pk_bf16_f32 v27, v118, v119
    v_cvt_pk_bf16_f32 v28, v120, v121
    v_cvt_pk_bf16_f32 v29, v122, v123
    v_cvt_pk_bf16_f32 v30, v124, v125
    v_cvt_pk_bf16_f32 v31, v126, v127
    buffer_store_dwordx4 v[24:27], v2, s[60:63], s70 offen offset:0 sc1
    buffer_store_dwordx4 v[28:31], v2, s[60:63], s70 offen offset:1024 sc1
    s_nop 15
    v_pk_mul_f32 v[32:33], v[128:129], v[128:129]
    v_pk_mul_f32 v[34:35], v[130:131], v[130:131]
    v_pk_mul_f32 v[36:37], v[132:133], v[132:133]
    v_pk_mul_f32 v[38:39], v[134:135], v[134:135]
    v_pk_mul_f32 v[40:41], v[136:137], v[136:137]
    v_pk_mul_f32 v[42:43], v[138:139], v[138:139]
    v_pk_mul_f32 v[44:45], v[140:141], v[140:141]
    v_pk_mul_f32 v[46:47], v[142:143], v[142:143]
    v_pk_fma_f32 v[32:33], v[32:33], v[10:11], v[8:9]
    v_pk_fma_f32 v[34:35], v[34:35], v[10:11], v[8:9]
    v_pk_fma_f32 v[36:37], v[36:37], v[10:11], v[8:9]
    v_pk_fma_f32 v[38:39], v[38:39], v[10:11], v[8:9]
    v_pk_fma_f32 v[40:41], v[40:41], v[10:11], v[8:9]
    v_pk_fma_f32 v[42:43], v[42:43], v[10:11], v[8:9]
    v_pk_fma_f32 v[44:45], v[44:45], v[10:11], v[8:9]
    v_pk_fma_f32 v[46:47], v[46:47], v[10:11], v[8:9]
    v_pk_mul_f32 v[32:33], v[32:33], v[128:129]
    v_pk_mul_f32 v[34:35], v[34:35], v[130:131]
    v_pk_mul_f32 v[36:37], v[36:37], v[132:133]
    v_pk_mul_f32 v[38:39], v[38:39], v[134:135]
    v_pk_mul_f32 v[40:41], v[40:41], v[136:137]
    v_pk_mul_f32 v[42:43], v[42:43], v[138:139]
    v_pk_mul_f32 v[44:45], v[44:45], v[140:141]
    v_pk_mul_f32 v[46:47], v[46:47], v[142:143]
    v_exp_f32 v48, v32
    v_exp_f32 v49, v33
    v_mfma_f32_32x32x16_bf16 v[176:191], a[72:75], a[44:47], v[176:191]
    v_exp_f32 v50, v34
    v_exp_f32 v51, v35
    ds_read_b64_tr_b16 a[72:73], v7 offset:29952
    ds_read_b64_tr_b16 a[74:75], v7 offset:30464
    v_exp_f32 v52, v36
    s_waitcnt lgkmcnt(12)
    v_mfma_f32_32x32x16_bf16 v[160:175], a[76:79], a[48:51], v[160:175]
    v_exp_f32 v53, v37
    v_exp_f32 v54, v38
    v_mfma_f32_32x32x16_bf16 v[176:191], a[76:79], a[52:55], v[176:191]
    v_exp_f32 v55, v39
    v_exp_f32 v56, v40
    ds_read_b64_tr_b16 a[76:77], v7 offset:37120
    ds_read_b64_tr_b16 a[78:79], v7 offset:37632
    v_exp_f32 v57, v41
    s_waitcnt lgkmcnt(12)
    v_mfma_f32_32x32x16_bf16 v[160:175], a[80:83], a[56:59], v[160:175]
    v_exp_f32 v58, v42
    v_exp_f32 v59, v43
    v_mfma_f32_32x32x16_bf16 v[176:191], a[80:83], a[60:63], v[176:191]
    v_exp_f32 v60, v44
    v_exp_f32 v61, v45
    ds_read_b64_tr_b16 a[80:81], v7 offset:44288
    ds_read_b64_tr_b16 a[82:83], v7 offset:44800
    v_exp_f32 v62, v46
    v_exp_f32 v63, v47
    s_waitcnt lgkmcnt(12)
    v_mfma_f32_32x32x16_bf16 v[160:175], a[84:87], a[128:131], v[160:175]
    v_pk_add_f32 v[48:49], v[48:49], v[12:13]
    v_pk_add_f32 v[50:51], v[50:51], v[12:13]
    v_pk_add_f32 v[52:53], v[52:53], v[12:13]
    v_pk_add_f32 v[54:55], v[54:55], v[12:13]
    v_pk_add_f32 v[56:57], v[56:57], v[12:13]
    v_pk_add_f32 v[58:59], v[58:59], v[12:13]
    v_pk_add_f32 v[60:61], v[60:61], v[12:13]
    v_pk_add_f32 v[62:63], v[62:63], v[12:13]
    v_rcp_f32 v32, v48
    v_rcp_f32 v33, v49
    v_mfma_f32_32x32x16_bf16 v[176:191], a[84:87], a[132:135], v[176:191]
    v_rcp_f32 v34, v50
    v_rcp_f32 v35, v51
    ds_read_b64_tr_b16 a[84:85], v7 offset:51456
    ds_read_b64_tr_b16 a[86:87], v7 offset:51968
    v_rcp_f32 v36, v52
    s_waitcnt lgkmcnt(12)
    v_mfma_f32_32x32x16_bf16 v[160:175], a[88:91], a[136:139], v[160:175]
    v_rcp_f32 v37, v53
    v_rcp_f32 v38, v54
    v_mfma_f32_32x32x16_bf16 v[176:191], a[88:91], a[140:143], v[176:191]
    v_rcp_f32 v39, v55
    v_rcp_f32 v40, v56
    ds_read_b64_tr_b16 a[88:89], v5 offset:30720
    ds_read_b64_tr_b16 a[90:91], v5 offset:31232
    v_rcp_f32 v41, v57
    s_waitcnt lgkmcnt(12)
    v_mfma_f32_32x32x16_bf16 v[160:175], a[64:67], a[144:147], v[160:175]
    v_rcp_f32 v42, v58
    v_rcp_f32 v43, v59
    v_mfma_f32_32x32x16_bf16 v[176:191], a[64:67], a[148:151], v[176:191]
    v_rcp_f32 v44, v60
    v_rcp_f32 v45, v61
    ds_read_b64_tr_b16 a[64:65], v5 offset:37888
    ds_read_b64_tr_b16 a[66:67], v5 offset:38400
    v_rcp_f32 v46, v62
    v_rcp_f32 v47, v63
    s_waitcnt lgkmcnt(12)
    v_mfma_f32_32x32x16_bf16 v[160:175], a[68:71], a[152:155], v[160:175]
    v_pk_mul_f32 v[128:129], v[128:129], v[32:33]
    v_pk_mul_f32 v[130:131], v[130:131], v[34:35]
    v_pk_mul_f32 v[132:133], v[132:133], v[36:37]
    v_pk_mul_f32 v[134:135], v[134:135], v[38:39]
    v_pk_mul_f32 v[136:137], v[136:137], v[40:41]
    v_pk_mul_f32 v[138:139], v[138:139], v[42:43]
    v_pk_mul_f32 v[140:141], v[140:141], v[44:45]
    v_pk_mul_f32 v[142:143], v[142:143], v[46:47]
    s_add_u32 s70, s71, 4096
    v_cvt_pk_bf16_f32 v16, v128, v129
    v_cvt_pk_bf16_f32 v17, v130, v131
    v_cvt_pk_bf16_f32 v18, v132, v133
    v_cvt_pk_bf16_f32 v19, v134, v135
    v_cvt_pk_bf16_f32 v20, v136, v137
    v_cvt_pk_bf16_f32 v21, v138, v139
    v_cvt_pk_bf16_f32 v22, v140, v141
    v_cvt_pk_bf16_f32 v23, v142, v143
    buffer_store_dwordx4 v[16:19], v2, s[60:63], s70 offen offset:0 sc1
    buffer_store_dwordx4 v[20:23], v2, s[60:63], s70 offen offset:1024 sc1
    v_pk_mul_f32 v[32:33], v[144:145], v[144:145]
    v_pk_mul_f32 v[34:35], v[146:147], v[146:147]
    v_pk_mul_f32 v[36:37], v[148:149], v[148:149]
    v_pk_mul_f32 v[38:39], v[150:151], v[150:151]
    v_pk_mul_f32 v[40:41], v[152:153], v[152:153]
    v_pk_mul_f32 v[42:43], v[154:155], v[154:155]
    v_pk_mul_f32 v[44:45], v[156:157], v[156:157]
    v_pk_mul_f32 v[46:47], v[158:159], v[158:159]
    v_pk_fma_f32 v[32:33], v[32:33], v[10:11], v[8:9]
    v_pk_fma_f32 v[34:35], v[34:35], v[10:11], v[8:9]
    v_pk_fma_f32 v[36:37], v[36:37], v[10:11], v[8:9]
    v_pk_fma_f32 v[38:39], v[38:39], v[10:11], v[8:9]
    v_pk_fma_f32 v[40:41], v[40:41], v[10:11], v[8:9]
    v_pk_fma_f32 v[42:43], v[42:43], v[10:11], v[8:9]
    v_pk_fma_f32 v[44:45], v[44:45], v[10:11], v[8:9]
    v_pk_fma_f32 v[46:47], v[46:47], v[10:11], v[8:9]
    v_pk_mul_f32 v[32:33], v[32:33], v[144:145]
    v_pk_mul_f32 v[34:35], v[34:35], v[146:147]
    v_pk_mul_f32 v[36:37], v[36:37], v[148:149]
    v_pk_mul_f32 v[38:39], v[38:39], v[150:151]
    v_pk_mul_f32 v[40:41], v[40:41], v[152:153]
    v_pk_mul_f32 v[42:43], v[42:43], v[154:155]
    v_pk_mul_f32 v[44:45], v[44:45], v[156:157]
    v_pk_mul_f32 v[46:47], v[46:47], v[158:159]
    v_exp_f32 v48, v32
    v_exp_f32 v49, v33
    v_mfma_f32_32x32x16_bf16 v[176:191], a[68:71], a[156:159], v[176:191]
    v_exp_f32 v50, v34
    v_exp_f32 v51, v35
    ds_read_b64_tr_b16 a[68:69], v5 offset:45056
    ds_read_b64_tr_b16 a[70:71], v5 offset:45568
    v_exp_f32 v52, v36
    s_waitcnt lgkmcnt(12)
    v_mfma_f32_32x32x16_bf16 v[160:175], a[72:75], a[160:163], v[160:175]
    v_exp_f32 v53, v37
    v_exp_f32 v54, v38
    v_mfma_f32_32x32x16_bf16 v[176:191], a[72:75], a[164:167], v[176:191]
    v_exp_f32 v55, v39
    v_exp_f32 v56, v40
    ds_read_b64_tr_b16 a[72:73], v5 offset:52224
    ds_read_b64_tr_b16 a[74:75], v5 offset:52736
    v_exp_f32 v57, v41
    s_waitcnt lgkmcnt(12)
    v_mfma_f32_32x32x16_bf16 v[160:175], a[76:79], a[168:171], v[160:175]
    v_exp_f32 v58, v42
    v_exp_f32 v59, v43
    v_mfma_f32_32x32x16_bf16 v[176:191], a[76:79], a[172:175], v[176:191]
    v_exp_f32 v60, v44
    v_exp_f32 v61, v45
    ds_read_b64_tr_b16 a[76:77], v7 offset:2048
    ds_read_b64_tr_b16 a[78:79], v7 offset:2560
    v_exp_f32 v62, v46
    v_exp_f32 v63, v47
    s_waitcnt lgkmcnt(12)
    v_mfma_f32_32x32x16_bf16 v[160:175], a[80:83], a[176:179], v[160:175]
    v_pk_add_f32 v[48:49], v[48:49], v[12:13]
    v_pk_add_f32 v[50:51], v[50:51], v[12:13]
    v_pk_add_f32 v[52:53], v[52:53], v[12:13]
    v_pk_add_f32 v[54:55], v[54:55], v[12:13]
    v_pk_add_f32 v[56:57], v[56:57], v[12:13]
    v_pk_add_f32 v[58:59], v[58:59], v[12:13]
    v_pk_add_f32 v[60:61], v[60:61], v[12:13]
    v_pk_add_f32 v[62:63], v[62:63], v[12:13]
    v_rcp_f32 v32, v48
    v_rcp_f32 v33, v49
    v_mfma_f32_32x32x16_bf16 v[176:191], a[80:83], a[180:183], v[176:191]
    v_rcp_f32 v34, v50
    v_rcp_f32 v35, v51
    ds_read_b64_tr_b16 a[80:81], v7 offset:9216
    ds_read_b64_tr_b16 a[82:83], v7 offset:9728
    v_rcp_f32 v36, v52
    s_waitcnt lgkmcnt(12)
    v_mfma_f32_32x32x16_bf16 v[160:175], a[84:87], a[184:187], v[160:175]
    v_rcp_f32 v37, v53
    v_rcp_f32 v38, v54
    v_mfma_f32_32x32x16_bf16 v[176:191], a[84:87], a[188:191], v[176:191]
    v_rcp_f32 v39, v55
    v_rcp_f32 v40, v56
    ds_read_b64_tr_b16 a[84:85], v7 offset:16384
    ds_read_b64_tr_b16 a[86:87], v7 offset:16896
    v_rcp_f32 v41, v57
    s_waitcnt lgkmcnt(12)
    v_mfma_f32_32x32x16_bf16 v[192:207], a[88:91], a[32:35], v[192:207]
    v_rcp_f32 v42, v58
    v_rcp_f32 v43, v59
    v_mfma_f32_32x32x16_bf16 v[208:223], a[88:91], a[36:39], v[208:223]
    v_rcp_f32 v44, v60
    v_rcp_f32 v45, v61
    ds_read_b64_tr_b16 a[88:89], v7 offset:23552
    ds_read_b64_tr_b16 a[90:91], v7 offset:24064
    v_rcp_f32 v46, v62
    v_rcp_f32 v47, v63
    s_waitcnt lgkmcnt(12)
    v_mfma_f32_32x32x16_bf16 v[192:207], a[64:67], a[40:43], v[192:207]
    v_pk_mul_f32 v[144:145], v[144:145], v[32:33]
    v_pk_mul_f32 v[146:147], v[146:147], v[34:35]
    v_pk_mul_f32 v[148:149], v[148:149], v[36:37]
    v_pk_mul_f32 v[150:151], v[150:151], v[38:39]
    v_pk_mul_f32 v[152:153], v[152:153], v[40:41]
    v_pk_mul_f32 v[154:155], v[154:155], v[42:43]
    v_pk_mul_f32 v[156:157], v[156:157], v[44:45]
    v_pk_mul_f32 v[158:159], v[158:159], v[46:47]
    s_add_u32 s70, s71, 299008
    v_cvt_pk_bf16_f32 v24, v144, v145
    v_cvt_pk_bf16_f32 v25, v146, v147
    v_cvt_pk_bf16_f32 v26, v148, v149
    v_cvt_pk_bf16_f32 v27, v150, v151
    v_cvt_pk_bf16_f32 v28, v152, v153
    v_cvt_pk_bf16_f32 v29, v154, v155
    v_cvt_pk_bf16_f32 v30, v156, v157
    v_cvt_pk_bf16_f32 v31, v158, v159
    buffer_store_dwordx4 v[24:27], v2, s[60:63], s70 offen offset:0 sc1
    buffer_store_dwordx4 v[28:31], v2, s[60:63], s70 offen offset:1024 sc1
    s_nop 15
    v_pk_mul_f32 v[32:33], v[160:161], v[160:161]
    v_pk_mul_f32 v[34:35], v[162:163], v[162:163]
    v_pk_mul_f32 v[36:37], v[164:165], v[164:165]
    v_pk_mul_f32 v[38:39], v[166:167], v[166:167]
    v_pk_mul_f32 v[40:41], v[168:169], v[168:169]
    v_pk_mul_f32 v[42:43], v[170:171], v[170:171]
    v_pk_mul_f32 v[44:45], v[172:173], v[172:173]
    v_pk_mul_f32 v[46:47], v[174:175], v[174:175]
    v_pk_fma_f32 v[32:33], v[32:33], v[10:11], v[8:9]
    v_pk_fma_f32 v[34:35], v[34:35], v[10:11], v[8:9]
    v_pk_fma_f32 v[36:37], v[36:37], v[10:11], v[8:9]
    v_pk_fma_f32 v[38:39], v[38:39], v[10:11], v[8:9]
    v_pk_fma_f32 v[40:41], v[40:41], v[10:11], v[8:9]
    v_pk_fma_f32 v[42:43], v[42:43], v[10:11], v[8:9]
    v_pk_fma_f32 v[44:45], v[44:45], v[10:11], v[8:9]
    v_pk_fma_f32 v[46:47], v[46:47], v[10:11], v[8:9]
    v_pk_mul_f32 v[32:33], v[32:33], v[160:161]
    v_pk_mul_f32 v[34:35], v[34:35], v[162:163]
    v_pk_mul_f32 v[36:37], v[36:37], v[164:165]
    v_pk_mul_f32 v[38:39], v[38:39], v[166:167]
    v_pk_mul_f32 v[40:41], v[40:41], v[168:169]
    v_pk_mul_f32 v[42:43], v[42:43], v[170:171]
    v_pk_mul_f32 v[44:45], v[44:45], v[172:173]
    v_pk_mul_f32 v[46:47], v[46:47], v[174:175]
    v_exp_f32 v48, v32
    v_exp_f32 v49, v33
    v_mfma_f32_32x32x16_bf16 v[208:223], a[64:67], a[44:47], v[208:223]
    v_exp_f32 v50, v34
    v_exp_f32 v51, v35
    ds_read_b64_tr_b16 a[64:65], v7 offset:30720
    ds_read_b64_tr_b16 a[66:67], v7 offset:31232
    v_exp_f32 v52, v36
    s_waitcnt lgkmcnt(12)
    v_mfma_f32_32x32x16_bf16 v[192:207], a[68:71], a[48:51], v[192:207]
    v_exp_f32 v53, v37
    v_exp_f32 v54, v38
    v_mfma_f32_32x32x16_bf16 v[208:223], a[68:71], a[52:55], v[208:223]
    v_exp_f32 v55, v39
    v_exp_f32 v56, v40
    ds_read_b64_tr_b16 a[68:69], v7 offset:37888
    ds_read_b64_tr_b16 a[70:71], v7 offset:38400
    v_exp_f32 v57, v41
    s_waitcnt lgkmcnt(12)
    v_mfma_f32_32x32x16_bf16 v[192:207], a[72:75], a[56:59], v[192:207]
    v_exp_f32 v58, v42
    v_exp_f32 v59, v43
    v_mfma_f32_32x32x16_bf16 v[208:223], a[72:75], a[60:63], v[208:223]
    v_exp_f32 v60, v44
    v_exp_f32 v61, v45
    ds_read_b64_tr_b16 a[72:73], v7 offset:45056
    ds_read_b64_tr_b16 a[74:75], v7 offset:45568
    v_exp_f32 v62, v46
    v_exp_f32 v63, v47
    s_waitcnt lgkmcnt(12)
    v_mfma_f32_32x32x16_bf16 v[192:207], a[76:79], a[128:131], v[192:207]
    v_pk_add_f32 v[48:49], v[48:49], v[12:13]
    v_pk_add_f32 v[50:51], v[50:51], v[12:13]
    v_pk_add_f32 v[52:53], v[52:53], v[12:13]
    v_pk_add_f32 v[54:55], v[54:55], v[12:13]
    v_pk_add_f32 v[56:57], v[56:57], v[12:13]
    v_pk_add_f32 v[58:59], v[58:59], v[12:13]
    v_pk_add_f32 v[60:61], v[60:61], v[12:13]
    v_pk_add_f32 v[62:63], v[62:63], v[12:13]
    v_rcp_f32 v32, v48
    v_rcp_f32 v33, v49
    v_mfma_f32_32x32x16_bf16 v[208:223], a[76:79], a[132:135], v[208:223]
    v_rcp_f32 v34, v50
    v_rcp_f32 v35, v51
    ds_read_b64_tr_b16 a[76:77], v7 offset:52224
    ds_read_b64_tr_b16 a[78:79], v7 offset:52736
    v_rcp_f32 v36, v52
    s_waitcnt lgkmcnt(12)
    v_mfma_f32_32x32x16_bf16 v[192:207], a[80:83], a[136:139], v[192:207]
    v_rcp_f32 v37, v53
    v_rcp_f32 v38, v54
    v_mfma_f32_32x32x16_bf16 v[208:223], a[80:83], a[140:143], v[208:223]
    v_rcp_f32 v39, v55
    v_rcp_f32 v40, v56
    ds_read_b64_tr_b16 a[80:81], v5 offset:30976
    ds_read_b64_tr_b16 a[82:83], v5 offset:31488
    v_rcp_f32 v41, v57
    s_waitcnt lgkmcnt(12)
    v_mfma_f32_32x32x16_bf16 v[192:207], a[84:87], a[144:147], v[192:207]
    v_rcp_f32 v42, v58
    v_rcp_f32 v43, v59
    v_mfma_f32_32x32x16_bf16 v[208:223], a[84:87], a[148:151], v[208:223]
    v_rcp_f32 v44, v60
    v_rcp_f32 v45, v61
    ds_read_b64_tr_b16 a[84:85], v5 offset:38144
    ds_read_b64_tr_b16 a[86:87], v5 offset:38656
    v_rcp_f32 v46, v62
    v_rcp_f32 v47, v63
    s_waitcnt lgkmcnt(12)
    v_mfma_f32_32x32x16_bf16 v[192:207], a[88:91], a[152:155], v[192:207]
    v_pk_mul_f32 v[160:161], v[160:161], v[32:33]
    v_pk_mul_f32 v[162:163], v[162:163], v[34:35]
    v_pk_mul_f32 v[164:165], v[164:165], v[36:37]
    v_pk_mul_f32 v[166:167], v[166:167], v[38:39]
    v_pk_mul_f32 v[168:169], v[168:169], v[40:41]
    v_pk_mul_f32 v[170:171], v[170:171], v[42:43]
    v_pk_mul_f32 v[172:173], v[172:173], v[44:45]
    v_pk_mul_f32 v[174:175], v[174:175], v[46:47]
    s_add_u32 s70, s71, 6144
    v_cvt_pk_bf16_f32 v16, v160, v161
    v_cvt_pk_bf16_f32 v17, v162, v163
    v_cvt_pk_bf16_f32 v18, v164, v165
    v_cvt_pk_bf16_f32 v19, v166, v167
    v_cvt_pk_bf16_f32 v20, v168, v169
    v_cvt_pk_bf16_f32 v21, v170, v171
    v_cvt_pk_bf16_f32 v22, v172, v173
    v_cvt_pk_bf16_f32 v23, v174, v175
    buffer_store_dwordx4 v[16:19], v2, s[60:63], s70 offen offset:0 sc1
    buffer_store_dwordx4 v[20:23], v2, s[60:63], s70 offen offset:1024 sc1
    v_pk_mul_f32 v[32:33], v[176:177], v[176:177]
    v_pk_mul_f32 v[34:35], v[178:179], v[178:179]
    v_pk_mul_f32 v[36:37], v[180:181], v[180:181]
    v_pk_mul_f32 v[38:39], v[182:183], v[182:183]
    v_pk_mul_f32 v[40:41], v[184:185], v[184:185]
    v_pk_mul_f32 v[42:43], v[186:187], v[186:187]
    v_pk_mul_f32 v[44:45], v[188:189], v[188:189]
    v_pk_mul_f32 v[46:47], v[190:191], v[190:191]
    v_pk_fma_f32 v[32:33], v[32:33], v[10:11], v[8:9]
    v_pk_fma_f32 v[34:35], v[34:35], v[10:11], v[8:9]
    v_pk_fma_f32 v[36:37], v[36:37], v[10:11], v[8:9]
    v_pk_fma_f32 v[38:39], v[38:39], v[10:11], v[8:9]
    v_pk_fma_f32 v[40:41], v[40:41], v[10:11], v[8:9]
    v_pk_fma_f32 v[42:43], v[42:43], v[10:11], v[8:9]
    v_pk_fma_f32 v[44:45], v[44:45], v[10:11], v[8:9]
    v_pk_fma_f32 v[46:47], v[46:47], v[10:11], v[8:9]
    v_pk_mul_f32 v[32:33], v[32:33], v[176:177]
    v_pk_mul_f32 v[34:35], v[34:35], v[178:179]
    v_pk_mul_f32 v[36:37], v[36:37], v[180:181]
    v_pk_mul_f32 v[38:39], v[38:39], v[182:183]
    v_pk_mul_f32 v[40:41], v[40:41], v[184:185]
    v_pk_mul_f32 v[42:43], v[42:43], v[186:187]
    v_pk_mul_f32 v[44:45], v[44:45], v[188:189]
    v_pk_mul_f32 v[46:47], v[46:47], v[190:191]
    v_exp_f32 v48, v32
    v_exp_f32 v49, v33
    v_mfma_f32_32x32x16_bf16 v[208:223], a[88:91], a[156:159], v[208:223]
    v_exp_f32 v50, v34
    v_exp_f32 v51, v35
    ds_read_b64_tr_b16 a[88:89], v5 offset:45312
    ds_read_b64_tr_b16 a[90:91], v5 offset:45824
    v_exp_f32 v52, v36
    s_waitcnt lgkmcnt(12)
    v_mfma_f32_32x32x16_bf16 v[192:207], a[64:67], a[160:163], v[192:207]
    v_exp_f32 v53, v37
    v_exp_f32 v54, v38
    v_mfma_f32_32x32x16_bf16 v[208:223], a[64:67], a[164:167], v[208:223]
    v_exp_f32 v55, v39
    v_exp_f32 v56, v40
    ds_read_b64_tr_b16 a[64:65], v5 offset:52480
    ds_read_b64_tr_b16 a[66:67], v5 offset:52992
    v_exp_f32 v57, v41
    s_waitcnt lgkmcnt(12)
    v_mfma_f32_32x32x16_bf16 v[192:207], a[68:71], a[168:171], v[192:207]
    v_exp_f32 v58, v42
    v_exp_f32 v59, v43
    v_mfma_f32_32x32x16_bf16 v[208:223], a[68:71], a[172:175], v[208:223]
    v_exp_f32 v60, v44
    v_exp_f32 v61, v45
    ds_read_b64_tr_b16 a[68:69], v7 offset:2304
    ds_read_b64_tr_b16 a[70:71], v7 offset:2816
    v_exp_f32 v62, v46
    v_exp_f32 v63, v47
    s_waitcnt lgkmcnt(12)
    v_mfma_f32_32x32x16_bf16 v[192:207], a[72:75], a[176:179], v[192:207]
    v_pk_add_f32 v[48:49], v[48:49], v[12:13]
    v_pk_add_f32 v[50:51], v[50:51], v[12:13]
    v_pk_add_f32 v[52:53], v[52:53], v[12:13]
    v_pk_add_f32 v[54:55], v[54:55], v[12:13]
    v_pk_add_f32 v[56:57], v[56:57], v[12:13]
    v_pk_add_f32 v[58:59], v[58:59], v[12:13]
    v_pk_add_f32 v[60:61], v[60:61], v[12:13]
    v_pk_add_f32 v[62:63], v[62:63], v[12:13]
    v_rcp_f32 v32, v48
    v_rcp_f32 v33, v49
    v_mfma_f32_32x32x16_bf16 v[208:223], a[72:75], a[180:183], v[208:223]
    v_rcp_f32 v34, v50
    v_rcp_f32 v35, v51
    ds_read_b64_tr_b16 a[72:73], v7 offset:9472
    ds_read_b64_tr_b16 a[74:75], v7 offset:9984
    v_rcp_f32 v36, v52
    s_waitcnt lgkmcnt(12)
    v_mfma_f32_32x32x16_bf16 v[192:207], a[76:79], a[184:187], v[192:207]
    v_rcp_f32 v37, v53
    v_rcp_f32 v38, v54
    v_mfma_f32_32x32x16_bf16 v[208:223], a[76:79], a[188:191], v[208:223]
    v_rcp_f32 v39, v55
    v_rcp_f32 v40, v56
    ds_read_b64_tr_b16 a[76:77], v7 offset:16640
    ds_read_b64_tr_b16 a[78:79], v7 offset:17152
    v_rcp_f32 v41, v57
    s_waitcnt lgkmcnt(12)
    v_mfma_f32_32x32x16_bf16 v[224:239], a[80:83], a[32:35], v[224:239]
    v_rcp_f32 v42, v58
    v_rcp_f32 v43, v59
    v_mfma_f32_32x32x16_bf16 v[240:255], a[80:83], a[36:39], v[240:255]
    v_rcp_f32 v44, v60
    v_rcp_f32 v45, v61
    ds_read_b64_tr_b16 a[80:81], v7 offset:23808
    ds_read_b64_tr_b16 a[82:83], v7 offset:24320
    v_rcp_f32 v46, v62
    v_rcp_f32 v47, v63
    s_waitcnt lgkmcnt(12)
    v_mfma_f32_32x32x16_bf16 v[224:239], a[84:87], a[40:43], v[224:239]
    v_pk_mul_f32 v[176:177], v[176:177], v[32:33]
    v_pk_mul_f32 v[178:179], v[178:179], v[34:35]
    v_pk_mul_f32 v[180:181], v[180:181], v[36:37]
    v_pk_mul_f32 v[182:183], v[182:183], v[38:39]
    v_pk_mul_f32 v[184:185], v[184:185], v[40:41]
    v_pk_mul_f32 v[186:187], v[186:187], v[42:43]
    v_pk_mul_f32 v[188:189], v[188:189], v[44:45]
    v_pk_mul_f32 v[190:191], v[190:191], v[46:47]
    s_add_u32 s70, s71, 301056
    v_cvt_pk_bf16_f32 v24, v176, v177
    v_cvt_pk_bf16_f32 v25, v178, v179
    v_cvt_pk_bf16_f32 v26, v180, v181
    v_cvt_pk_bf16_f32 v27, v182, v183
    v_cvt_pk_bf16_f32 v28, v184, v185
    v_cvt_pk_bf16_f32 v29, v186, v187
    v_cvt_pk_bf16_f32 v30, v188, v189
    v_cvt_pk_bf16_f32 v31, v190, v191
    buffer_store_dwordx4 v[24:27], v2, s[60:63], s70 offen offset:0 sc1
    buffer_store_dwordx4 v[28:31], v2, s[60:63], s70 offen offset:1024 sc1
    s_nop 15
    v_pk_mul_f32 v[32:33], v[192:193], v[192:193]
    v_pk_mul_f32 v[34:35], v[194:195], v[194:195]
    v_pk_mul_f32 v[36:37], v[196:197], v[196:197]
    v_pk_mul_f32 v[38:39], v[198:199], v[198:199]
    v_pk_mul_f32 v[40:41], v[200:201], v[200:201]
    v_pk_mul_f32 v[42:43], v[202:203], v[202:203]
    v_pk_mul_f32 v[44:45], v[204:205], v[204:205]
    v_pk_mul_f32 v[46:47], v[206:207], v[206:207]
    v_pk_fma_f32 v[32:33], v[32:33], v[10:11], v[8:9]
    v_pk_fma_f32 v[34:35], v[34:35], v[10:11], v[8:9]
    v_pk_fma_f32 v[36:37], v[36:37], v[10:11], v[8:9]
    v_pk_fma_f32 v[38:39], v[38:39], v[10:11], v[8:9]
    v_pk_fma_f32 v[40:41], v[40:41], v[10:11], v[8:9]
    v_pk_fma_f32 v[42:43], v[42:43], v[10:11], v[8:9]
    v_pk_fma_f32 v[44:45], v[44:45], v[10:11], v[8:9]
    v_pk_fma_f32 v[46:47], v[46:47], v[10:11], v[8:9]
    v_pk_mul_f32 v[32:33], v[32:33], v[192:193]
    v_pk_mul_f32 v[34:35], v[34:35], v[194:195]
    v_pk_mul_f32 v[36:37], v[36:37], v[196:197]
    v_pk_mul_f32 v[38:39], v[38:39], v[198:199]
    v_pk_mul_f32 v[40:41], v[40:41], v[200:201]
    v_pk_mul_f32 v[42:43], v[42:43], v[202:203]
    v_pk_mul_f32 v[44:45], v[44:45], v[204:205]
    v_pk_mul_f32 v[46:47], v[46:47], v[206:207]
    v_exp_f32 v48, v32
    v_exp_f32 v49, v33
    v_mfma_f32_32x32x16_bf16 v[240:255], a[84:87], a[44:47], v[240:255]
    v_exp_f32 v50, v34
    v_exp_f32 v51, v35
    ds_read_b64_tr_b16 a[84:85], v7 offset:30976
    ds_read_b64_tr_b16 a[86:87], v7 offset:31488
    v_exp_f32 v52, v36
    s_waitcnt lgkmcnt(12)
    v_mfma_f32_32x32x16_bf16 v[224:239], a[88:91], a[48:51], v[224:239]
    v_exp_f32 v53, v37
    v_exp_f32 v54, v38
    v_mfma_f32_32x32x16_bf16 v[240:255], a[88:91], a[52:55], v[240:255]
    v_exp_f32 v55, v39
    v_exp_f32 v56, v40
    ds_read_b64_tr_b16 a[88:89], v7 offset:38144
    ds_read_b64_tr_b16 a[90:91], v7 offset:38656
    v_exp_f32 v57, v41
    s_waitcnt lgkmcnt(12)
    v_mfma_f32_32x32x16_bf16 v[224:239], a[64:67], a[56:59], v[224:239]
    v_exp_f32 v58, v42
    v_exp_f32 v59, v43
    v_mfma_f32_32x32x16_bf16 v[240:255], a[64:67], a[60:63], v[240:255]
    v_exp_f32 v60, v44
    v_exp_f32 v61, v45
    ds_read_b64_tr_b16 a[64:65], v7 offset:45312
    ds_read_b64_tr_b16 a[66:67], v7 offset:45824
    v_exp_f32 v62, v46
    v_exp_f32 v63, v47
    s_waitcnt lgkmcnt(12)
    v_mfma_f32_32x32x16_bf16 v[224:239], a[68:71], a[128:131], v[224:239]
    v_pk_add_f32 v[48:49], v[48:49], v[12:13]
    v_pk_add_f32 v[50:51], v[50:51], v[12:13]
    v_pk_add_f32 v[52:53], v[52:53], v[12:13]
    v_pk_add_f32 v[54:55], v[54:55], v[12:13]
    v_pk_add_f32 v[56:57], v[56:57], v[12:13]
    v_pk_add_f32 v[58:59], v[58:59], v[12:13]
    v_pk_add_f32 v[60:61], v[60:61], v[12:13]
    v_pk_add_f32 v[62:63], v[62:63], v[12:13]
    v_rcp_f32 v32, v48
    v_rcp_f32 v33, v49
    v_mfma_f32_32x32x16_bf16 v[240:255], a[68:71], a[132:135], v[240:255]
    v_rcp_f32 v34, v50
    v_rcp_f32 v35, v51
    ds_read_b64_tr_b16 a[68:69], v7 offset:52480
    ds_read_b64_tr_b16 a[70:71], v7 offset:52992
    v_rcp_f32 v36, v52
    s_waitcnt lgkmcnt(12)
    v_mfma_f32_32x32x16_bf16 v[224:239], a[72:75], a[136:139], v[224:239]
    v_rcp_f32 v37, v53
    v_rcp_f32 v38, v54
    v_mfma_f32_32x32x16_bf16 v[240:255], a[72:75], a[140:143], v[240:255]
    v_rcp_f32 v39, v55
    v_rcp_f32 v40, v56
    ds_read_b64_tr_b16 a[72:73], v14 offset:34816
    ds_read_b64_tr_b16 a[74:75], v14 offset:35072
    v_rcp_f32 v41, v57
    s_waitcnt lgkmcnt(12)
    v_mfma_f32_32x32x16_bf16 v[224:239], a[76:79], a[144:147], v[224:239]
    v_rcp_f32 v42, v58
    v_rcp_f32 v43, v59
    v_mfma_f32_32x32x16_bf16 v[240:255], a[76:79], a[148:151], v[240:255]
    v_rcp_f32 v44, v60
    v_rcp_f32 v45, v61
    ds_read_b64_tr_b16 a[76:77], v14 offset:41984
    ds_read_b64_tr_b16 a[78:79], v14 offset:42240
    v_rcp_f32 v46, v62
    v_rcp_f32 v47, v63
    s_waitcnt lgkmcnt(12)
    v_mfma_f32_32x32x16_bf16 v[224:239], a[80:83], a[152:155], v[224:239]
    v_pk_mul_f32 v[192:193], v[192:193], v[32:33]
    v_pk_mul_f32 v[194:195], v[194:195], v[34:35]
    v_pk_mul_f32 v[196:197], v[196:197], v[36:37]
    v_pk_mul_f32 v[198:199], v[198:199], v[38:39]
    v_pk_mul_f32 v[200:201], v[200:201], v[40:41]
    v_pk_mul_f32 v[202:203], v[202:203], v[42:43]
    v_pk_mul_f32 v[204:205], v[204:205], v[44:45]
    v_pk_mul_f32 v[206:207], v[206:207], v[46:47]
    s_add_u32 s70, s71, 8192
    v_cvt_pk_bf16_f32 v16, v192, v193
    v_cvt_pk_bf16_f32 v17, v194, v195
    v_cvt_pk_bf16_f32 v18, v196, v197
    v_cvt_pk_bf16_f32 v19, v198, v199
    v_cvt_pk_bf16_f32 v20, v200, v201
    v_cvt_pk_bf16_f32 v21, v202, v203
    v_cvt_pk_bf16_f32 v22, v204, v205
    v_cvt_pk_bf16_f32 v23, v206, v207
    buffer_store_dwordx4 v[16:19], v2, s[60:63], s70 offen offset:0 sc1
    buffer_store_dwordx4 v[20:23], v2, s[60:63], s70 offen offset:1024 sc1
    v_pk_mul_f32 v[32:33], v[208:209], v[208:209]
    v_pk_mul_f32 v[34:35], v[210:211], v[210:211]
    v_pk_mul_f32 v[36:37], v[212:213], v[212:213]
    v_pk_mul_f32 v[38:39], v[214:215], v[214:215]
    v_pk_mul_f32 v[40:41], v[216:217], v[216:217]
    v_pk_mul_f32 v[42:43], v[218:219], v[218:219]
    v_pk_mul_f32 v[44:45], v[220:221], v[220:221]
    v_pk_mul_f32 v[46:47], v[222:223], v[222:223]
    v_pk_fma_f32 v[32:33], v[32:33], v[10:11], v[8:9]
    v_pk_fma_f32 v[34:35], v[34:35], v[10:11], v[8:9]
    v_pk_fma_f32 v[36:37], v[36:37], v[10:11], v[8:9]
    v_pk_fma_f32 v[38:39], v[38:39], v[10:11], v[8:9]
    v_pk_fma_f32 v[40:41], v[40:41], v[10:11], v[8:9]
    v_pk_fma_f32 v[42:43], v[42:43], v[10:11], v[8:9]
    v_pk_fma_f32 v[44:45], v[44:45], v[10:11], v[8:9]
    v_pk_fma_f32 v[46:47], v[46:47], v[10:11], v[8:9]
    v_pk_mul_f32 v[32:33], v[32:33], v[208:209]
    v_pk_mul_f32 v[34:35], v[34:35], v[210:211]
    v_pk_mul_f32 v[36:37], v[36:37], v[212:213]
    v_pk_mul_f32 v[38:39], v[38:39], v[214:215]
    v_pk_mul_f32 v[40:41], v[40:41], v[216:217]
    v_pk_mul_f32 v[42:43], v[42:43], v[218:219]
    v_pk_mul_f32 v[44:45], v[44:45], v[220:221]
    v_pk_mul_f32 v[46:47], v[46:47], v[222:223]
    v_exp_f32 v48, v32
    v_exp_f32 v49, v33
    v_mfma_f32_32x32x16_bf16 v[240:255], a[80:83], a[156:159], v[240:255]
    v_exp_f32 v50, v34
    v_exp_f32 v51, v35
    ds_read_b64_tr_b16 a[80:81], v14 offset:49152
    ds_read_b64_tr_b16 a[82:83], v14 offset:49408
    v_exp_f32 v52, v36
    s_waitcnt lgkmcnt(12)
    v_mfma_f32_32x32x16_bf16 v[224:239], a[84:87], a[160:163], v[224:239]
    v_exp_f32 v53, v37
    v_exp_f32 v54, v38
    v_mfma_f32_32x32x16_bf16 v[240:255], a[84:87], a[164:167], v[240:255]
    v_exp_f32 v55, v39
    v_exp_f32 v56, v40
    ds_read_b64_tr_b16 a[84:85], v14 offset:56320
    ds_read_b64_tr_b16 a[86:87], v14 offset:56576
    v_exp_f32 v57, v41
    s_waitcnt lgkmcnt(12)
    v_mfma_f32_32x32x16_bf16 v[224:239], a[88:91], a[168:171], v[224:239]
    v_exp_f32 v58, v42
    v_exp_f32 v59, v43
    v_mfma_f32_32x32x16_bf16 v[240:255], a[88:91], a[172:175], v[240:255]
    v_exp_f32 v60, v44
    v_exp_f32 v61, v45
    ds_read_b64_tr_b16 a[88:89], v15 offset:6144
    ds_read_b64_tr_b16 a[90:91], v15 offset:6400
    v_exp_f32 v62, v46
    v_exp_f32 v63, v47
    s_waitcnt lgkmcnt(12)
    v_mfma_f32_32x32x16_bf16 v[224:239], a[64:67], a[176:179], v[224:239]
    v_pk_add_f32 v[48:49], v[48:49], v[12:13]
    v_pk_add_f32 v[50:51], v[50:51], v[12:13]
    v_pk_add_f32 v[52:53], v[52:53], v[12:13]
    v_pk_add_f32 v[54:55], v[54:55], v[12:13]
    v_pk_add_f32 v[56:57], v[56:57], v[12:13]
    v_pk_add_f32 v[58:59], v[58:59], v[12:13]
    v_pk_add_f32 v[60:61], v[60:61], v[12:13]
    v_pk_add_f32 v[62:63], v[62:63], v[12:13]
    v_rcp_f32 v32, v48
    v_rcp_f32 v33, v49
    v_mfma_f32_32x32x16_bf16 v[240:255], a[64:67], a[180:183], v[240:255]
    v_rcp_f32 v34, v50
    v_rcp_f32 v35, v51
    ds_read_b64_tr_b16 a[64:65], v15 offset:13312
    ds_read_b64_tr_b16 a[66:67], v15 offset:13568
    v_rcp_f32 v36, v52
    s_waitcnt lgkmcnt(12)
    v_mfma_f32_32x32x16_bf16 v[224:239], a[68:71], a[184:187], v[224:239]
    v_rcp_f32 v37, v53
    v_rcp_f32 v38, v54
    v_mfma_f32_32x32x16_bf16 v[240:255], a[68:71], a[188:191], v[240:255]
    v_rcp_f32 v39, v55
    v_rcp_f32 v40, v56
    ds_read_b64_tr_b16 a[68:69], v15 offset:20480
    ds_read_b64_tr_b16 a[70:71], v15 offset:20736
    v_rcp_f32 v41, v57
    s_waitcnt lgkmcnt(12)
    v_mfma_f32_32x32x16_bf16 a[96:111], a[72:75], a[32:35], a[96:111]
    v_rcp_f32 v42, v58
    v_rcp_f32 v43, v59
    v_mfma_f32_32x32x16_bf16 a[112:127], a[72:75], a[36:39], a[112:127]
    v_rcp_f32 v44, v60
    v_rcp_f32 v45, v61
    ds_read_b64_tr_b16 a[72:73], v15 offset:27648
    ds_read_b64_tr_b16 a[74:75], v15 offset:27904
    v_rcp_f32 v46, v62
    v_rcp_f32 v47, v63
    s_waitcnt lgkmcnt(12)
    v_mfma_f32_32x32x16_bf16 a[96:111], a[76:79], a[40:43], a[96:111]
    v_pk_mul_f32 v[208:209], v[208:209], v[32:33]
    v_pk_mul_f32 v[210:211], v[210:211], v[34:35]
    v_pk_mul_f32 v[212:213], v[212:213], v[36:37]
    v_pk_mul_f32 v[214:215], v[214:215], v[38:39]
    v_pk_mul_f32 v[216:217], v[216:217], v[40:41]
    v_pk_mul_f32 v[218:219], v[218:219], v[42:43]
    v_pk_mul_f32 v[220:221], v[220:221], v[44:45]
    v_pk_mul_f32 v[222:223], v[222:223], v[46:47]
    s_add_u32 s70, s71, 303104
    v_cvt_pk_bf16_f32 v24, v208, v209
    v_cvt_pk_bf16_f32 v25, v210, v211
    v_cvt_pk_bf16_f32 v26, v212, v213
    v_cvt_pk_bf16_f32 v27, v214, v215
    v_cvt_pk_bf16_f32 v28, v216, v217
    v_cvt_pk_bf16_f32 v29, v218, v219
    v_cvt_pk_bf16_f32 v30, v220, v221
    v_cvt_pk_bf16_f32 v31, v222, v223
    buffer_store_dwordx4 v[24:27], v2, s[60:63], s70 offen offset:0 sc1
    buffer_store_dwordx4 v[28:31], v2, s[60:63], s70 offen offset:1024 sc1
    s_nop 15
    v_pk_mul_f32 v[32:33], v[224:225], v[224:225]
    v_pk_mul_f32 v[34:35], v[226:227], v[226:227]
    v_pk_mul_f32 v[36:37], v[228:229], v[228:229]
    v_pk_mul_f32 v[38:39], v[230:231], v[230:231]
    v_pk_mul_f32 v[40:41], v[232:233], v[232:233]
    v_pk_mul_f32 v[42:43], v[234:235], v[234:235]
    v_pk_mul_f32 v[44:45], v[236:237], v[236:237]
    v_pk_mul_f32 v[46:47], v[238:239], v[238:239]
    v_pk_fma_f32 v[32:33], v[32:33], v[10:11], v[8:9]
    v_pk_fma_f32 v[34:35], v[34:35], v[10:11], v[8:9]
    v_pk_fma_f32 v[36:37], v[36:37], v[10:11], v[8:9]
    v_pk_fma_f32 v[38:39], v[38:39], v[10:11], v[8:9]
    v_pk_fma_f32 v[40:41], v[40:41], v[10:11], v[8:9]
    v_pk_fma_f32 v[42:43], v[42:43], v[10:11], v[8:9]
    v_pk_fma_f32 v[44:45], v[44:45], v[10:11], v[8:9]
    v_pk_fma_f32 v[46:47], v[46:47], v[10:11], v[8:9]
    v_pk_mul_f32 v[32:33], v[32:33], v[224:225]
    v_pk_mul_f32 v[34:35], v[34:35], v[226:227]
    v_pk_mul_f32 v[36:37], v[36:37], v[228:229]
    v_pk_mul_f32 v[38:39], v[38:39], v[230:231]
    v_pk_mul_f32 v[40:41], v[40:41], v[232:233]
    v_pk_mul_f32 v[42:43], v[42:43], v[234:235]
    v_pk_mul_f32 v[44:45], v[44:45], v[236:237]
    v_pk_mul_f32 v[46:47], v[46:47], v[238:239]
    v_exp_f32 v48, v32
    v_exp_f32 v49, v33
    v_mfma_f32_32x32x16_bf16 a[112:127], a[76:79], a[44:47], a[112:127]
    v_exp_f32 v50, v34
    v_exp_f32 v51, v35
    ds_read_b64_tr_b16 a[76:77], v15 offset:34816
    ds_read_b64_tr_b16 a[78:79], v15 offset:35072
    v_exp_f32 v52, v36
    s_waitcnt lgkmcnt(12)
    v_mfma_f32_32x32x16_bf16 a[96:111], a[80:83], a[48:51], a[96:111]
    v_exp_f32 v53, v37
    v_exp_f32 v54, v38
    v_mfma_f32_32x32x16_bf16 a[112:127], a[80:83], a[52:55], a[112:127]
    v_exp_f32 v55, v39
    v_exp_f32 v56, v40
    ds_read_b64_tr_b16 a[80:81], v15 offset:41984
    ds_read_b64_tr_b16 a[82:83], v15 offset:42240
    v_exp_f32 v57, v41
    s_waitcnt lgkmcnt(12)
    v_mfma_f32_32x32x16_bf16 a[96:111], a[84:87], a[56:59], a[96:111]
    v_exp_f32 v58, v42
    v_exp_f32 v59, v43
    v_mfma_f32_32x32x16_bf16 a[112:127], a[84:87], a[60:63], a[112:127]
    v_exp_f32 v60, v44
    v_exp_f32 v61, v45
    ds_read_b64_tr_b16 a[84:85], v15 offset:49152
    ds_read_b64_tr_b16 a[86:87], v15 offset:49408
    v_exp_f32 v62, v46
    v_exp_f32 v63, v47
    s_waitcnt lgkmcnt(12)
    v_mfma_f32_32x32x16_bf16 a[96:111], a[88:91], a[128:131], a[96:111]
    v_pk_add_f32 v[48:49], v[48:49], v[12:13]
    v_pk_add_f32 v[50:51], v[50:51], v[12:13]
    v_pk_add_f32 v[52:53], v[52:53], v[12:13]
    v_pk_add_f32 v[54:55], v[54:55], v[12:13]
    v_pk_add_f32 v[56:57], v[56:57], v[12:13]
    v_pk_add_f32 v[58:59], v[58:59], v[12:13]
    v_pk_add_f32 v[60:61], v[60:61], v[12:13]
    v_pk_add_f32 v[62:63], v[62:63], v[12:13]
    v_rcp_f32 v32, v48
    v_rcp_f32 v33, v49
    v_mfma_f32_32x32x16_bf16 a[112:127], a[88:91], a[132:135], a[112:127]
    v_rcp_f32 v34, v50
    v_rcp_f32 v35, v51
    ds_read_b64_tr_b16 a[88:89], v15 offset:56320
    ds_read_b64_tr_b16 a[90:91], v15 offset:56576
    v_rcp_f32 v36, v52
    s_waitcnt lgkmcnt(12)
    v_mfma_f32_32x32x16_bf16 a[96:111], a[64:67], a[136:139], a[96:111]
    v_rcp_f32 v37, v53
    v_rcp_f32 v38, v54
    v_mfma_f32_32x32x16_bf16 a[112:127], a[64:67], a[140:143], a[112:127]
    v_rcp_f32 v39, v55
    v_rcp_f32 v40, v56
    v_rcp_f32 v41, v57
    s_waitcnt lgkmcnt(10)
    v_mfma_f32_32x32x16_bf16 a[96:111], a[68:71], a[144:147], a[96:111]
    v_rcp_f32 v42, v58
    v_rcp_f32 v43, v59
    v_mfma_f32_32x32x16_bf16 a[112:127], a[68:71], a[148:151], a[112:127]
    v_rcp_f32 v44, v60
    v_rcp_f32 v45, v61
    v_rcp_f32 v46, v62
    v_rcp_f32 v47, v63
    s_waitcnt lgkmcnt(8)
    v_mfma_f32_32x32x16_bf16 a[96:111], a[72:75], a[152:155], a[96:111]
    v_pk_mul_f32 v[224:225], v[224:225], v[32:33]
    v_pk_mul_f32 v[226:227], v[226:227], v[34:35]
    v_pk_mul_f32 v[228:229], v[228:229], v[36:37]
    v_pk_mul_f32 v[230:231], v[230:231], v[38:39]
    v_pk_mul_f32 v[232:233], v[232:233], v[40:41]
    v_pk_mul_f32 v[234:235], v[234:235], v[42:43]
    v_pk_mul_f32 v[236:237], v[236:237], v[44:45]
    v_pk_mul_f32 v[238:239], v[238:239], v[46:47]
    s_add_u32 s70, s71, 10240
    v_cvt_pk_bf16_f32 v16, v224, v225
    v_cvt_pk_bf16_f32 v17, v226, v227
    v_cvt_pk_bf16_f32 v18, v228, v229
    v_cvt_pk_bf16_f32 v19, v230, v231
    v_cvt_pk_bf16_f32 v20, v232, v233
    v_cvt_pk_bf16_f32 v21, v234, v235
    v_cvt_pk_bf16_f32 v22, v236, v237
    v_cvt_pk_bf16_f32 v23, v238, v239
    buffer_store_dwordx4 v[16:19], v2, s[60:63], s70 offen offset:0 sc1
    buffer_store_dwordx4 v[20:23], v2, s[60:63], s70 offen offset:1024 sc1
    v_pk_mul_f32 v[32:33], v[240:241], v[240:241]
    v_pk_mul_f32 v[34:35], v[242:243], v[242:243]
    v_pk_mul_f32 v[36:37], v[244:245], v[244:245]
    v_pk_mul_f32 v[38:39], v[246:247], v[246:247]
    v_pk_mul_f32 v[40:41], v[248:249], v[248:249]
    v_pk_mul_f32 v[42:43], v[250:251], v[250:251]
    v_pk_mul_f32 v[44:45], v[252:253], v[252:253]
    v_pk_mul_f32 v[46:47], v[254:255], v[254:255]
    v_pk_fma_f32 v[32:33], v[32:33], v[10:11], v[8:9]
    v_pk_fma_f32 v[34:35], v[34:35], v[10:11], v[8:9]
    v_pk_fma_f32 v[36:37], v[36:37], v[10:11], v[8:9]
    v_pk_fma_f32 v[38:39], v[38:39], v[10:11], v[8:9]
    v_pk_fma_f32 v[40:41], v[40:41], v[10:11], v[8:9]
    v_pk_fma_f32 v[42:43], v[42:43], v[10:11], v[8:9]
    v_pk_fma_f32 v[44:45], v[44:45], v[10:11], v[8:9]
    v_pk_fma_f32 v[46:47], v[46:47], v[10:11], v[8:9]
    v_pk_mul_f32 v[32:33], v[32:33], v[240:241]
    v_pk_mul_f32 v[34:35], v[34:35], v[242:243]
    v_pk_mul_f32 v[36:37], v[36:37], v[244:245]
    v_pk_mul_f32 v[38:39], v[38:39], v[246:247]
    v_pk_mul_f32 v[40:41], v[40:41], v[248:249]
    v_pk_mul_f32 v[42:43], v[42:43], v[250:251]
    v_pk_mul_f32 v[44:45], v[44:45], v[252:253]
    v_pk_mul_f32 v[46:47], v[46:47], v[254:255]
    v_exp_f32 v48, v32
    v_exp_f32 v49, v33
    v_mfma_f32_32x32x16_bf16 a[112:127], a[72:75], a[156:159], a[112:127]
    v_exp_f32 v50, v34
    v_exp_f32 v51, v35
    v_exp_f32 v52, v36
    s_waitcnt lgkmcnt(6)
    v_mfma_f32_32x32x16_bf16 a[96:111], a[76:79], a[160:163], a[96:111]
    v_exp_f32 v53, v37
    v_exp_f32 v54, v38
    v_mfma_f32_32x32x16_bf16 a[112:127], a[76:79], a[164:167], a[112:127]
    v_exp_f32 v55, v39
    v_exp_f32 v56, v40
    v_exp_f32 v57, v41
    s_waitcnt lgkmcnt(4)
    v_mfma_f32_32x32x16_bf16 a[96:111], a[80:83], a[168:171], a[96:111]
    v_exp_f32 v58, v42
    v_exp_f32 v59, v43
    v_mfma_f32_32x32x16_bf16 a[112:127], a[80:83], a[172:175], a[112:127]
    v_exp_f32 v60, v44
    v_exp_f32 v61, v45
    v_exp_f32 v62, v46
    v_exp_f32 v63, v47
    s_waitcnt lgkmcnt(2)
    v_mfma_f32_32x32x16_bf16 a[96:111], a[84:87], a[176:179], a[96:111]
    v_pk_add_f32 v[48:49], v[48:49], v[12:13]
    v_pk_add_f32 v[50:51], v[50:51], v[12:13]
    v_pk_add_f32 v[52:53], v[52:53], v[12:13]
    v_pk_add_f32 v[54:55], v[54:55], v[12:13]
    v_pk_add_f32 v[56:57], v[56:57], v[12:13]
    v_pk_add_f32 v[58:59], v[58:59], v[12:13]
    v_pk_add_f32 v[60:61], v[60:61], v[12:13]
    v_pk_add_f32 v[62:63], v[62:63], v[12:13]
    v_rcp_f32 v32, v48
    v_rcp_f32 v33, v49
    v_mfma_f32_32x32x16_bf16 a[112:127], a[84:87], a[180:183], a[112:127]
    v_rcp_f32 v34, v50
    v_rcp_f32 v35, v51
    v_rcp_f32 v36, v52
    s_waitcnt lgkmcnt(0)
    v_mfma_f32_32x32x16_bf16 a[96:111], a[88:91], a[184:187], a[96:111]
    v_rcp_f32 v37, v53
    v_rcp_f32 v38, v54
    v_mfma_f32_32x32x16_bf16 a[112:127], a[88:91], a[188:191], a[112:127]
    v_rcp_f32 v39, v55
    v_rcp_f32 v40, v56
    v_rcp_f32 v41, v57
    v_rcp_f32 v42, v58
    v_rcp_f32 v43, v59
    v_rcp_f32 v44, v60
    v_rcp_f32 v45, v61
    v_rcp_f32 v46, v62
    v_rcp_f32 v47, v63
    v_pk_mul_f32 v[240:241], v[240:241], v[32:33]
    v_pk_mul_f32 v[242:243], v[242:243], v[34:35]
    v_pk_mul_f32 v[244:245], v[244:245], v[36:37]
    v_pk_mul_f32 v[246:247], v[246:247], v[38:39]
    v_pk_mul_f32 v[248:249], v[248:249], v[40:41]
    v_pk_mul_f32 v[250:251], v[250:251], v[42:43]
    v_pk_mul_f32 v[252:253], v[252:253], v[44:45]
    v_pk_mul_f32 v[254:255], v[254:255], v[46:47]
    s_add_u32 s70, s71, 305152
    v_cvt_pk_bf16_f32 v24, v240, v241
    v_cvt_pk_bf16_f32 v25, v242, v243
    v_cvt_pk_bf16_f32 v26, v244, v245
    v_cvt_pk_bf16_f32 v27, v246, v247
    v_cvt_pk_bf16_f32 v28, v248, v249
    v_cvt_pk_bf16_f32 v29, v250, v251
    v_cvt_pk_bf16_f32 v30, v252, v253
    v_cvt_pk_bf16_f32 v31, v254, v255
    buffer_store_dwordx4 v[24:27], v2, s[60:63], s70 offen offset:0 sc1
    buffer_store_dwordx4 v[28:31], v2, s[60:63], s70 offen offset:1024 sc1
    s_nop 15
    s_nop 15
    v_accvgpr_read_b32 v64, a96
    v_accvgpr_read_b32 v65, a97
    v_accvgpr_read_b32 v66, a98
    v_accvgpr_read_b32 v67, a99
    v_accvgpr_read_b32 v68, a100
    v_accvgpr_read_b32 v69, a101
    v_accvgpr_read_b32 v70, a102
    v_accvgpr_read_b32 v71, a103
    v_accvgpr_read_b32 v72, a104
    v_accvgpr_read_b32 v73, a105
    v_accvgpr_read_b32 v74, a106
    v_accvgpr_read_b32 v75, a107
    v_accvgpr_read_b32 v76, a108
    v_accvgpr_read_b32 v77, a109
    v_accvgpr_read_b32 v78, a110
    v_accvgpr_read_b32 v79, a111
    v_pk_mul_f32 v[32:33], v[64:65], v[64:65]
    v_pk_mul_f32 v[34:35], v[66:67], v[66:67]
    v_pk_mul_f32 v[36:37], v[68:69], v[68:69]
    v_pk_mul_f32 v[38:39], v[70:71], v[70:71]
    v_pk_mul_f32 v[40:41], v[72:73], v[72:73]
    v_pk_mul_f32 v[42:43], v[74:75], v[74:75]
    v_pk_mul_f32 v[44:45], v[76:77], v[76:77]
    v_pk_mul_f32 v[46:47], v[78:79], v[78:79]
    v_pk_fma_f32 v[32:33], v[32:33], v[10:11], v[8:9]
    v_pk_fma_f32 v[34:35], v[34:35], v[10:11], v[8:9]
    v_pk_fma_f32 v[36:37], v[36:37], v[10:11], v[8:9]
    v_pk_fma_f32 v[38:39], v[38:39], v[10:11], v[8:9]
    v_pk_fma_f32 v[40:41], v[40:41], v[10:11], v[8:9]
    v_pk_fma_f32 v[42:43], v[42:43], v[10:11], v[8:9]
    v_pk_fma_f32 v[44:45], v[44:45], v[10:11], v[8:9]
    v_pk_fma_f32 v[46:47], v[46:47], v[10:11], v[8:9]
    v_pk_mul_f32 v[32:33], v[32:33], v[64:65]
    v_pk_mul_f32 v[34:35], v[34:35], v[66:67]
    v_pk_mul_f32 v[36:37], v[36:37], v[68:69]
    v_pk_mul_f32 v[38:39], v[38:39], v[70:71]
    v_pk_mul_f32 v[40:41], v[40:41], v[72:73]
    v_pk_mul_f32 v[42:43], v[42:43], v[74:75]
    v_pk_mul_f32 v[44:45], v[44:45], v[76:77]
    v_pk_mul_f32 v[46:47], v[46:47], v[78:79]
    v_exp_f32 v48, v32
    v_exp_f32 v49, v33
    v_exp_f32 v50, v34
    v_exp_f32 v51, v35
    v_exp_f32 v52, v36
    v_exp_f32 v53, v37
    v_exp_f32 v54, v38
    v_exp_f32 v55, v39
    v_exp_f32 v56, v40
    v_exp_f32 v57, v41
    v_exp_f32 v58, v42
    v_exp_f32 v59, v43
    v_exp_f32 v60, v44
    v_exp_f32 v61, v45
    v_exp_f32 v62, v46
    v_exp_f32 v63, v47
    v_pk_add_f32 v[48:49], v[48:49], v[12:13]
    v_pk_add_f32 v[50:51], v[50:51], v[12:13]
    v_pk_add_f32 v[52:53], v[52:53], v[12:13]
    v_pk_add_f32 v[54:55], v[54:55], v[12:13]
    v_pk_add_f32 v[56:57], v[56:57], v[12:13]
    v_pk_add_f32 v[58:59], v[58:59], v[12:13]
    v_pk_add_f32 v[60:61], v[60:61], v[12:13]
    v_pk_add_f32 v[62:63], v[62:63], v[12:13]
    v_rcp_f32 v32, v48
    v_rcp_f32 v33, v49
    v_rcp_f32 v34, v50
    v_rcp_f32 v35, v51
    v_rcp_f32 v36, v52
    v_rcp_f32 v37, v53
    v_rcp_f32 v38, v54
    v_rcp_f32 v39, v55
    v_rcp_f32 v40, v56
    v_rcp_f32 v41, v57
    v_rcp_f32 v42, v58
    v_rcp_f32 v43, v59
    v_rcp_f32 v44, v60
    v_rcp_f32 v45, v61
    v_rcp_f32 v46, v62
    v_rcp_f32 v47, v63
    v_pk_mul_f32 v[64:65], v[64:65], v[32:33]
    v_pk_mul_f32 v[66:67], v[66:67], v[34:35]
    v_pk_mul_f32 v[68:69], v[68:69], v[36:37]
    v_pk_mul_f32 v[70:71], v[70:71], v[38:39]
    v_pk_mul_f32 v[72:73], v[72:73], v[40:41]
    v_pk_mul_f32 v[74:75], v[74:75], v[42:43]
    v_pk_mul_f32 v[76:77], v[76:77], v[44:45]
    v_pk_mul_f32 v[78:79], v[78:79], v[46:47]
    s_add_u32 s70, s72, 0
    v_cvt_pk_bf16_f32 v16, v64, v65
    v_cvt_pk_bf16_f32 v17, v66, v67
    v_cvt_pk_bf16_f32 v18, v68, v69
    v_cvt_pk_bf16_f32 v19, v70, v71
    v_cvt_pk_bf16_f32 v20, v72, v73
    v_cvt_pk_bf16_f32 v21, v74, v75
    v_cvt_pk_bf16_f32 v22, v76, v77
    v_cvt_pk_bf16_f32 v23, v78, v79
    buffer_store_dwordx4 v[16:19], v2, s[60:63], s70 offen offset:0 sc1
    buffer_store_dwordx4 v[20:23], v2, s[60:63], s70 offen offset:1024 sc1
    v_accvgpr_read_b32 v80, a112
    v_accvgpr_read_b32 v81, a113
    v_accvgpr_read_b32 v82, a114
    v_accvgpr_read_b32 v83, a115
    v_accvgpr_read_b32 v84, a116
    v_accvgpr_read_b32 v85, a117
    v_accvgpr_read_b32 v86, a118
    v_accvgpr_read_b32 v87, a119
    v_accvgpr_read_b32 v88, a120
    v_accvgpr_read_b32 v89, a121
    v_accvgpr_read_b32 v90, a122
    v_accvgpr_read_b32 v91, a123
    v_accvgpr_read_b32 v92, a124
    v_accvgpr_read_b32 v93, a125
    v_accvgpr_read_b32 v94, a126
    v_accvgpr_read_b32 v95, a127
    v_pk_mul_f32 v[32:33], v[80:81], v[80:81]
    v_pk_mul_f32 v[34:35], v[82:83], v[82:83]
    v_pk_mul_f32 v[36:37], v[84:85], v[84:85]
    v_pk_mul_f32 v[38:39], v[86:87], v[86:87]
    v_pk_mul_f32 v[40:41], v[88:89], v[88:89]
    v_pk_mul_f32 v[42:43], v[90:91], v[90:91]
    v_pk_mul_f32 v[44:45], v[92:93], v[92:93]
    v_pk_mul_f32 v[46:47], v[94:95], v[94:95]
    v_pk_fma_f32 v[32:33], v[32:33], v[10:11], v[8:9]
    v_pk_fma_f32 v[34:35], v[34:35], v[10:11], v[8:9]
    v_pk_fma_f32 v[36:37], v[36:37], v[10:11], v[8:9]
    v_pk_fma_f32 v[38:39], v[38:39], v[10:11], v[8:9]
    v_pk_fma_f32 v[40:41], v[40:41], v[10:11], v[8:9]
    v_pk_fma_f32 v[42:43], v[42:43], v[10:11], v[8:9]
    v_pk_fma_f32 v[44:45], v[44:45], v[10:11], v[8:9]
    v_pk_fma_f32 v[46:47], v[46:47], v[10:11], v[8:9]
    v_pk_mul_f32 v[32:33], v[32:33], v[80:81]
    v_pk_mul_f32 v[34:35], v[34:35], v[82:83]
    v_pk_mul_f32 v[36:37], v[36:37], v[84:85]
    v_pk_mul_f32 v[38:39], v[38:39], v[86:87]
    v_pk_mul_f32 v[40:41], v[40:41], v[88:89]
    v_pk_mul_f32 v[42:43], v[42:43], v[90:91]
    v_pk_mul_f32 v[44:45], v[44:45], v[92:93]
    v_pk_mul_f32 v[46:47], v[46:47], v[94:95]
    v_exp_f32 v48, v32
    v_exp_f32 v49, v33
    v_exp_f32 v50, v34
    v_exp_f32 v51, v35
    v_exp_f32 v52, v36
    v_exp_f32 v53, v37
    v_exp_f32 v54, v38
    v_exp_f32 v55, v39
    v_exp_f32 v56, v40
    v_exp_f32 v57, v41
    v_exp_f32 v58, v42
    v_exp_f32 v59, v43
    v_exp_f32 v60, v44
    v_exp_f32 v61, v45
    v_exp_f32 v62, v46
    v_exp_f32 v63, v47
    v_pk_add_f32 v[48:49], v[48:49], v[12:13]
    v_pk_add_f32 v[50:51], v[50:51], v[12:13]
    v_pk_add_f32 v[52:53], v[52:53], v[12:13]
    v_pk_add_f32 v[54:55], v[54:55], v[12:13]
    v_pk_add_f32 v[56:57], v[56:57], v[12:13]
    v_pk_add_f32 v[58:59], v[58:59], v[12:13]
    v_pk_add_f32 v[60:61], v[60:61], v[12:13]
    v_pk_add_f32 v[62:63], v[62:63], v[12:13]
    v_rcp_f32 v32, v48
    v_rcp_f32 v33, v49
    v_rcp_f32 v34, v50
    v_rcp_f32 v35, v51
    v_rcp_f32 v36, v52
    v_rcp_f32 v37, v53
    v_rcp_f32 v38, v54
    v_rcp_f32 v39, v55
    v_rcp_f32 v40, v56
    v_rcp_f32 v41, v57
    v_rcp_f32 v42, v58
    v_rcp_f32 v43, v59
    v_rcp_f32 v44, v60
    v_rcp_f32 v45, v61
    v_rcp_f32 v46, v62
    v_rcp_f32 v47, v63
    v_pk_mul_f32 v[80:81], v[80:81], v[32:33]
    v_pk_mul_f32 v[82:83], v[82:83], v[34:35]
    v_pk_mul_f32 v[84:85], v[84:85], v[36:37]
    v_pk_mul_f32 v[86:87], v[86:87], v[38:39]
    v_pk_mul_f32 v[88:89], v[88:89], v[40:41]
    v_pk_mul_f32 v[90:91], v[90:91], v[42:43]
    v_pk_mul_f32 v[92:93], v[92:93], v[44:45]
    v_pk_mul_f32 v[94:95], v[94:95], v[46:47]
    s_add_u32 s70, s72, 294912
    v_cvt_pk_bf16_f32 v24, v80, v81
    v_cvt_pk_bf16_f32 v25, v82, v83
    v_cvt_pk_bf16_f32 v26, v84, v85
    v_cvt_pk_bf16_f32 v27, v86, v87
    v_cvt_pk_bf16_f32 v28, v88, v89
    v_cvt_pk_bf16_f32 v29, v90, v91
    v_cvt_pk_bf16_f32 v30, v92, v93
    v_cvt_pk_bf16_f32 v31, v94, v95
    buffer_store_dwordx4 v[24:27], v2, s[60:63], s70 offen offset:0 sc1
    buffer_store_dwordx4 v[28:31], v2, s[60:63], s70 offen offset:1024 sc1
    s_endpgm
g1_a:
    s_mov_b32 s8, s4
    s_mov_b32 s9, s5
    s_mov_b32 s10, 0x600000
    s_mov_b32 s11, 0x20000
    s_lshl_b32 s36, s31, 3
    s_lshl_b32 s37, s33, 1
    s_add_u32 s36, s36, s37
    s_lshl_b32 s37, s36, 16
    s_add_u32 s37, s37, 0x0
    s_add_u32 s12, s28, s37
    s_addc_u32 s13, s29, 0
    s_mov_b32 s14, 0x10000
    s_mov_b32 s15, 0x20000
    s_add_u32 s16, s12, 0x10000
    s_addc_u32 s17, s13, 0
    s_mov_b32 s18, 0x10000
    s_mov_b32 s19, 0x20000
    v_lshlrev_b32 v2, 4, v1
    v_lshrrev_b32 v3, 5, v1
    v_lshlrev_b32 v3, 2, v3
    v_bfe_u32 v4, v1, 2, 2
    v_add_u32 v3, v3, v4
    s_lshl_b32 s37, s33, 4
    v_add_u32 v3, s37, v3
    v_mul_u32_u24 v3, 6144, v3
    v_bfe_u32 v4, v1, 4, 1
    v_lshl_add_u32 v3, v4, 6, v3
    v_and_b32 v4, 3, v1
    v_lshl_add_u32 v3, v4, 4, v3
    s_lshl_b32 s39, s30, 1
    v_add_u32 v3, s39, v3
    v_add_u32 v4, 49152, v3
    v_bfe_u32 v7, v1, 2, 2
    v_lshlrev_b32 v5, 6, v7
    v_bfe_u32 v7, v1, 4, 1
    v_lshl_add_u32 v5, v7, 5, v5
    v_and_b32 v7, 3, v1
    v_lshl_add_u32 v5, v7, 3, v5
    v_lshrrev_b32 v7, 5, v1
    v_mul_u32_u24 v7, 3072, v7
    v_add_u32 v5, v5, v7
    v_add_u32 v7, 49152, v5
    s_mul_i32 s38, s33, 6144
    s_mov_b32 s24, 0
    s_mov_b32 s25, 0
    s_lshl_b32 s3, s31, 2
    s_add_u32 s3, s3, s33
    s_lshl_b32 s3, s3, 1
    s_add_u32 s3, s3, 128
    v_bfe_u32 v44, v1, 2, 1
    v_add_u32 v44, s3, v44
    v_mul_u32_u24 v44, 6144, v44
    v_and_b32 v45, 3, v1
    v_min_u32 v45, 2, v45
    v_lshlrev_b32 v46, 11, v45
    v_add_u32 v46, s39, v46
    v_add_u32 v44, v44, v46
    v_lshrrev_b32 v47, 2, v1
    v_mul_u32_u24 v47, 6144, v47
    v_add_u32 v47, v47, v46
    s_add_u32 m0, s38, 0
    s_add_u32 s27, s24, 0
    buffer_load_dwordx4 v3, s[8:11], s27 offen lds
    s_add_u32 m0, s38, 1024
    s_add_u32 s27, s24, 2048
    buffer_load_dwordx4 v3, s[8:11], s27 offen lds
    s_add_u32 m0, s38, 2048
    s_add_u32 s27, s24, 4096
    buffer_load_dwordx4 v3, s[8:11], s27 offen lds
    s_waitcnt vmcnt(3)
    s_add_u32 m0, s38, 3072
    s_add_u32 s27, s24, 0
    buffer_load_dwordx4 v4, s[8:11], s27 offen lds
    s_add_u32 m0, s38, 4096
    s_add_u32 s27, s24, 2048
    buffer_load_dwordx4 v4, s[8:11], s27 offen lds
    s_add_u32 m0, s38, 5120
    s_add_u32 s27, s24, 4096
    buffer_load_dwordx4 v4, s[8:11], s27 offen lds
    s_add_u32 s24, s24, 393216
    v_lshrrev_b32 v144, 5, v56
    v_lshlrev_b32 v144, 16, v144
    v_lshrrev_b32 v145, 1, v57
    v_lshl_add_u32 v144, v145, 10, v144
    v_and_b32 v145, 1, v57
    v_lshl_add_u32 v144, v145, 9, v144
    v_and_b32 v145, 31, v56
    v_lshl_add_u32 v144, v145, 4, v144
    s_mov_b32 s52, 0xffff0000
    s_mov_b32 s53, 0x3a800000
    s_mov_b32 s54, 0x3727c5ac
    v_add_u32 v144, v56, v57
    v_and_b32 v144, 7, v144
    v_lshlrev_b32 v144, 4, v144
    v_lshl_add_u32 v144, v57, 7, v144
    v_add_u32 v144, 114688, v144
    v_lshlrev_b32 v80, 16, v64
    v_and_b32 v81, s52, v64
    v_lshlrev_b32 v82, 16, v65
    v_and_b32 v83, s52, v65
    v_lshlrev_b32 v84, 16, v66
    v_and_b32 v85, s52, v66
    v_lshlrev_b32 v86, 16, v67
    v_and_b32 v87, s52, v67
    v_lshlrev_b32 v88, 16, v68
    v_and_b32 v89, s52, v68
    v_lshlrev_b32 v90, 16, v69
    v_and_b32 v91, s52, v69
    v_lshlrev_b32 v92, 16, v70
    v_and_b32 v93, s52, v70
    v_lshlrev_b32 v94, 16, v71
    v_and_b32 v95, s52, v71
    v_lshlrev_b32 v96, 16, v72
    v_and_b32 v97, s52, v72
    v_lshlrev_b32 v98, 16, v73
    v_and_b32 v99, s52, v73
    v_lshlrev_b32 v100, 16, v74
    v_and_b32 v101, s52, v74
    v_lshlrev_b32 v102, 16, v75
    v_and_b32 v103, s52, v75
    v_lshlrev_b32 v104, 16, v76
    v_and_b32 v105, s52, v76
    v_lshlrev_b32 v106, 16, v77
    v_and_b32 v107, s52, v77
    v_lshlrev_b32 v108, 16, v78
    v_and_b32 v109, s52, v78
    v_lshlrev_b32 v110, 16, v79
    v_and_b32 v111, s52, v79
    v_pk_add_f32 v[112:113], v[80:81], v[82:83]
    v_pk_add_f32 v[114:115], v[84:85], v[86:87]
    v_pk_add_f32 v[116:117], v[88:89], v[90:91]
    v_pk_add_f32 v[118:119], v[92:93], v[94:95]
    v_pk_add_f32 v[120:121], v[96:97], v[98:99]
    v_pk_add_f32 v[122:123], v[100:101], v[102:103]
    v_pk_add_f32 v[124:125], v[104:105], v[106:107]
    v_pk_add_f32 v[126:127], v[108:109], v[110:111]
    v_pk_add_f32 v[112:113], v[112:113], v[114:115]
    v_pk_add_f32 v[114:115], v[116:117], v[118:119]
    v_pk_add_f32 v[116:117], v[120:121], v[122:123]
    v_pk_add_f32 v[118:119], v[124:125], v[126:127]
    v_pk_add_f32 v[112:113], v[112:113], v[114:115]
    v_pk_add_f32 v[114:115], v[116:117], v[118:119]
    v_pk_add_f32 v[112:113], v[112:113], v[114:115]
    v_add_f32 v112, v112, v113
    s_nop 1
    v_add_f32_dpp v112, v112, v112 row_ror:8 row_mask:0xf bank_mask:0xf
    s_nop 1
    v_add_f32_dpp v112, v112, v112 row_ror:4 row_mask:0xf bank_mask:0xf
    s_nop 1
    v_add_f32_dpp v112, v112, v112 row_ror:2 row_mask:0xf bank_mask:0xf
    s_nop 1
    v_add_f32_dpp v112, v112, v112 row_ror:1 row_mask:0xf bank_mask:0xf
    v_mov_b32 v113, v112
    s_nop 1
    v_permlane16_swap_b32 v113, v112
    s_nop 1
    v_add_f32 v112, v112, v113
    v_mul_f32 v146, s53, v112
    v_mov_b32 v147, v146
    v_pk_add_f32 v[150:151], v[80:81], v[146:147] neg_lo:[0,1] neg_hi:[0,1]
    v_pk_add_f32 v[152:153], v[82:83], v[146:147] neg_lo:[0,1] neg_hi:[0,1]
    v_pk_add_f32 v[154:155], v[84:85], v[146:147] neg_lo:[0,1] neg_hi:[0,1]
    v_pk_add_f32 v[156:157], v[86:87], v[146:147] neg_lo:[0,1] neg_hi:[0,1]
    v_pk_add_f32 v[158:159], v[88:89], v[146:147] neg_lo:[0,1] neg_hi:[0,1]
    v_pk_add_f32 v[160:161], v[90:91], v[146:147] neg_lo:[0,1] neg_hi:[0,1]
    v_pk_add_f32 v[162:163], v[92:93], v[146:147] neg_lo:[0,1] neg_hi:[0,1]
    v_pk_add_f32 v[164:165], v[94:95], v[146:147] neg_lo:[0,1] neg_hi:[0,1]
    v_pk_add_f32 v[166:167], v[96:97], v[146:147] neg_lo:[0,1] neg_hi:[0,1]
    v_pk_add_f32 v[168:169], v[98:99], v[146:147] neg_lo:[0,1] neg_hi:[0,1]
    v_pk_add_f32 v[170:171], v[100:101], v[146:147] neg_lo:[0,1] neg_hi:[0,1]
    v_pk_add_f32 v[172:173], v[102:103], v[146:147] neg_lo:[0,1] neg_hi:[0,1]
    v_pk_add_f32 v[174:175], v[104:105], v[146:147] neg_lo:[0,1] neg_hi:[0,1]
    v_pk_add_f32 v[176:177], v[106:107], v[146:147] neg_lo:[0,1] neg_hi:[0,1]
    v_pk_add_f32 v[178:179], v[108:109], v[146:147] neg_lo:[0,1] neg_hi:[0,1]
    v_pk_add_f32 v[180:181], v[110:111], v[146:147] neg_lo:[0,1] neg_hi:[0,1]
    v_pk_mul_f32 v[112:113], v[150:151], v[150:151]
    v_pk_mul_f32 v[114:115], v[152:153], v[152:153]
    v_pk_mul_f32 v[116:117], v[154:155], v[154:155]
    v_pk_mul_f32 v[118:119], v[156:157], v[156:157]
    v_pk_fma_f32 v[112:113], v[158:159], v[158:159], v[112:113]
    v_pk_fma_f32 v[114:115], v[160:161], v[160:161], v[114:115]
    v_pk_fma_f32 v[116:117], v[162:163], v[162:163], v[116:117]
    v_pk_fma_f32 v[118:119], v[164:165], v[164:165], v[118:119]
    v_pk_fma_f32 v[112:113], v[166:167], v[166:167], v[112:113]
    v_pk_fma_f32 v[114:115], v[168:169], v[168:169], v[114:115]
    v_pk_fma_f32 v[116:117], v[170:171], v[170:171], v[116:117]
    v_pk_fma_f32 v[118:119], v[172:173], v[172:173], v[118:119]
    v_pk_fma_f32 v[112:113], v[174:175], v[174:175], v[112:113]
    v_pk_fma_f32 v[114:115], v[176:177], v[176:177], v[114:115]
    v_pk_fma_f32 v[116:117], v[178:179], v[178:179], v[116:117]
    v_pk_fma_f32 v[118:119], v[180:181], v[180:181], v[118:119]
    v_pk_add_f32 v[112:113], v[112:113], v[114:115]
    v_pk_add_f32 v[114:115], v[116:117], v[118:119]
    v_pk_add_f32 v[112:113], v[112:113], v[114:115]
    v_add_f32 v112, v112, v113
    s_nop 1
    v_add_f32_dpp v112, v112, v112 row_ror:8 row_mask:0xf bank_mask:0xf
    s_nop 1
    v_add_f32_dpp v112, v112, v112 row_ror:4 row_mask:0xf bank_mask:0xf
    s_nop 1
    v_add_f32_dpp v112, v112, v112 row_ror:2 row_mask:0xf bank_mask:0xf
    s_nop 1
    v_add_f32_dpp v112, v112, v112 row_ror:1 row_mask:0xf bank_mask:0xf
    v_mov_b32 v113, v112
    s_nop 1
    v_permlane16_swap_b32 v113, v112
    s_nop 1
    v_add_f32 v112, v112, v113
    v_mul_f32 v148, s53, v112
    v_cvt_pk_bf16_f32 v148, v148, v148
    v_lshlrev_b32 v148, 16, v148
    v_add_f32 v148, s54, v148
    v_cvt_pk_bf16_f32 v148, v148, v148
    v_lshlrev_b32 v148, 16, v148
    v_sqrt_f32 v148, v148
    s_nop 0
    v_cvt_pk_bf16_f32 v148, v148, v148
    v_lshlrev_b32 v148, 16, v148
    v_rcp_f32 v148, v148
    v_cvt_pk_bf16_f32 v146, v146, v146
    v_lshlrev_b32 v146, 16, v146
    v_mov_b32 v147, v146
    v_mov_b32 v149, v148
    v_pk_add_f32 v[80:81], v[80:81], v[146:147] neg_lo:[0,1] neg_hi:[0,1]
    v_pk_add_f32 v[82:83], v[82:83], v[146:147] neg_lo:[0,1] neg_hi:[0,1]
    v_pk_add_f32 v[84:85], v[84:85], v[146:147] neg_lo:[0,1] neg_hi:[0,1]
    v_pk_add_f32 v[86:87], v[86:87], v[146:147] neg_lo:[0,1] neg_hi:[0,1]
    v_pk_add_f32 v[88:89], v[88:89], v[146:147] neg_lo:[0,1] neg_hi:[0,1]
    v_pk_add_f32 v[90:91], v[90:91], v[146:147] neg_lo:[0,1] neg_hi:[0,1]
    v_pk_add_f32 v[92:93], v[92:93], v[146:147] neg_lo:[0,1] neg_hi:[0,1]
    v_pk_add_f32 v[94:95], v[94:95], v[146:147] neg_lo:[0,1] neg_hi:[0,1]
    v_pk_add_f32 v[96:97], v[96:97], v[146:147] neg_lo:[0,1] neg_hi:[0,1]
    v_pk_add_f32 v[98:99], v[98:99], v[146:147] neg_lo:[0,1] neg_hi:[0,1]
    v_pk_add_f32 v[100:101], v[100:101], v[146:147] neg_lo:[0,1] neg_hi:[0,1]
    v_pk_add_f32 v[102:103], v[102:103], v[146:147] neg_lo:[0,1] neg_hi:[0,1]
    v_pk_add_f32 v[104:105], v[104:105], v[146:147] neg_lo:[0,1] neg_hi:[0,1]
    v_pk_add_f32 v[106:107], v[106:107], v[146:147] neg_lo:[0,1] neg_hi:[0,1]
    v_pk_add_f32 v[108:109], v[108:109], v[146:147] neg_lo:[0,1] neg_hi:[0,1]
    v_pk_add_f32 v[110:111], v[110:111], v[146:147] neg_lo:[0,1] neg_hi:[0,1]
    v_cvt_pk_bf16_f32 v64, v80, v81
    v_cvt_pk_bf16_f32 v65, v82, v83
    v_cvt_pk_bf16_f32 v66, v84, v85
    v_cvt_pk_bf16_f32 v67, v86, v87
    v_cvt_pk_bf16_f32 v68, v88, v89
    v_cvt_pk_bf16_f32 v69, v90, v91
    v_cvt_pk_bf16_f32 v70, v92, v93
    v_cvt_pk_bf16_f32 v71, v94, v95
    v_cvt_pk_bf16_f32 v72, v96, v97
    v_cvt_pk_bf16_f32 v73, v98, v99
    v_cvt_pk_bf16_f32 v74, v100, v101
    v_cvt_pk_bf16_f32 v75, v102, v103
    v_cvt_pk_bf16_f32 v76, v104, v105
    v_cvt_pk_bf16_f32 v77, v106, v107
    v_cvt_pk_bf16_f32 v78, v108, v109
    v_cvt_pk_bf16_f32 v79, v110, v111
    v_lshlrev_b32 v80, 16, v64
    v_and_b32 v81, s52, v64
    v_lshlrev_b32 v82, 16, v65
    v_and_b32 v83, s52, v65
    v_lshlrev_b32 v84, 16, v66
    v_and_b32 v85, s52, v66
    v_lshlrev_b32 v86, 16, v67
    v_and_b32 v87, s52, v67
    v_lshlrev_b32 v88, 16, v68
    v_and_b32 v89, s52, v68
    v_lshlrev_b32 v90, 16, v69
    v_and_b32 v91, s52, v69
    v_lshlrev_b32 v92, 16, v70
    v_and_b32 v93, s52, v70
    v_lshlrev_b32 v94, 16, v71
    v_and_b32 v95, s52, v71
    v_lshlrev_b32 v96, 16, v72
    v_and_b32 v97, s52, v72
    v_lshlrev_b32 v98, 16, v73
    v_and_b32 v99, s52, v73
    v_lshlrev_b32 v100, 16, v74
    v_and_b32 v101, s52, v74
    v_lshlrev_b32 v102, 16, v75
    v_and_b32 v103, s52, v75
    v_lshlrev_b32 v104, 16, v76
    v_and_b32 v105, s52, v76
    v_lshlrev_b32 v106, 16, v77
    v_and_b32 v107, s52, v77
    v_lshlrev_b32 v108, 16, v78
    v_and_b32 v109, s52, v78
    v_lshlrev_b32 v110, 16, v79
    v_and_b32 v111, s52, v79
    v_pk_mul_f32 v[80:81], v[80:81], v[148:149]
    v_pk_mul_f32 v[82:83], v[82:83], v[148:149]
    v_pk_mul_f32 v[84:85], v[84:85], v[148:149]
    v_pk_mul_f32 v[86:87], v[86:87], v[148:149]
    v_pk_mul_f32 v[88:89], v[88:89], v[148:149]
    v_pk_mul_f32 v[90:91], v[90:91], v[148:149]
    v_pk_mul_f32 v[92:93], v[92:93], v[148:149]
    v_pk_mul_f32 v[94:95], v[94:95], v[148:149]
    v_pk_mul_f32 v[96:97], v[96:97], v[148:149]
    v_pk_mul_f32 v[98:99], v[98:99], v[148:149]
    v_pk_mul_f32 v[100:101], v[100:101], v[148:149]
    v_pk_mul_f32 v[102:103], v[102:103], v[148:149]
    v_pk_mul_f32 v[104:105], v[104:105], v[148:149]
    v_pk_mul_f32 v[106:107], v[106:107], v[148:149]
    v_pk_mul_f32 v[108:109], v[108:109], v[148:149]
    v_pk_mul_f32 v[110:111], v[110:111], v[148:149]
    v_cvt_pk_bf16_f32 v184, v80, v81
    v_cvt_pk_bf16_f32 v185, v82, v83
    v_cvt_pk_bf16_f32 v186, v84, v85
    v_cvt_pk_bf16_f32 v187, v86, v87
    v_cvt_pk_bf16_f32 v188, v88, v89
    v_cvt_pk_bf16_f32 v189, v90, v91
    v_cvt_pk_bf16_f32 v190, v92, v93
    v_cvt_pk_bf16_f32 v191, v94, v95
    v_cvt_pk_bf16_f32 v192, v96, v97
    v_cvt_pk_bf16_f32 v193, v98, v99
    v_cvt_pk_bf16_f32 v194, v100, v101
    v_cvt_pk_bf16_f32 v195, v102, v103
    v_cvt_pk_bf16_f32 v196, v104, v105
    v_cvt_pk_bf16_f32 v197, v106, v107
    v_cvt_pk_bf16_f32 v198, v108, v109
    v_cvt_pk_bf16_f32 v199, v110, v111
    ds_write_b128 v144, v[184:187] offset:0
    ds_write_b128 v144, v[188:191] offset:4096
    ds_write_b128 v144, v[192:195] offset:8192
    ds_write_b128 v144, v[196:199] offset:12288
    v_mov_b32 v20, 0
    buffer_load_dword v21, v20, s[48:51], 0 offen
    v_lshlrev_b32 v80, 16, v184
    v_and_b32 v81, s52, v184
    v_lshlrev_b32 v82, 16, v185
    v_and_b32 v83, s52, v185
    v_lshlrev_b32 v84, 16, v186
    v_and_b32 v85, s52, v186
    v_lshlrev_b32 v86, 16, v187
    v_and_b32 v87, s52, v187
    v_lshlrev_b32 v88, 16, v188
    v_and_b32 v89, s52, v188
    v_lshlrev_b32 v90, 16, v189
    v_and_b32 v91, s52, v189
    v_lshlrev_b32 v92, 16, v190
    v_and_b32 v93, s52, v190
    v_lshlrev_b32 v94, 16, v191
    v_and_b32 v95, s52, v191
    v_lshlrev_b32 v96, 16, v192
    v_and_b32 v97, s52, v192
    v_lshlrev_b32 v98, 16, v193
    v_and_b32 v99, s52, v193
    v_lshlrev_b32 v100, 16, v194
    v_and_b32 v101, s52, v194
    v_lshlrev_b32 v102, 16, v195
    v_and_b32 v103, s52, v195
    v_lshlrev_b32 v104, 16, v196
    v_and_b32 v105, s52, v196
    v_lshlrev_b32 v106, 16, v197
    v_and_b32 v107, s52, v197
    v_lshlrev_b32 v108, 16, v198
    v_and_b32 v109, s52, v198
    v_lshlrev_b32 v110, 16, v199
    v_and_b32 v111, s52, v199
    v_pk_add_f32 v[112:113], v[80:81], v[82:83]
    v_pk_add_f32 v[114:115], v[84:85], v[86:87]
    v_pk_add_f32 v[116:117], v[88:89], v[90:91]
    v_pk_add_f32 v[118:119], v[92:93], v[94:95]
    v_pk_add_f32 v[120:121], v[96:97], v[98:99]
    v_pk_add_f32 v[122:123], v[100:101], v[102:103]
    v_pk_add_f32 v[124:125], v[104:105], v[106:107]
    v_pk_add_f32 v[126:127], v[108:109], v[110:111]
    v_pk_add_f32 v[112:113], v[112:113], v[114:115]
    v_pk_add_f32 v[114:115], v[116:117], v[118:119]
    v_pk_add_f32 v[116:117], v[120:121], v[122:123]
    v_pk_add_f32 v[118:119], v[124:125], v[126:127]
    v_pk_add_f32 v[112:113], v[112:113], v[114:115]
    v_pk_add_f32 v[114:115], v[116:117], v[118:119]
    v_pk_add_f32 v[112:113], v[112:113], v[114:115]
    v_add_f32 v112, v112, v113
    s_nop 1
    v_add_f32_dpp v112, v112, v112 row_ror:8 row_mask:0xf bank_mask:0xf
    s_nop 1
    v_add_f32_dpp v112, v112, v112 row_ror:4 row_mask:0xf bank_mask:0xf
    s_nop 1
    v_add_f32_dpp v112, v112, v112 row_ror:2 row_mask:0xf bank_mask:0xf
    s_nop 1
    v_add_f32_dpp v112, v112, v112 row_ror:1 row_mask:0xf bank_mask:0xf
    v_mov_b32 v113, v112
    s_nop 1
    v_permlane16_swap_b32 v113, v112
    s_nop 1
    v_add_f32 v112, v112, v113
    v_mul_f32 v146, s53, v112
    v_mov_b32 v147, v146
    v_pk_add_f32 v[150:151], v[80:81], v[146:147] neg_lo:[0,1] neg_hi:[0,1]
    v_pk_add_f32 v[152:153], v[82:83], v[146:147] neg_lo:[0,1] neg_hi:[0,1]
    v_pk_add_f32 v[154:155], v[84:85], v[146:147] neg_lo:[0,1] neg_hi:[0,1]
    v_pk_add_f32 v[156:157], v[86:87], v[146:147] neg_lo:[0,1] neg_hi:[0,1]
    v_pk_add_f32 v[158:159], v[88:89], v[146:147] neg_lo:[0,1] neg_hi:[0,1]
    v_pk_add_f32 v[160:161], v[90:91], v[146:147] neg_lo:[0,1] neg_hi:[0,1]
    v_pk_add_f32 v[162:163], v[92:93], v[146:147] neg_lo:[0,1] neg_hi:[0,1]
    v_pk_add_f32 v[164:165], v[94:95], v[146:147] neg_lo:[0,1] neg_hi:[0,1]
    v_pk_add_f32 v[166:167], v[96:97], v[146:147] neg_lo:[0,1] neg_hi:[0,1]
    v_pk_add_f32 v[168:169], v[98:99], v[146:147] neg_lo:[0,1] neg_hi:[0,1]
    v_pk_add_f32 v[170:171], v[100:101], v[146:147] neg_lo:[0,1] neg_hi:[0,1]
    v_pk_add_f32 v[172:173], v[102:103], v[146:147] neg_lo:[0,1] neg_hi:[0,1]
    v_pk_add_f32 v[174:175], v[104:105], v[146:147] neg_lo:[0,1] neg_hi:[0,1]
    v_pk_add_f32 v[176:177], v[106:107], v[146:147] neg_lo:[0,1] neg_hi:[0,1]
    v_pk_add_f32 v[178:179], v[108:109], v[146:147] neg_lo:[0,1] neg_hi:[0,1]
    v_pk_add_f32 v[180:181], v[110:111], v[146:147] neg_lo:[0,1] neg_hi:[0,1]
    v_pk_mul_f32 v[112:113], v[150:151], v[150:151]
    v_pk_mul_f32 v[114:115], v[152:153], v[152:153]
    v_pk_mul_f32 v[116:117], v[154:155], v[154:155]
    v_pk_mul_f32 v[118:119], v[156:157], v[156:157]
    v_pk_fma_f32 v[112:113], v[158:159], v[158:159], v[112:113]
    v_pk_fma_f32 v[114:115], v[160:161], v[160:161], v[114:115]
    v_pk_fma_f32 v[116:117], v[162:163], v[162:163], v[116:117]
    v_pk_fma_f32 v[118:119], v[164:165], v[164:165], v[118:119]
    v_pk_fma_f32 v[112:113], v[166:167], v[166:167], v[112:113]
    v_pk_fma_f32 v[114:115], v[168:169], v[168:169], v[114:115]
    v_pk_fma_f32 v[116:117], v[170:171], v[170:171], v[116:117]
    v_pk_fma_f32 v[118:119], v[172:173], v[172:173], v[118:119]
    v_pk_fma_f32 v[112:113], v[174:175], v[174:175], v[112:113]
    v_pk_fma_f32 v[114:115], v[176:177], v[176:177], v[114:115]
    v_pk_fma_f32 v[116:117], v[178:179], v[178:179], v[116:117]
    v_pk_fma_f32 v[118:119], v[180:181], v[180:181], v[118:119]
    v_pk_add_f32 v[112:113], v[112:113], v[114:115]
    v_pk_add_f32 v[114:115], v[116:117], v[118:119]
    v_pk_add_f32 v[112:113], v[112:113], v[114:115]
    v_add_f32 v112, v112, v113
    s_nop 1
    v_add_f32_dpp v112, v112, v112 row_ror:8 row_mask:0xf bank_mask:0xf
    s_nop 1
    v_add_f32_dpp v112, v112, v112 row_ror:4 row_mask:0xf bank_mask:0xf
    s_nop 1
    v_add_f32_dpp v112, v112, v112 row_ror:2 row_mask:0xf bank_mask:0xf
    s_nop 1
    v_add_f32_dpp v112, v112, v112 row_ror:1 row_mask:0xf bank_mask:0xf
    v_mov_b32 v113, v112
    s_nop 1
    v_permlane16_swap_b32 v113, v112
    s_nop 1
    v_add_f32 v112, v112, v113
    v_mul_f32 v148, s53, v112
    v_cvt_pk_bf16_f32 v148, v148, v148
    v_lshlrev_b32 v148, 16, v148
    v_add_f32 v148, s54, v148
    v_cvt_pk_bf16_f32 v148, v148, v148
    v_lshlrev_b32 v148, 16, v148
    v_sqrt_f32 v148, v148
    s_nop 0
    v_cvt_pk_bf16_f32 v148, v148, v148
    v_lshlrev_b32 v148, 16, v148
    v_rcp_f32 v148, v148
    v_cvt_pk_bf16_f32 v146, v146, v146
    v_lshlrev_b32 v146, 16, v146
    v_mov_b32 v147, v146
    v_mov_b32 v149, v148
    v_pk_add_f32 v[80:81], v[80:81], v[146:147] neg_lo:[0,1] neg_hi:[0,1]
    v_pk_add_f32 v[82:83], v[82:83], v[146:147] neg_lo:[0,1] neg_hi:[0,1]
    v_pk_add_f32 v[84:85], v[84:85], v[146:147] neg_lo:[0,1] neg_hi:[0,1]
    v_pk_add_f32 v[86:87], v[86:87], v[146:147] neg_lo:[0,1] neg_hi:[0,1]
    v_pk_add_f32 v[88:89], v[88:89], v[146:147] neg_lo:[0,1] neg_hi:[0,1]
    v_pk_add_f32 v[90:91], v[90:91], v[146:147] neg_lo:[0,1] neg_hi:[0,1]
    v_pk_add_f32 v[92:93], v[92:93], v[146:147] neg_lo:[0,1] neg_hi:[0,1]
    v_pk_add_f32 v[94:95], v[94:95], v[146:147] neg_lo:[0,1] neg_hi:[0,1]
    v_pk_add_f32 v[96:97], v[96:97], v[146:147] neg_lo:[0,1] neg_hi:[0,1]
    v_pk_add_f32 v[98:99], v[98:99], v[146:147] neg_lo:[0,1] neg_hi:[0,1]
    v_pk_add_f32 v[100:101], v[100:101], v[146:147] neg_lo:[0,1] neg_hi:[0,1]
    v_pk_add_f32 v[102:103], v[102:103], v[146:147] neg_lo:[0,1] neg_hi:[0,1]
    v_pk_add_f32 v[104:105], v[104:105], v[146:147] neg_lo:[0,1] neg_hi:[0,1]
    v_pk_add_f32 v[106:107], v[106:107], v[146:147] neg_lo:[0,1] neg_hi:[0,1]
    v_pk_add_f32 v[108:109], v[108:109], v[146:147] neg_lo:[0,1] neg_hi:[0,1]
    v_pk_add_f32 v[110:111], v[110:111], v[146:147] neg_lo:[0,1] neg_hi:[0,1]
    v_cvt_pk_bf16_f32 v64, v80, v81
    v_cvt_pk_bf16_f32 v65, v82, v83
    v_cvt_pk_bf16_f32 v66, v84, v85
    v_cvt_pk_bf16_f32 v67, v86, v87
    v_cvt_pk_bf16_f32 v68, v88, v89
    v_cvt_pk_bf16_f32 v69, v90, v91
    v_cvt_pk_bf16_f32 v70, v92, v93
    v_cvt_pk_bf16_f32 v71, v94, v95
    v_cvt_pk_bf16_f32 v72, v96, v97
    v_cvt_pk_bf16_f32 v73, v98, v99
    v_cvt_pk_bf16_f32 v74, v100, v101
    v_cvt_pk_bf16_f32 v75, v102, v103
    v_cvt_pk_bf16_f32 v76, v104, v105
    v_cvt_pk_bf16_f32 v77, v106, v107
    v_cvt_pk_bf16_f32 v78, v108, v109
    v_cvt_pk_bf16_f32 v79, v110, v111
    v_lshlrev_b32 v80, 16, v64
    v_and_b32 v81, s52, v64
    v_lshlrev_b32 v82, 16, v65
    v_and_b32 v83, s52, v65
    v_lshlrev_b32 v84, 16, v66
    v_and_b32 v85, s52, v66
    v_lshlrev_b32 v86, 16, v67
    v_and_b32 v87, s52, v67
    v_lshlrev_b32 v88, 16, v68
    v_and_b32 v89, s52, v68
    v_lshlrev_b32 v90, 16, v69
    v_and_b32 v91, s52, v69
    v_lshlrev_b32 v92, 16, v70
    v_and_b32 v93, s52, v70
    v_lshlrev_b32 v94, 16, v71
    v_and_b32 v95, s52, v71
    v_lshlrev_b32 v96, 16, v72
    v_and_b32 v97, s52, v72
    v_lshlrev_b32 v98, 16, v73
    v_and_b32 v99, s52, v73
    v_lshlrev_b32 v100, 16, v74
    v_and_b32 v101, s52, v74
    v_lshlrev_b32 v102, 16, v75
    v_and_b32 v103, s52, v75
    v_lshlrev_b32 v104, 16, v76
    v_and_b32 v105, s52, v76
    v_lshlrev_b32 v106, 16, v77
    v_and_b32 v107, s52, v77
    v_lshlrev_b32 v108, 16, v78
    v_and_b32 v109, s52, v78
    v_lshlrev_b32 v110, 16, v79
    v_and_b32 v111, s52, v79
    v_pk_mul_f32 v[80:81], v[80:81], v[148:149]
    v_pk_mul_f32 v[82:83], v[82:83], v[148:149]
    v_pk_mul_f32 v[84:85], v[84:85], v[148:149]
    v_pk_mul_f32 v[86:87], v[86:87], v[148:149]
    v_pk_mul_f32 v[88:89], v[88:89], v[148:149]
    v_pk_mul_f32 v[90:91], v[90:91], v[148:149]
    v_pk_mul_f32 v[92:93], v[92:93], v[148:149]
    v_pk_mul_f32 v[94:95], v[94:95], v[148:149]
    v_pk_mul_f32 v[96:97], v[96:97], v[148:149]
    v_pk_mul_f32 v[98:99], v[98:99], v[148:149]
    v_pk_mul_f32 v[100:101], v[100:101], v[148:149]
    v_pk_mul_f32 v[102:103], v[102:103], v[148:149]
    v_pk_mul_f32 v[104:105], v[104:105], v[148:149]
    v_pk_mul_f32 v[106:107], v[106:107], v[148:149]
    v_pk_mul_f32 v[108:109], v[108:109], v[148:149]
    v_pk_mul_f32 v[110:111], v[110:111], v[148:149]
    v_cvt_pk_bf16_f32 v64, v80, v81
    v_cvt_pk_bf16_f32 v65, v82, v83
    v_cvt_pk_bf16_f32 v66, v84, v85
    v_cvt_pk_bf16_f32 v67, v86, v87
    v_cvt_pk_bf16_f32 v68, v88, v89
    v_cvt_pk_bf16_f32 v69, v90, v91
    v_cvt_pk_bf16_f32 v70, v92, v93
    v_cvt_pk_bf16_f32 v71, v94, v95
    v_cvt_pk_bf16_f32 v72, v96, v97
    v_cvt_pk_bf16_f32 v73, v98, v99
    v_cvt_pk_bf16_f32 v74, v100, v101
    v_cvt_pk_bf16_f32 v75, v102, v103
    v_cvt_pk_bf16_f32 v76, v104, v105
    v_cvt_pk_bf16_f32 v77, v106, v107
    v_cvt_pk_bf16_f32 v78, v108, v109
    v_cvt_pk_bf16_f32 v79, v110, v111
    ds_write_b128 v144, v[64:67] offset:16384
    ds_write_b128 v144, v[68:71] offset:20480
    ds_write_b128 v144, v[72:75] offset:24576
    ds_write_b128 v144, v[76:79] offset:28672
    v_lshrrev_b32 v146, 3, v1
    v_add_u32 v144, v146, v1
    v_and_b32 v144, 7, v144
    v_lshlrev_b32 v144, 4, v144
    v_lshl_add_u32 v144, v146, 7, v144
    s_lshl_b32 s52, s33, 12
    s_add_u32 s52, s52, 114688
    v_add_u32 v144, s52, v144
    v_lshrrev_b32 v145, 5, v56
    v_lshlrev_b32 v145, 16, v145
    v_lshl_add_u32 v145, v146, 9, v145
    v_and_b32 v146, 24, v56
    v_and_b32 v148, 7, v1
    v_add_u32 v146, v146, v148
    v_lshl_add_u32 v145, v146, 4, v145
    s_lshl_b32 s52, s33, 14
    s_waitcnt lgkmcnt(0)
    s_barrier
    ds_read_b128 v[80:83], v144 offset:0
    ds_read_b128 v[84:87], v144 offset:1024
    ds_read_b128 v[88:91], v144 offset:2048
    ds_read_b128 v[92:95], v144 offset:3072
    ds_read_b128 v[96:99], v144 offset:16384
    ds_read_b128 v[100:103], v144 offset:17408
    ds_read_b128 v[104:107], v144 offset:18432
    ds_read_b128 v[108:111], v144 offset:19456
    s_add_u32 s55, s52, 0x0
    s_waitcnt lgkmcnt(7)
    buffer_store_dwordx4 v[80:83], v145, s[44:47], s55 offen sc1
    s_add_u32 s55, s52, 0x1000
    s_waitcnt lgkmcnt(6)
    buffer_store_dwordx4 v[84:87], v145, s[44:47], s55 offen sc1
    s_add_u32 s55, s52, 0x2000
    s_waitcnt lgkmcnt(5)
    buffer_store_dwordx4 v[88:91], v145, s[44:47], s55 offen sc1
    s_add_u32 s55, s52, 0x3000
    s_waitcnt lgkmcnt(4)
    buffer_store_dwordx4 v[92:95], v145, s[44:47], s55 offen sc1
    s_add_u32 s55, s52, 0x400000
    s_waitcnt lgkmcnt(3)
    buffer_store_dwordx4 v[96:99], v145, s[44:47], s55 offen sc1
    s_add_u32 s55, s52, 0x401000
    s_waitcnt lgkmcnt(2)
    buffer_store_dwordx4 v[100:103], v145, s[44:47], s55 offen sc1
    s_add_u32 s55, s52, 0x402000
    s_waitcnt lgkmcnt(1)
    buffer_store_dwordx4 v[104:107], v145, s[44:47], s55 offen sc1
    s_add_u32 s55, s52, 0x403000
    s_waitcnt lgkmcnt(0)
    buffer_store_dwordx4 v[108:111], v145, s[44:47], s55 offen sc1
    v_lshrrev_b32 v8, 4, v0
    v_lshl_add_u32 v8, v8, 8, s2
    v_mul_u32_u24 v8, 4352, v8
    v_and_b32 v9, 15, v0
    v_lshl_add_u32 v8, v9, 2, v8
    v_mov_b32 v9, 0
    buffer_store_dword v9, v8, s[60:63], 0 offen
    s_mul_i32 s37, s31, 4
    v_add_u32 v22, s37, v1
    v_mul_u32_u24 v22, 4352, v22
    s_lshl_b32 s39, s32, 2
    v_add_u32 v22, s39, v22
    s_and_b32 s39, s32, 3
    s_add_u32 s37, s37, s39
    s_mul_i32 s37, s37, 4352
    v_and_b32 v23, 31, v1
    v_lshlrev_b32 v23, 2, v23
    v_add_u32 v23, s37, v23
    s_mov_b32 s43, 0
    s_waitcnt vmcnt(0)
    s_barrier
    s_cmp_lg_u32 s33, 0
    s_cbranch_scc1 g1_a_pub
    v_cmp_eq_u32 vcc, 0, v21
    s_cbranch_vccz g1_a_tag
g1_a_tagpoll:
    buffer_load_dword v21, v20, s[48:51], 0 offen sc1
    s_add_u32 s43, s43, 1
    s_waitcnt vmcnt(0)
    v_cmp_eq_u32 vcc, 0, v21
    s_cmp_ge_u32 s43, 0x8000
    s_cbranch_scc1 g1_a_tag
    s_cbranch_vccnz g1_a_tagpoll
g1_a_tag:
    s_mov_b64 exec, 15
    buffer_store_dword v21, v22, s[64:67], 0 offen sc1
    s_mov_b64 exec, -1
g1_a_pub:
    s_add_u32 m0, s38, 24576
    s_add_u32 s27, s24, 0
    buffer_load_dwordx4 v3, s[8:11], s27 offen lds
    s_add_u32 m0, s38, 25600
    s_add_u32 s27, s24, 2048
    buffer_load_dwordx4 v3, s[8:11], s27 offen lds
    s_add_u32 m0, s38, 26624
    s_add_u32 s27, s24, 4096
    buffer_load_dwordx4 v3, s[8:11], s27 offen lds
    s_add_u32 m0, s38, 27648
    s_add_u32 s27, s24, 0
    buffer_load_dwordx4 v4, s[8:11], s27 offen lds
    s_add_u32 m0, s38, 28672
    s_add_u32 s27, s24, 2048
    buffer_load_dwordx4 v4, s[8:11], s27 offen lds
    s_add_u32 m0, s38, 29696
    s_add_u32 s27, s24, 4096
    buffer_load_dwordx4 v4, s[8:11], s27 offen lds
    s_add_u32 s24, s24, 393216
    s_add_u32 m0, s38, 49152
    s_add_u32 s27, s24, 0
    buffer_load_dwordx4 v3, s[8:11], s27 offen lds
    s_add_u32 m0, s38, 50176
    s_add_u32 s27, s24, 2048
    buffer_load_dwordx4 v3, s[8:11], s27 offen lds
    s_add_u32 m0, s38, 51200
    s_add_u32 s27, s24, 4096
    buffer_load_dwordx4 v3, s[8:11], s27 offen lds
    s_mov_b32 s3, 393216
    buffer_load_dword v45, v44, s[8:11], s3 offen
    s_mov_b32 s3, 786432
    buffer_load_dword v45, v44, s[8:11], s3 offen
    v_mov_b32 v64, 0
    v_mov_b32 v65, 0
    v_mov_b32 v66, 0
    v_mov_b32 v67, 0
    v_mov_b32 v68, 0
    v_mov_b32 v69, 0
    v_mov_b32 v70, 0
    v_mov_b32 v71, 0
    v_mov_b32 v72, 0
    v_mov_b32 v73, 0
    v_mov_b32 v74, 0
    v_mov_b32 v75, 0
    v_mov_b32 v76, 0
    v_mov_b32 v77, 0
    v_mov_b32 v78, 0
    v_mov_b32 v79, 0
    v_mov_b32 v80, 0
    v_mov_b32 v81, 0
    v_mov_b32 v82, 0
    v_mov_b32 v83, 0
    v_mov_b32 v84, 0
    v_mov_b32 v85, 0
    v_mov_b32 v86, 0
    v_mov_b32 v87, 0
    v_mov_b32 v88, 0
    v_mov_b32 v89, 0
    v_mov_b32 v90, 0
    v_mov_b32 v91, 0
    v_mov_b32 v92, 0
    v_mov_b32 v93, 0
    v_mov_b32 v94, 0
    v_mov_b32 v95, 0
    v_mov_b32 v96, 0
    v_mov_b32 v97, 0
    v_mov_b32 v98, 0
    v_mov_b32 v99, 0
    v_mov_b32 v100, 0
    v_mov_b32 v101, 0
    v_mov_b32 v102, 0
    v_mov_b32 v103, 0
    v_mov_b32 v104, 0
    v_mov_b32 v105, 0
    v_mov_b32 v106, 0
    v_mov_b32 v107, 0
    v_mov_b32 v108, 0
    v_mov_b32 v109, 0
    v_mov_b32 v110, 0
    v_mov_b32 v111, 0
    v_mov_b32 v112, 0
    v_mov_b32 v113, 0
    v_mov_b32 v114, 0
    v_mov_b32 v115, 0
    v_mov_b32 v116, 0
    v_mov_b32 v117, 0
    v_mov_b32 v118, 0
    v_mov_b32 v119, 0
    v_mov_b32 v120, 0
    v_mov_b32 v121, 0
    v_mov_b32 v122, 0
    v_mov_b32 v123, 0
    v_mov_b32 v124, 0
    v_mov_b32 v125, 0
    v_mov_b32 v126, 0
    v_mov_b32 v127, 0
    v_mov_b32 v128, 0
    v_mov_b32 v129, 0
    v_mov_b32 v130, 0
    v_mov_b32 v131, 0
    v_mov_b32 v132, 0
    v_mov_b32 v133, 0
    v_mov_b32 v134, 0
    v_mov_b32 v135, 0
    v_mov_b32 v136, 0
    v_mov_b32 v137, 0
    v_mov_b32 v138, 0
    v_mov_b32 v139, 0
    v_mov_b32 v140, 0
    v_mov_b32 v141, 0
    v_mov_b32 v142, 0
    v_mov_b32 v143, 0
    v_mov_b32 v144, 0
    v_mov_b32 v145, 0
    v_mov_b32 v146, 0
    v_mov_b32 v147, 0
    v_mov_b32 v148, 0
    v_mov_b32 v149, 0
    v_mov_b32 v150, 0
    v_mov_b32 v151, 0
    v_mov_b32 v152, 0
    v_mov_b32 v153, 0
    v_mov_b32 v154, 0
    v_mov_b32 v155, 0
    v_mov_b32 v156, 0
    v_mov_b32 v157, 0
    v_mov_b32 v158, 0
    v_mov_b32 v159, 0
    v_mov_b32 v160, 0
    v_mov_b32 v161, 0
    v_mov_b32 v162, 0
    v_mov_b32 v163, 0
    v_mov_b32 v164, 0
    v_mov_b32 v165, 0
    v_mov_b32 v166, 0
    v_mov_b32 v167, 0
    v_mov_b32 v168, 0
    v_mov_b32 v169, 0
    v_mov_b32 v170, 0
    v_mov_b32 v171, 0
    v_mov_b32 v172, 0
    v_mov_b32 v173, 0
    v_mov_b32 v174, 0
    v_mov_b32 v175, 0
    v_mov_b32 v176, 0
    v_mov_b32 v177, 0
    v_mov_b32 v178, 0
    v_mov_b32 v179, 0
    v_mov_b32 v180, 0
    v_mov_b32 v181, 0
    v_mov_b32 v182, 0
    v_mov_b32 v183, 0
    v_mov_b32 v184, 0
    v_mov_b32 v185, 0
    v_mov_b32 v186, 0
    v_mov_b32 v187, 0
    v_mov_b32 v188, 0
    v_mov_b32 v189, 0
    v_mov_b32 v190, 0
    v_mov_b32 v191, 0
    v_mov_b32 v192, 0
    v_mov_b32 v193, 0
    v_mov_b32 v194, 0
    v_mov_b32 v195, 0
    v_mov_b32 v196, 0
    v_mov_b32 v197, 0
    v_mov_b32 v198, 0
    v_mov_b32 v199, 0
    v_mov_b32 v200, 0
    v_mov_b32 v201, 0
    v_mov_b32 v202, 0
    v_mov_b32 v203, 0
    v_mov_b32 v204, 0
    v_mov_b32 v205, 0
    v_mov_b32 v206, 0
    v_mov_b32 v207, 0
    v_mov_b32 v208, 0
    v_mov_b32 v209, 0
    v_mov_b32 v210, 0
    v_mov_b32 v211, 0
    v_mov_b32 v212, 0
    v_mov_b32 v213, 0
    v_mov_b32 v214, 0
    v_mov_b32 v215, 0
    v_mov_b32 v216, 0
    v_mov_b32 v217, 0
    v_mov_b32 v218, 0
    v_mov_b32 v219, 0
    v_mov_b32 v220, 0
    v_mov_b32 v221, 0
    v_mov_b32 v222, 0
    v_mov_b32 v223, 0
    v_mov_b32 v224, 0
    v_mov_b32 v225, 0
    v_mov_b32 v226, 0
    v_mov_b32 v227, 0
    v_mov_b32 v228, 0
    v_mov_b32 v229, 0
    v_mov_b32 v230, 0
    v_mov_b32 v231, 0
    v_mov_b32 v232, 0
    v_mov_b32 v233, 0
    v_mov_b32 v234, 0
    v_mov_b32 v235, 0
    v_mov_b32 v236, 0
    v_mov_b32 v237, 0
    v_mov_b32 v238, 0
    v_mov_b32 v239, 0
    v_mov_b32 v240, 0
    v_mov_b32 v241, 0
    v_mov_b32 v242, 0
    v_mov_b32 v243, 0
    v_mov_b32 v244, 0
    v_mov_b32 v245, 0
    v_mov_b32 v246, 0
    v_mov_b32 v247, 0
    v_mov_b32 v248, 0
    v_mov_b32 v249, 0
    v_mov_b32 v250, 0
    v_mov_b32 v251, 0
    v_mov_b32 v252, 0
    v_mov_b32 v253, 0
    v_mov_b32 v254, 0
    v_mov_b32 v255, 0
    s_cmp_lg_u32 s33, 0
    s_cbranch_scc1 g1_a_rdy
g1_a_poll:
    s_add_u32 s43, s43, 1
    s_cmp_ge_u32 s43, 0x8000
    s_cbranch_scc1 g1_a_rdy
    buffer_load_dword v40, v23, s[64:67], 0 offen sc1
    s_waitcnt vmcnt(0)
    v_cmp_ne_u32 vcc, v21, v40
    s_cbranch_vccz g1_a_rdy
    s_branch g1_a_poll
g1_a_rdy:
    s_barrier
    buffer_load_dwordx4 a[0:3], v2, s[12:15], s25 offen offset:0
    buffer_load_dwordx4 a[4:7], v2, s[16:19], s25 offen offset:0
    buffer_load_dwordx4 a[8:11], v2, s[12:15], s25 offen offset:1024
    buffer_load_dwordx4 a[12:15], v2, s[16:19], s25 offen offset:1024
    buffer_load_dwordx4 a[16:19], v2, s[12:15], s25 offen offset:2048
    buffer_load_dwordx4 a[20:23], v2, s[16:19], s25 offen offset:2048
    buffer_load_dwordx4 a[24:27], v2, s[12:15], s25 offen offset:3072
    buffer_load_dwordx4 a[28:31], v2, s[16:19], s25 offen offset:3072
    s_add_u32 s25, s25, 4096
    buffer_load_dwordx4 a[32:35], v2, s[12:15], s25 offen offset:0
    buffer_load_dwordx4 a[36:39], v2, s[16:19], s25 offen offset:0
    buffer_load_dwordx4 a[40:43], v2, s[12:15], s25 offen offset:1024
    buffer_load_dwordx4 a[44:47], v2, s[16:19], s25 offen offset:1024
    buffer_load_dwordx4 a[48:51], v2, s[12:15], s25 offen offset:2048
    buffer_load_dwordx4 a[52:55], v2, s[16:19], s25 offen offset:2048
    ds_read_b64_tr_b16 a[64:65], v5 offset:0
    ds_read_b64_tr_b16 a[66:67], v5 offset:512
    ds_read_b64_tr_b16 a[68:69], v5 offset:256
    ds_read_b64_tr_b16 a[70:71], v5 offset:768
    ds_read_b64_tr_b16 a[72:73], v5 offset:1024
    ds_read_b64_tr_b16 a[74:75], v5 offset:1536
    ds_read_b64_tr_b16 a[76:77], v5 offset:1280
    ds_read_b64_tr_b16 a[78:79], v5 offset:1792
    ds_read_b64_tr_b16 a[80:81], v5 offset:2048
    ds_read_b64_tr_b16 a[82:83], v5 offset:2560
    ds_read_b64_tr_b16 a[84:85], v5 offset:2304
    ds_read_b64_tr_b16 a[86:87], v5 offset:2816
    s_waitcnt vmcnt(10)
    s_add_u32 s60, s28, 0x800000
    s_addc_u32 s61, s29, 0
    s_mov_b32 s62, 0xc00000
    s_mov_b32 s63, 0x20000
    s_lshl_b32 s71, s36, 11
    s_lshl_b32 s70, s32, 18
    s_add_u32 s71, s71, s70
    s_lshl_b32 s72, s71, 1
    s_add_u32 s72, s72, 0x400000
    v_mov_b32 v8, 0x3e8293ee
    v_mov_b32 v9, 0x3e8293ee
    s_lshl_b32 s37, s32, 3
    s_add_u32 s37, s37, s31
    s_lshl_b32 s37, s37, 2
    s_add_u32 s37, s37, s33
    s_mul_i32 s68, s37, 14336
    s_lshl_b32 s69, s37, 12
    v_lshlrev_b32 v10, 7, v1
    v_and_b32 v11, 0xfff, v10
    v_add_u32 v12, 0x1800, v10
    s_mov_b32 s44, s74
    s_mov_b32 s45, s75
    s_mov_b32 s46, 0x700000
    s_mov_b32 s47, 0x20000
    s_mov_b32 s48, s76
    s_mov_b32 s49, s77
    s_mov_b32 s50, 0x200000
    s_mov_b32 s51, 0x20000
    s_mov_b32 s26, 0
g1_a_loop:
    s_waitcnt vmcnt(23)
    s_waitcnt lgkmcnt(10)
    v_mfma_f32_32x32x16_bf16 v[64:79], a[64:67], a[0:3], v[64:79]
    v_mfma_f32_32x32x16_bf16 v[80:95], a[64:67], a[4:7], v[80:95]
    ds_read_b64_tr_b16 a[64:65], v5 offset:6144
    ds_read_b64_tr_b16 a[66:67], v5 offset:6656
    s_waitcnt lgkmcnt(10)
    v_mfma_f32_32x32x16_bf16 v[96:111], a[68:71], a[0:3], v[96:111]
    v_mfma_f32_32x32x16_bf16 v[112:127], a[68:71], a[4:7], v[112:127]
    ds_read_b64_tr_b16 a[68:69], v5 offset:6400
    ds_read_b64_tr_b16 a[70:71], v5 offset:6912
    buffer_load_dwordx4 a[56:59], v2, s[12:15], s25 offen offset:3072
    buffer_load_dwordx4 a[60:63], v2, s[16:19], s25 offen offset:3072
    s_add_u32 s25, s25, 4096
    s_waitcnt lgkmcnt(10)
    v_mfma_f32_32x32x16_bf16 v[128:143], a[72:75], a[0:3], v[128:143]
    v_mfma_f32_32x32x16_bf16 v[144:159], a[72:75], a[4:7], v[144:159]
    ds_read_b64_tr_b16 a[72:73], v5 offset:7168
    ds_read_b64_tr_b16 a[74:75], v5 offset:7680
    s_add_u32 m0, s38, 52224
    s_add_u32 s27, s24, 0
    buffer_load_dwordx4 v4, s[8:11], s27 offen lds
    s_waitcnt lgkmcnt(10)
    v_mfma_f32_32x32x16_bf16 v[160:175], a[76:79], a[0:3], v[160:175]
    v_mfma_f32_32x32x16_bf16 v[176:191], a[76:79], a[4:7], v[176:191]
    ds_read_b64_tr_b16 a[76:77], v5 offset:7424
    ds_read_b64_tr_b16 a[78:79], v5 offset:7936
    s_add_u32 m0, s38, 53248
    s_add_u32 s27, s24, 2048
    buffer_load_dwordx4 v4, s[8:11], s27 offen lds
    s_waitcnt lgkmcnt(10)
    v_mfma_f32_32x32x16_bf16 v[192:207], a[0:3], a[80:83], v[192:207]
    v_mfma_f32_32x32x16_bf16 v[208:223], a[4:7], a[80:83], v[208:223]
    ds_read_b64_tr_b16 a[80:81], v5 offset:8192
    ds_read_b64_tr_b16 a[82:83], v5 offset:8704
    s_add_u32 m0, s38, 54272
    s_add_u32 s27, s24, 4096
    buffer_load_dwordx4 v4, s[8:11], s27 offen lds
    s_add_u32 s24, s24, 393216
    s_waitcnt lgkmcnt(10)
    v_mfma_f32_32x32x16_bf16 v[224:239], a[0:3], a[84:87], v[224:239]
    v_mfma_f32_32x32x16_bf16 v[240:255], a[4:7], a[84:87], v[240:255]
    ds_read_b64_tr_b16 a[84:85], v5 offset:8448
    ds_read_b64_tr_b16 a[86:87], v5 offset:8960
    s_waitcnt vmcnt(25)
    s_waitcnt lgkmcnt(10)
    v_mfma_f32_32x32x16_bf16 v[64:79], a[64:67], a[8:11], v[64:79]
    v_mfma_f32_32x32x16_bf16 v[80:95], a[64:67], a[12:15], v[80:95]
    ds_read_b64_tr_b16 a[64:65], v5 offset:12288
    ds_read_b64_tr_b16 a[66:67], v5 offset:12800
    s_waitcnt lgkmcnt(10)
    v_mfma_f32_32x32x16_bf16 v[96:111], a[68:71], a[8:11], v[96:111]
    v_mfma_f32_32x32x16_bf16 v[112:127], a[68:71], a[12:15], v[112:127]
    ds_read_b64_tr_b16 a[68:69], v5 offset:12544
    ds_read_b64_tr_b16 a[70:71], v5 offset:13056
    buffer_load_dwordx4 a[0:3], v2, s[12:15], s25 offen offset:0
    buffer_load_dwordx4 a[4:7], v2, s[16:19], s25 offen offset:0
    s_waitcnt lgkmcnt(10)
    v_mfma_f32_32x32x16_bf16 v[128:143], a[72:75], a[8:11], v[128:143]
    v_mfma_f32_32x32x16_bf16 v[144:159], a[72:75], a[12:15], v[144:159]
    ds_read_b64_tr_b16 a[72:73], v5 offset:13312
    ds_read_b64_tr_b16 a[74:75], v5 offset:13824
    buffer_load_dword v45, v44, s[8:11], s24 offen
    s_waitcnt lgkmcnt(10)
    v_mfma_f32_32x32x16_bf16 v[160:175], a[76:79], a[8:11], v[160:175]
    v_mfma_f32_32x32x16_bf16 v[176:191], a[76:79], a[12:15], v[176:191]
    ds_read_b64_tr_b16 a[76:77], v5 offset:13568
    ds_read_b64_tr_b16 a[78:79], v5 offset:14080
    s_waitcnt lgkmcnt(10)
    v_mfma_f32_32x32x16_bf16 v[192:207], a[8:11], a[80:83], v[192:207]
    v_mfma_f32_32x32x16_bf16 v[208:223], a[12:15], a[80:83], v[208:223]
    ds_read_b64_tr_b16 a[80:81], v5 offset:14336
    ds_read_b64_tr_b16 a[82:83], v5 offset:14848
    s_waitcnt lgkmcnt(10)
    v_mfma_f32_32x32x16_bf16 v[224:239], a[8:11], a[84:87], v[224:239]
    v_mfma_f32_32x32x16_bf16 v[240:255], a[12:15], a[84:87], v[240:255]
    ds_read_b64_tr_b16 a[84:85], v5 offset:14592
    ds_read_b64_tr_b16 a[86:87], v5 offset:15104
    s_waitcnt vmcnt(16)
    s_waitcnt lgkmcnt(10)
    v_mfma_f32_32x32x16_bf16 v[64:79], a[64:67], a[16:19], v[64:79]
    v_mfma_f32_32x32x16_bf16 v[80:95], a[64:67], a[20:23], v[80:95]
    ds_read_b64_tr_b16 a[64:65], v5 offset:18432
    ds_read_b64_tr_b16 a[66:67], v5 offset:18944
    s_waitcnt lgkmcnt(10)
    v_mfma_f32_32x32x16_bf16 v[96:111], a[68:71], a[16:19], v[96:111]
    v_mfma_f32_32x32x16_bf16 v[112:127], a[68:71], a[20:23], v[112:127]
    ds_read_b64_tr_b16 a[68:69], v5 offset:18688
    ds_read_b64_tr_b16 a[70:71], v5 offset:19200
    buffer_load_dwordx4 a[8:11], v2, s[12:15], s25 offen offset:1024
    buffer_load_dwordx4 a[12:15], v2, s[16:19], s25 offen offset:1024
    s_waitcnt lgkmcnt(10)
    v_mfma_f32_32x32x16_bf16 v[128:143], a[72:75], a[16:19], v[128:143]
    v_mfma_f32_32x32x16_bf16 v[144:159], a[72:75], a[20:23], v[144:159]
    ds_read_b64_tr_b16 a[72:73], v5 offset:19456
    ds_read_b64_tr_b16 a[74:75], v5 offset:19968
    s_waitcnt lgkmcnt(10)
    v_mfma_f32_32x32x16_bf16 v[160:175], a[76:79], a[16:19], v[160:175]
    v_mfma_f32_32x32x16_bf16 v[176:191], a[76:79], a[20:23], v[176:191]
    ds_read_b64_tr_b16 a[76:77], v5 offset:19712
    ds_read_b64_tr_b16 a[78:79], v5 offset:20224
    s_waitcnt lgkmcnt(10)
    v_mfma_f32_32x32x16_bf16 v[192:207], a[16:19], a[80:83], v[192:207]
    v_mfma_f32_32x32x16_bf16 v[208:223], a[20:23], a[80:83], v[208:223]
    ds_read_b64_tr_b16 a[80:81], v5 offset:20480
    ds_read_b64_tr_b16 a[82:83], v5 offset:20992
    s_waitcnt lgkmcnt(10)
    v_mfma_f32_32x32x16_bf16 v[224:239], a[16:19], a[84:87], v[224:239]
    v_mfma_f32_32x32x16_bf16 v[240:255], a[20:23], a[84:87], v[240:255]
    ds_read_b64_tr_b16 a[84:85], v5 offset:20736
    ds_read_b64_tr_b16 a[86:87], v5 offset:21248
    s_waitcnt vmcnt(16)
    s_waitcnt lgkmcnt(10)
    v_mfma_f32_32x32x16_bf16 v[64:79], a[64:67], a[24:27], v[64:79]
    v_mfma_f32_32x32x16_bf16 v[80:95], a[64:67], a[28:31], v[80:95]
    s_waitcnt vmcnt(20)
    s_barrier
    ds_read_b64_tr_b16 a[64:65], v5 offset:24576
    ds_read_b64_tr_b16 a[66:67], v5 offset:25088
    s_waitcnt lgkmcnt(10)
    v_mfma_f32_32x32x16_bf16 v[96:111], a[68:71], a[24:27], v[96:111]
    v_mfma_f32_32x32x16_bf16 v[112:127], a[68:71], a[28:31], v[112:127]
    ds_read_b64_tr_b16 a[68:69], v5 offset:24832
    ds_read_b64_tr_b16 a[70:71], v5 offset:25344
    buffer_load_dwordx4 a[16:19], v2, s[12:15], s25 offen offset:2048
    buffer_load_dwordx4 a[20:23], v2, s[16:19], s25 offen offset:2048
    s_waitcnt lgkmcnt(10)
    v_mfma_f32_32x32x16_bf16 v[128:143], a[72:75], a[24:27], v[128:143]
    v_mfma_f32_32x32x16_bf16 v[144:159], a[72:75], a[28:31], v[144:159]
    ds_read_b64_tr_b16 a[72:73], v5 offset:25600
    ds_read_b64_tr_b16 a[74:75], v5 offset:26112
    s_add_u32 m0, s38, 73728
    s_add_u32 s27, s24, 0
    buffer_load_dwordx4 v3, s[8:11], s27 offen lds
    s_waitcnt lgkmcnt(10)
    v_mfma_f32_32x32x16_bf16 v[160:175], a[76:79], a[24:27], v[160:175]
    v_mfma_f32_32x32x16_bf16 v[176:191], a[76:79], a[28:31], v[176:191]
    ds_read_b64_tr_b16 a[76:77], v5 offset:25856
    ds_read_b64_tr_b16 a[78:79], v5 offset:26368
    s_add_u32 m0, s38, 74752
    s_add_u32 s27, s24, 2048
    buffer_load_dwordx4 v3, s[8:11], s27 offen lds
    s_waitcnt lgkmcnt(10)
    v_mfma_f32_32x32x16_bf16 v[192:207], a[24:27], a[80:83], v[192:207]
    v_mfma_f32_32x32x16_bf16 v[208:223], a[28:31], a[80:83], v[208:223]
    ds_read_b64_tr_b16 a[80:81], v5 offset:26624
    ds_read_b64_tr_b16 a[82:83], v5 offset:27136
    s_add_u32 m0, s38, 75776
    s_add_u32 s27, s24, 4096
    buffer_load_dwordx4 v3, s[8:11], s27 offen lds
    s_waitcnt lgkmcnt(10)
    v_mfma_f32_32x32x16_bf16 v[224:239], a[24:27], a[84:87], v[224:239]
    v_mfma_f32_32x32x16_bf16 v[240:255], a[28:31], a[84:87], v[240:255]
    ds_read_b64_tr_b16 a[84:85], v5 offset:26880
    ds_read_b64_tr_b16 a[86:87], v5 offset:27392
    s_waitcnt vmcnt(19)
    s_waitcnt lgkmcnt(10)
    v_mfma_f32_32x32x16_bf16 v[64:79], a[64:67], a[32:35], v[64:79]
    v_mfma_f32_32x32x16_bf16 v[80:95], a[64:67], a[36:39], v[80:95]
    ds_read_b64_tr_b16 a[64:65], v5 offset:30720
    ds_read_b64_tr_b16 a[66:67], v5 offset:31232
    s_waitcnt lgkmcnt(10)
    v_mfma_f32_32x32x16_bf16 v[96:111], a[68:71], a[32:35], v[96:111]
    v_mfma_f32_32x32x16_bf16 v[112:127], a[68:71], a[36:39], v[112:127]
    ds_read_b64_tr_b16 a[68:69], v5 offset:30976
    ds_read_b64_tr_b16 a[70:71], v5 offset:31488
    buffer_load_dwordx4 a[24:27], v2, s[12:15], s25 offen offset:3072
    buffer_load_dwordx4 a[28:31], v2, s[16:19], s25 offen offset:3072
    s_add_u32 s25, s25, 4096
    s_waitcnt lgkmcnt(10)
    v_mfma_f32_32x32x16_bf16 v[128:143], a[72:75], a[32:35], v[128:143]
    v_mfma_f32_32x32x16_bf16 v[144:159], a[72:75], a[36:39], v[144:159]
    ds_read_b64_tr_b16 a[72:73], v5 offset:31744
    ds_read_b64_tr_b16 a[74:75], v5 offset:32256
    s_add_u32 m0, s38, 76800
    s_add_u32 s27, s24, 0
    buffer_load_dwordx4 v4, s[8:11], s27 offen lds
    s_waitcnt lgkmcnt(10)
    v_mfma_f32_32x32x16_bf16 v[160:175], a[76:79], a[32:35], v[160:175]
    v_mfma_f32_32x32x16_bf16 v[176:191], a[76:79], a[36:39], v[176:191]
    ds_read_b64_tr_b16 a[76:77], v5 offset:32000
    ds_read_b64_tr_b16 a[78:79], v5 offset:32512
    s_add_u32 m0, s38, 77824
    s_add_u32 s27, s24, 2048
    buffer_load_dwordx4 v4, s[8:11], s27 offen lds
    s_waitcnt lgkmcnt(10)
    v_mfma_f32_32x32x16_bf16 v[192:207], a[32:35], a[80:83], v[192:207]
    v_mfma_f32_32x32x16_bf16 v[208:223], a[36:39], a[80:83], v[208:223]
    ds_read_b64_tr_b16 a[80:81], v5 offset:32768
    ds_read_b64_tr_b16 a[82:83], v5 offset:33280
    s_add_u32 m0, s38, 78848
    s_add_u32 s27, s24, 4096
    buffer_load_dwordx4 v4, s[8:11], s27 offen lds
    s_add_u32 s24, s24, 393216
    s_waitcnt lgkmcnt(10)
    v_mfma_f32_32x32x16_bf16 v[224:239], a[32:35], a[84:87], v[224:239]
    v_mfma_f32_32x32x16_bf16 v[240:255], a[36:39], a[84:87], v[240:255]
    ds_read_b64_tr_b16 a[84:85], v5 offset:33024
    ds_read_b64_tr_b16 a[86:87], v5 offset:33536
    s_waitcnt vmcnt(22)
    s_waitcnt lgkmcnt(10)
    v_mfma_f32_32x32x16_bf16 v[64:79], a[64:67], a[40:43], v[64:79]
    v_mfma_f32_32x32x16_bf16 v[80:95], a[64:67], a[44:47], v[80:95]
    ds_read_b64_tr_b16 a[64:65], v5 offset:36864
    ds_read_b64_tr_b16 a[66:67], v5 offset:37376
    s_waitcnt lgkmcnt(10)
    v_mfma_f32_32x32x16_bf16 v[96:111], a[68:71], a[40:43], v[96:111]
    v_mfma_f32_32x32x16_bf16 v[112:127], a[68:71], a[44:47], v[112:127]
    ds_read_b64_tr_b16 a[68:69], v5 offset:37120
    ds_read_b64_tr_b16 a[70:71], v5 offset:37632
    buffer_load_dwordx4 a[32:35], v2, s[12:15], s25 offen offset:0
    buffer_load_dwordx4 a[36:39], v2, s[16:19], s25 offen offset:0
    s_waitcnt lgkmcnt(10)
    v_mfma_f32_32x32x16_bf16 v[128:143], a[72:75], a[40:43], v[128:143]
    v_mfma_f32_32x32x16_bf16 v[144:159], a[72:75], a[44:47], v[144:159]
    ds_read_b64_tr_b16 a[72:73], v5 offset:37888
    ds_read_b64_tr_b16 a[74:75], v5 offset:38400
    buffer_load_dword v45, v44, s[8:11], s24 offen
    s_waitcnt lgkmcnt(10)
    v_mfma_f32_32x32x16_bf16 v[160:175], a[76:79], a[40:43], v[160:175]
    v_mfma_f32_32x32x16_bf16 v[176:191], a[76:79], a[44:47], v[176:191]
    ds_read_b64_tr_b16 a[76:77], v5 offset:38144
    ds_read_b64_tr_b16 a[78:79], v5 offset:38656
    s_waitcnt lgkmcnt(10)
    v_mfma_f32_32x32x16_bf16 v[192:207], a[40:43], a[80:83], v[192:207]
    v_mfma_f32_32x32x16_bf16 v[208:223], a[44:47], a[80:83], v[208:223]
    ds_read_b64_tr_b16 a[80:81], v5 offset:38912
    ds_read_b64_tr_b16 a[82:83], v5 offset:39424
    s_waitcnt lgkmcnt(10)
    v_mfma_f32_32x32x16_bf16 v[224:239], a[40:43], a[84:87], v[224:239]
    v_mfma_f32_32x32x16_bf16 v[240:255], a[44:47], a[84:87], v[240:255]
    ds_read_b64_tr_b16 a[84:85], v5 offset:39168
    ds_read_b64_tr_b16 a[86:87], v5 offset:39680
    s_waitcnt vmcnt(23)
    s_waitcnt lgkmcnt(10)
    v_mfma_f32_32x32x16_bf16 v[64:79], a[64:67], a[48:51], v[64:79]
    v_mfma_f32_32x32x16_bf16 v[80:95], a[64:67], a[52:55], v[80:95]
    ds_read_b64_tr_b16 a[64:65], v5 offset:43008
    ds_read_b64_tr_b16 a[66:67], v5 offset:43520
    s_waitcnt lgkmcnt(10)
    v_mfma_f32_32x32x16_bf16 v[96:111], a[68:71], a[48:51], v[96:111]
    v_mfma_f32_32x32x16_bf16 v[112:127], a[68:71], a[52:55], v[112:127]
    ds_read_b64_tr_b16 a[68:69], v5 offset:43264
    ds_read_b64_tr_b16 a[70:71], v5 offset:43776
    buffer_load_dwordx4 a[40:43], v2, s[12:15], s25 offen offset:1024
    buffer_load_dwordx4 a[44:47], v2, s[16:19], s25 offen offset:1024
    s_waitcnt lgkmcnt(10)
    v_mfma_f32_32x32x16_bf16 v[128:143], a[72:75], a[48:51], v[128:143]
    v_mfma_f32_32x32x16_bf16 v[144:159], a[72:75], a[52:55], v[144:159]
    ds_read_b64_tr_b16 a[72:73], v5 offset:44032
    ds_read_b64_tr_b16 a[74:75], v5 offset:44544
    s_waitcnt lgkmcnt(10)
    v_mfma_f32_32x32x16_bf16 v[160:175], a[76:79], a[48:51], v[160:175]
    v_mfma_f32_32x32x16_bf16 v[176:191], a[76:79], a[52:55], v[176:191]
    ds_read_b64_tr_b16 a[76:77], v5 offset:44288
    ds_read_b64_tr_b16 a[78:79], v5 offset:44800
    s_waitcnt lgkmcnt(10)
    v_mfma_f32_32x32x16_bf16 v[192:207], a[48:51], a[80:83], v[192:207]
    v_mfma_f32_32x32x16_bf16 v[208:223], a[52:55], a[80:83], v[208:223]
    ds_read_b64_tr_b16 a[80:81], v5 offset:45056
    ds_read_b64_tr_b16 a[82:83], v5 offset:45568
    s_waitcnt lgkmcnt(10)
    v_mfma_f32_32x32x16_bf16 v[224:239], a[48:51], a[84:87], v[224:239]
    v_mfma_f32_32x32x16_bf16 v[240:255], a[52:55], a[84:87], v[240:255]
    ds_read_b64_tr_b16 a[84:85], v5 offset:45312
    ds_read_b64_tr_b16 a[86:87], v5 offset:45824
    s_waitcnt vmcnt(23)
    s_waitcnt lgkmcnt(10)
    v_mfma_f32_32x32x16_bf16 v[64:79], a[64:67], a[56:59], v[64:79]
    v_mfma_f32_32x32x16_bf16 v[80:95], a[64:67], a[60:63], v[80:95]
    s_waitcnt vmcnt(20)
    s_barrier
    ds_read_b64_tr_b16 a[64:65], v7 offset:0
    ds_read_b64_tr_b16 a[66:67], v7 offset:512
    s_waitcnt lgkmcnt(10)
    v_mfma_f32_32x32x16_bf16 v[96:111], a[68:71], a[56:59], v[96:111]
    v_mfma_f32_32x32x16_bf16 v[112:127], a[68:71], a[60:63], v[112:127]
    ds_read_b64_tr_b16 a[68:69], v7 offset:256
    ds_read_b64_tr_b16 a[70:71], v7 offset:768
    buffer_load_dwordx4 a[48:51], v2, s[12:15], s25 offen offset:2048
    buffer_load_dwordx4 a[52:55], v2, s[16:19], s25 offen offset:2048
    s_waitcnt lgkmcnt(10)
    v_mfma_f32_32x32x16_bf16 v[128:143], a[72:75], a[56:59], v[128:143]
    v_mfma_f32_32x32x16_bf16 v[144:159], a[72:75], a[60:63], v[144:159]
    ds_read_b64_tr_b16 a[72:73], v7 offset:1024
    ds_read_b64_tr_b16 a[74:75], v7 offset:1536
    s_add_u32 m0, s38, 0
    s_add_u32 s27, s24, 0
    buffer_load_dwordx4 v3, s[8:11], s27 offen lds
    s_waitcnt lgkmcnt(10)
    v_mfma_f32_32x32x16_bf16 v[160:175], a[76:79], a[56:59], v[160:175]
    v_mfma_f32_32x32x16_bf16 v[176:191], a[76:79], a[60:63], v[176:191]
    ds_read_b64_tr_b16 a[76:77], v7 offset:1280
    ds_read_b64_tr_b16 a[78:79], v7 offset:1792
    s_add_u32 m0, s38, 1024
    s_add_u32 s27, s24, 2048
    buffer_load_dwordx4 v3, s[8:11], s27 offen lds
    s_waitcnt lgkmcnt(10)
    v_mfma_f32_32x32x16_bf16 v[192:207], a[56:59], a[80:83], v[192:207]
    v_mfma_f32_32x32x16_bf16 v[208:223], a[60:63], a[80:83], v[208:223]
    ds_read_b64_tr_b16 a[80:81], v7 offset:2048
    ds_read_b64_tr_b16 a[82:83], v7 offset:2560
    s_add_u32 m0, s38, 2048
    s_add_u32 s27, s24, 4096
    buffer_load_dwordx4 v3, s[8:11], s27 offen lds
    s_waitcnt lgkmcnt(10)
    v_mfma_f32_32x32x16_bf16 v[224:239], a[56:59], a[84:87], v[224:239]
    v_mfma_f32_32x32x16_bf16 v[240:255], a[60:63], a[84:87], v[240:255]
    ds_read_b64_tr_b16 a[84:85], v7 offset:2304
    ds_read_b64_tr_b16 a[86:87], v7 offset:2816
    s_waitcnt vmcnt(23)
    s_waitcnt lgkmcnt(10)
    v_mfma_f32_32x32x16_bf16 v[64:79], a[64:67], a[0:3], v[64:79]
    v_mfma_f32_32x32x16_bf16 v[80:95], a[64:67], a[4:7], v[80:95]
    ds_read_b64_tr_b16 a[64:65], v7 offset:6144
    ds_read_b64_tr_b16 a[66:67], v7 offset:6656
    s_waitcnt lgkmcnt(10)
    v_mfma_f32_32x32x16_bf16 v[96:111], a[68:71], a[0:3], v[96:111]
    v_mfma_f32_32x32x16_bf16 v[112:127], a[68:71], a[4:7], v[112:127]
    ds_read_b64_tr_b16 a[68:69], v7 offset:6400
    ds_read_b64_tr_b16 a[70:71], v7 offset:6912
    buffer_load_dwordx4 a[56:59], v2, s[12:15], s25 offen offset:3072
    buffer_load_dwordx4 a[60:63], v2, s[16:19], s25 offen offset:3072
    s_add_u32 s25, s25, 4096
    s_waitcnt lgkmcnt(10)
    v_mfma_f32_32x32x16_bf16 v[128:143], a[72:75], a[0:3], v[128:143]
    v_mfma_f32_32x32x16_bf16 v[144:159], a[72:75], a[4:7], v[144:159]
    ds_read_b64_tr_b16 a[72:73], v7 offset:7168
    ds_read_b64_tr_b16 a[74:75], v7 offset:7680
    s_add_u32 m0, s38, 3072
    s_add_u32 s27, s24, 0
    buffer_load_dwordx4 v4, s[8:11], s27 offen lds
    s_waitcnt lgkmcnt(10)
    v_mfma_f32_32x32x16_bf16 v[160:175], a[76:79], a[0:3], v[160:175]
    v_mfma_f32_32x32x16_bf16 v[176:191], a[76:79], a[4:7], v[176:191]
    ds_read_b64_tr_b16 a[76:77], v7 offset:7424
    ds_read_b64_tr_b16 a[78:79], v7 offset:7936
    s_add_u32 m0, s38, 4096
    s_add_u32 s27, s24, 2048
    buffer_load_dwordx4 v4, s[8:11], s27 offen lds
    s_waitcnt lgkmcnt(10)
    v_mfma_f32_32x32x16_bf16 v[192:207], a[0:3], a[80:83], v[192:207]
    v_mfma_f32_32x32x16_bf16 v[208:223], a[4:7], a[80:83], v[208:223]
    ds_read_b64_tr_b16 a[80:81], v7 offset:8192
    ds_read_b64_tr_b16 a[82:83], v7 offset:8704
    s_add_u32 m0, s38, 5120
    s_add_u32 s27, s24, 4096
    buffer_load_dwordx4 v4, s[8:11], s27 offen lds
    s_add_u32 s24, s24, 393216
    s_waitcnt lgkmcnt(10)
    v_mfma_f32_32x32x16_bf16 v[224:239], a[0:3], a[84:87], v[224:239]
    v_mfma_f32_32x32x16_bf16 v[240:255], a[4:7], a[84:87], v[240:255]
    ds_read_b64_tr_b16 a[84:85], v7 offset:8448
    ds_read_b64_tr_b16 a[86:87], v7 offset:8960
    s_waitcnt vmcnt(25)
    s_waitcnt lgkmcnt(10)
    v_mfma_f32_32x32x16_bf16 v[64:79], a[64:67], a[8:11], v[64:79]
    v_mfma_f32_32x32x16_bf16 v[80:95], a[64:67], a[12:15], v[80:95]
    ds_read_b64_tr_b16 a[64:65], v7 offset:12288
    ds_read_b64_tr_b16 a[66:67], v7 offset:12800
    s_waitcnt lgkmcnt(10)
    v_mfma_f32_32x32x16_bf16 v[96:111], a[68:71], a[8:11], v[96:111]
    v_mfma_f32_32x32x16_bf16 v[112:127], a[68:71], a[12:15], v[112:127]
    ds_read_b64_tr_b16 a[68:69], v7 offset:12544
    ds_read_b64_tr_b16 a[70:71], v7 offset:13056
    buffer_load_dwordx4 a[0:3], v2, s[12:15], s25 offen offset:0
    buffer_load_dwordx4 a[4:7], v2, s[16:19], s25 offen offset:0
    s_waitcnt lgkmcnt(10)
    v_mfma_f32_32x32x16_bf16 v[128:143], a[72:75], a[8:11], v[128:143]
    v_mfma_f32_32x32x16_bf16 v[144:159], a[72:75], a[12:15], v[144:159]
    ds_read_b64_tr_b16 a[72:73], v7 offset:13312
    ds_read_b64_tr_b16 a[74:75], v7 offset:13824
    buffer_load_dword v45, v44, s[8:11], s24 offen
    s_waitcnt lgkmcnt(10)
    v_mfma_f32_32x32x16_bf16 v[160:175], a[76:79], a[8:11], v[160:175]
    v_mfma_f32_32x32x16_bf16 v[176:191], a[76:79], a[12:15], v[176:191]
    ds_read_b64_tr_b16 a[76:77], v7 offset:13568
    ds_read_b64_tr_b16 a[78:79], v7 offset:14080
    s_waitcnt lgkmcnt(10)
    v_mfma_f32_32x32x16_bf16 v[192:207], a[8:11], a[80:83], v[192:207]
    v_mfma_f32_32x32x16_bf16 v[208:223], a[12:15], a[80:83], v[208:223]
    ds_read_b64_tr_b16 a[80:81], v7 offset:14336
    ds_read_b64_tr_b16 a[82:83], v7 offset:14848
    s_waitcnt lgkmcnt(10)
    v_mfma_f32_32x32x16_bf16 v[224:239], a[8:11], a[84:87], v[224:239]
    v_mfma_f32_32x32x16_bf16 v[240:255], a[12:15], a[84:87], v[240:255]
    ds_read_b64_tr_b16 a[84:85], v7 offset:14592
    ds_read_b64_tr_b16 a[86:87], v7 offset:15104
    s_waitcnt vmcnt(26)
    s_waitcnt lgkmcnt(10)
    v_mfma_f32_32x32x16_bf16 v[64:79], a[64:67], a[16:19], v[64:79]
    v_mfma_f32_32x32x16_bf16 v[80:95], a[64:67], a[20:23], v[80:95]
    ds_read_b64_tr_b16 a[64:65], v7 offset:18432
    ds_read_b64_tr_b16 a[66:67], v7 offset:18944
    s_waitcnt lgkmcnt(10)
    v_mfma_f32_32x32x16_bf16 v[96:111], a[68:71], a[16:19], v[96:111]
    v_mfma_f32_32x32x16_bf16 v[112:127], a[68:71], a[20:23], v[112:127]
    ds_read_b64_tr_b16 a[68:69], v7 offset:18688
    ds_read_b64_tr_b16 a[70:71], v7 offset:19200
    buffer_load_dwordx4 a[8:11], v2, s[12:15], s25 offen offset:1024
    buffer_load_dwordx4 a[12:15], v2, s[16:19], s25 offen offset:1024
    s_waitcnt lgkmcnt(10)
    v_mfma_f32_32x32x16_bf16 v[128:143], a[72:75], a[16:19], v[128:143]
    v_mfma_f32_32x32x16_bf16 v[144:159], a[72:75], a[20:23], v[144:159]
    ds_read_b64_tr_b16 a[72:73], v7 offset:19456
    ds_read_b64_tr_b16 a[74:75], v7 offset:19968
    s_waitcnt lgkmcnt(10)
    v_mfma_f32_32x32x16_bf16 v[160:175], a[76:79], a[16:19], v[160:175]
    v_mfma_f32_32x32x16_bf16 v[176:191], a[76:79], a[20:23], v[176:191]
    ds_read_b64_tr_b16 a[76:77], v7 offset:19712
    ds_read_b64_tr_b16 a[78:79], v7 offset:20224
    s_waitcnt lgkmcnt(10)
    v_mfma_f32_32x32x16_bf16 v[192:207], a[16:19], a[80:83], v[192:207]
    v_mfma_f32_32x32x16_bf16 v[208:223], a[20:23], a[80:83], v[208:223]
    ds_read_b64_tr_b16 a[80:81], v7 offset:20480
    ds_read_b64_tr_b16 a[82:83], v7 offset:20992
    s_waitcnt lgkmcnt(10)
    v_mfma_f32_32x32x16_bf16 v[224:239], a[16:19], a[84:87], v[224:239]
    v_mfma_f32_32x32x16_bf16 v[240:255], a[20:23], a[84:87], v[240:255]
    ds_read_b64_tr_b16 a[84:85], v7 offset:20736
    ds_read_b64_tr_b16 a[86:87], v7 offset:21248
    s_waitcnt vmcnt(23)
    s_waitcnt lgkmcnt(10)
    v_mfma_f32_32x32x16_bf16 v[64:79], a[64:67], a[24:27], v[64:79]
    v_mfma_f32_32x32x16_bf16 v[80:95], a[64:67], a[28:31], v[80:95]
    s_waitcnt vmcnt(20)
    s_barrier
    ds_read_b64_tr_b16 a[64:65], v7 offset:24576
    ds_read_b64_tr_b16 a[66:67], v7 offset:25088
    s_waitcnt lgkmcnt(10)
    v_mfma_f32_32x32x16_bf16 v[96:111], a[68:71], a[24:27], v[96:111]
    v_mfma_f32_32x32x16_bf16 v[112:127], a[68:71], a[28:31], v[112:127]
    ds_read_b64_tr_b16 a[68:69], v7 offset:24832
    ds_read_b64_tr_b16 a[70:71], v7 offset:25344
    buffer_load_dwordx4 a[16:19], v2, s[12:15], s25 offen offset:2048
    buffer_load_dwordx4 a[20:23], v2, s[16:19], s25 offen offset:2048
    s_waitcnt lgkmcnt(10)
    v_mfma_f32_32x32x16_bf16 v[128:143], a[72:75], a[24:27], v[128:143]
    v_mfma_f32_32x32x16_bf16 v[144:159], a[72:75], a[28:31], v[144:159]
    ds_read_b64_tr_b16 a[72:73], v7 offset:25600
    ds_read_b64_tr_b16 a[74:75], v7 offset:26112
    s_add_u32 m0, s38, 24576
    s_add_u32 s27, s24, 0
    buffer_load_dwordx4 v3, s[8:11], s27 offen lds
    s_waitcnt lgkmcnt(10)
    v_mfma_f32_32x32x16_bf16 v[160:175], a[76:79], a[24:27], v[160:175]
    v_mfma_f32_32x32x16_bf16 v[176:191], a[76:79], a[28:31], v[176:191]
    ds_read_b64_tr_b16 a[76:77], v7 offset:25856
    ds_read_b64_tr_b16 a[78:79], v7 offset:26368
    s_add_u32 m0, s38, 25600
    s_add_u32 s27, s24, 2048
    buffer_load_dwordx4 v3, s[8:11], s27 offen lds
    s_waitcnt lgkmcnt(10)
    v_mfma_f32_32x32x16_bf16 v[192:207], a[24:27], a[80:83], v[192:207]
    v_mfma_f32_32x32x16_bf16 v[208:223], a[28:31], a[80:83], v[208:223]
    ds_read_b64_tr_b16 a[80:81], v7 offset:26624
    ds_read_b64_tr_b16 a[82:83], v7 offset:27136
    s_add_u32 m0, s38, 26624
    s_add_u32 s27, s24, 4096
    buffer_load_dwordx4 v3, s[8:11], s27 offen lds
    s_waitcnt lgkmcnt(10)
    v_mfma_f32_32x32x16_bf16 v[224:239], a[24:27], a[84:87], v[224:239]
    v_mfma_f32_32x32x16_bf16 v[240:255], a[28:31], a[84:87], v[240:255]
    ds_read_b64_tr_b16 a[84:85], v7 offset:26880
    ds_read_b64_tr_b16 a[86:87], v7 offset:27392
    s_waitcnt vmcnt(23)
    s_waitcnt lgkmcnt(10)
    v_mfma_f32_32x32x16_bf16 v[64:79], a[64:67], a[32:35], v[64:79]
    v_mfma_f32_32x32x16_bf16 v[80:95], a[64:67], a[36:39], v[80:95]
    ds_read_b64_tr_b16 a[64:65], v7 offset:30720
    ds_read_b64_tr_b16 a[66:67], v7 offset:31232
    s_waitcnt lgkmcnt(10)
    v_mfma_f32_32x32x16_bf16 v[96:111], a[68:71], a[32:35], v[96:111]
    v_mfma_f32_32x32x16_bf16 v[112:127], a[68:71], a[36:39], v[112:127]
    ds_read_b64_tr_b16 a[68:69], v7 offset:30976
    ds_read_b64_tr_b16 a[70:71], v7 offset:31488
    buffer_load_dwordx4 a[24:27], v2, s[12:15], s25 offen offset:3072
    buffer_load_dwordx4 a[28:31], v2, s[16:19], s25 offen offset:3072
    s_add_u32 s25, s25, 4096
    s_waitcnt lgkmcnt(10)
    v_mfma_f32_32x32x16_bf16 v[128:143], a[72:75], a[32:35], v[128:143]
    v_mfma_f32_32x32x16_bf16 v[144:159], a[72:75], a[36:39], v[144:159]
    ds_read_b64_tr_b16 a[72:73], v7 offset:31744
    ds_read_b64_tr_b16 a[74:75], v7 offset:32256
    s_add_u32 m0, s38, 27648
    s_add_u32 s27, s24, 0
    buffer_load_dwordx4 v4, s[8:11], s27 offen lds
    s_waitcnt lgkmcnt(10)
    v_mfma_f32_32x32x16_bf16 v[160:175], a[76:79], a[32:35], v[160:175]
    v_mfma_f32_32x32x16_bf16 v[176:191], a[76:79], a[36:39], v[176:191]
    ds_read_b64_tr_b16 a[76:77], v7 offset:32000
    ds_read_b64_tr_b16 a[78:79], v7 offset:32512
    s_add_u32 m0, s38, 28672
    s_add_u32 s27, s24, 2048
    buffer_load_dwordx4 v4, s[8:11], s27 offen lds
    s_waitcnt lgkmcnt(10)
    v_mfma_f32_32x32x16_bf16 v[192:207], a[32:35], a[80:83], v[192:207]
    v_mfma_f32_32x32x16_bf16 v[208:223], a[36:39], a[80:83], v[208:223]
    ds_read_b64_tr_b16 a[80:81], v7 offset:32768
    ds_read_b64_tr_b16 a[82:83], v7 offset:33280
    s_add_u32 m0, s38, 29696
    s_add_u32 s27, s24, 4096
    buffer_load_dwordx4 v4, s[8:11], s27 offen lds
    s_add_u32 s24, s24, 393216
    s_waitcnt lgkmcnt(10)
    v_mfma_f32_32x32x16_bf16 v[224:239], a[32:35], a[84:87], v[224:239]
    v_mfma_f32_32x32x16_bf16 v[240:255], a[36:39], a[84:87], v[240:255]
    ds_read_b64_tr_b16 a[84:85], v7 offset:33024
    ds_read_b64_tr_b16 a[86:87], v7 offset:33536
    s_waitcnt vmcnt(25)
    s_waitcnt lgkmcnt(10)
    v_mfma_f32_32x32x16_bf16 v[64:79], a[64:67], a[40:43], v[64:79]
    v_mfma_f32_32x32x16_bf16 v[80:95], a[64:67], a[44:47], v[80:95]
    ds_read_b64_tr_b16 a[64:65], v7 offset:36864
    ds_read_b64_tr_b16 a[66:67], v7 offset:37376
    s_waitcnt lgkmcnt(10)
    v_mfma_f32_32x32x16_bf16 v[96:111], a[68:71], a[40:43], v[96:111]
    v_mfma_f32_32x32x16_bf16 v[112:127], a[68:71], a[44:47], v[112:127]
    ds_read_b64_tr_b16 a[68:69], v7 offset:37120
    ds_read_b64_tr_b16 a[70:71], v7 offset:37632
    buffer_load_dwordx4 a[32:35], v2, s[12:15], s25 offen offset:0
    buffer_load_dwordx4 a[36:39], v2, s[16:19], s25 offen offset:0
    s_waitcnt lgkmcnt(10)
    v_mfma_f32_32x32x16_bf16 v[128:143], a[72:75], a[40:43], v[128:143]
    v_mfma_f32_32x32x16_bf16 v[144:159], a[72:75], a[44:47], v[144:159]
    ds_read_b64_tr_b16 a[72:73], v7 offset:37888
    ds_read_b64_tr_b16 a[74:75], v7 offset:38400
    buffer_load_dword v45, v44, s[8:11], s24 offen
    s_waitcnt lgkmcnt(10)
    v_mfma_f32_32x32x16_bf16 v[160:175], a[76:79], a[40:43], v[160:175]
    v_mfma_f32_32x32x16_bf16 v[176:191], a[76:79], a[44:47], v[176:191]
    ds_read_b64_tr_b16 a[76:77], v7 offset:38144
    ds_read_b64_tr_b16 a[78:79], v7 offset:38656
    s_waitcnt lgkmcnt(10)
    v_mfma_f32_32x32x16_bf16 v[192:207], a[40:43], a[80:83], v[192:207]
    v_mfma_f32_32x32x16_bf16 v[208:223], a[44:47], a[80:83], v[208:223]
    ds_read_b64_tr_b16 a[80:81], v7 offset:38912
    ds_read_b64_tr_b16 a[82:83], v7 offset:39424
    s_waitcnt lgkmcnt(10)
    v_mfma_f32_32x32x16_bf16 v[224:239], a[40:43], a[84:87], v[224:239]
    v_mfma_f32_32x32x16_bf16 v[240:255], a[44:47], a[84:87], v[240:255]
    ds_read_b64_tr_b16 a[84:85], v7 offset:39168
    ds_read_b64_tr_b16 a[86:87], v7 offset:39680
    s_waitcnt vmcnt(26)
    s_waitcnt lgkmcnt(10)
    v_mfma_f32_32x32x16_bf16 v[64:79], a[64:67], a[48:51], v[64:79]
    v_mfma_f32_32x32x16_bf16 v[80:95], a[64:67], a[52:55], v[80:95]
    ds_read_b64_tr_b16 a[64:65], v7 offset:43008
    ds_read_b64_tr_b16 a[66:67], v7 offset:43520
    s_waitcnt lgkmcnt(10)
    v_mfma_f32_32x32x16_bf16 v[96:111], a[68:71], a[48:51], v[96:111]
    v_mfma_f32_32x32x16_bf16 v[112:127], a[68:71], a[52:55], v[112:127]
    ds_read_b64_tr_b16 a[68:69], v7 offset:43264
    ds_read_b64_tr_b16 a[70:71], v7 offset:43776
    buffer_load_dwordx4 a[40:43], v2, s[12:15], s25 offen offset:1024
    buffer_load_dwordx4 a[44:47], v2, s[16:19], s25 offen offset:1024
    s_waitcnt lgkmcnt(10)
    v_mfma_f32_32x32x16_bf16 v[128:143], a[72:75], a[48:51], v[128:143]
    v_mfma_f32_32x32x16_bf16 v[144:159], a[72:75], a[52:55], v[144:159]
    ds_read_b64_tr_b16 a[72:73], v7 offset:44032
    ds_read_b64_tr_b16 a[74:75], v7 offset:44544
    s_waitcnt lgkmcnt(10)
    v_mfma_f32_32x32x16_bf16 v[160:175], a[76:79], a[48:51], v[160:175]
    v_mfma_f32_32x32x16_bf16 v[176:191], a[76:79], a[52:55], v[176:191]
    ds_read_b64_tr_b16 a[76:77], v7 offset:44288
    ds_read_b64_tr_b16 a[78:79], v7 offset:44800
    s_waitcnt lgkmcnt(10)
    v_mfma_f32_32x32x16_bf16 v[192:207], a[48:51], a[80:83], v[192:207]
    v_mfma_f32_32x32x16_bf16 v[208:223], a[52:55], a[80:83], v[208:223]
    ds_read_b64_tr_b16 a[80:81], v7 offset:45056
    ds_read_b64_tr_b16 a[82:83], v7 offset:45568
    s_waitcnt lgkmcnt(10)
    v_mfma_f32_32x32x16_bf16 v[224:239], a[48:51], a[84:87], v[224:239]
    v_mfma_f32_32x32x16_bf16 v[240:255], a[52:55], a[84:87], v[240:255]
    ds_read_b64_tr_b16 a[84:85], v7 offset:45312
    ds_read_b64_tr_b16 a[86:87], v7 offset:45824
    s_waitcnt vmcnt(23)
    s_waitcnt lgkmcnt(10)
    v_mfma_f32_32x32x16_bf16 v[64:79], a[64:67], a[56:59], v[64:79]
    v_mfma_f32_32x32x16_bf16 v[80:95], a[64:67], a[60:63], v[80:95]
    s_waitcnt vmcnt(20)
    s_barrier
    ds_read_b64_tr_b16 a[64:65], v5 offset:0
    ds_read_b64_tr_b16 a[66:67], v5 offset:512
    s_waitcnt lgkmcnt(10)
    v_mfma_f32_32x32x16_bf16 v[96:111], a[68:71], a[56:59], v[96:111]
    v_mfma_f32_32x32x16_bf16 v[112:127], a[68:71], a[60:63], v[112:127]
    ds_read_b64_tr_b16 a[68:69], v5 offset:256
    ds_read_b64_tr_b16 a[70:71], v5 offset:768
    buffer_load_dwordx4 a[48:51], v2, s[12:15], s25 offen offset:2048
    buffer_load_dwordx4 a[52:55], v2, s[16:19], s25 offen offset:2048
    s_waitcnt lgkmcnt(10)
    v_mfma_f32_32x32x16_bf16 v[128:143], a[72:75], a[56:59], v[128:143]
    v_mfma_f32_32x32x16_bf16 v[144:159], a[72:75], a[60:63], v[144:159]
    ds_read_b64_tr_b16 a[72:73], v5 offset:1024
    ds_read_b64_tr_b16 a[74:75], v5 offset:1536
    s_add_u32 m0, s38, 49152
    s_add_u32 s27, s24, 0
    buffer_load_dwordx4 v3, s[8:11], s27 offen lds
    s_waitcnt lgkmcnt(10)
    v_mfma_f32_32x32x16_bf16 v[160:175], a[76:79], a[56:59], v[160:175]
    v_mfma_f32_32x32x16_bf16 v[176:191], a[76:79], a[60:63], v[176:191]
    ds_read_b64_tr_b16 a[76:77], v5 offset:1280
    ds_read_b64_tr_b16 a[78:79], v5 offset:1792
    s_add_u32 m0, s38, 50176
    s_add_u32 s27, s24, 2048
    buffer_load_dwordx4 v3, s[8:11], s27 offen lds
    s_waitcnt lgkmcnt(10)
    v_mfma_f32_32x32x16_bf16 v[192:207], a[56:59], a[80:83], v[192:207]
    v_mfma_f32_32x32x16_bf16 v[208:223], a[60:63], a[80:83], v[208:223]
    ds_read_b64_tr_b16 a[80:81], v5 offset:2048
    ds_read_b64_tr_b16 a[82:83], v5 offset:2560
    s_add_u32 m0, s38, 51200
    s_add_u32 s27, s24, 4096
    buffer_load_dwordx4 v3, s[8:11], s27 offen lds
    s_waitcnt lgkmcnt(10)
    v_mfma_f32_32x32x16_bf16 v[224:239], a[56:59], a[84:87], v[224:239]
    v_mfma_f32_32x32x16_bf16 v[240:255], a[60:63], a[84:87], v[240:255]
    ds_read_b64_tr_b16 a[84:85], v5 offset:2304
    ds_read_b64_tr_b16 a[86:87], v5 offset:2816
    s_add_u32 s26, s26, 1
    s_cmp_lt_u32 s26, 3
    s_cbranch_scc1 g1_a_loop
    s_waitcnt vmcnt(23)
    s_waitcnt lgkmcnt(10)
    v_mfma_f32_32x32x16_bf16 v[64:79], a[64:67], a[0:3], v[64:79]
    v_mfma_f32_32x32x16_bf16 v[80:95], a[64:67], a[4:7], v[80:95]
    s_barrier
    ds_read_b64_tr_b16 a[64:65], v5 offset:6144
    ds_read_b64_tr_b16 a[66:67], v5 offset:6656
    s_waitcnt lgkmcnt(10)
    v_mfma_f32_32x32x16_bf16 v[96:111], a[68:71], a[0:3], v[96:111]
    v_mfma_f32_32x32x16_bf16 v[112:127], a[68:71], a[4:7], v[112:127]
    ds_read_b64_tr_b16 a[68:69], v5 offset:6400
    ds_read_b64_tr_b16 a[70:71], v5 offset:6912
    s_add_u32 m0, s38, 52224
    s_add_u32 s27, s24, 0
    buffer_load_dwordx4 v4, s[8:11], s27 offen lds
    s_waitcnt lgkmcnt(10)
    v_mfma_f32_32x32x16_bf16 v[128:143], a[72:75], a[0:3], v[128:143]
    v_mfma_f32_32x32x16_bf16 v[144:159], a[72:75], a[4:7], v[144:159]
    ds_read_b64_tr_b16 a[72:73], v5 offset:7168
    ds_read_b64_tr_b16 a[74:75], v5 offset:7680
    s_add_u32 m0, s38, 53248
    s_add_u32 s27, s24, 2048
    buffer_load_dwordx4 v4, s[8:11], s27 offen lds
    s_waitcnt lgkmcnt(10)
    v_mfma_f32_32x32x16_bf16 v[160:175], a[76:79], a[0:3], v[160:175]
    v_mfma_f32_32x32x16_bf16 v[176:191], a[76:79], a[4:7], v[176:191]
    ds_read_b64_tr_b16 a[76:77], v5 offset:7424
    ds_read_b64_tr_b16 a[78:79], v5 offset:7936
    s_add_u32 m0, s38, 54272
    s_add_u32 s27, s24, 4096
    buffer_load_dwordx4 v4, s[8:11], s27 offen lds
    s_add_u32 s24, s24, 393216
    s_waitcnt lgkmcnt(10)
    v_mfma_f32_32x32x16_bf16 v[192:207], a[0:3], a[80:83], v[192:207]
    v_mfma_f32_32x32x16_bf16 v[208:223], a[4:7], a[80:83], v[208:223]
    ds_read_b64_tr_b16 a[80:81], v5 offset:8192
    ds_read_b64_tr_b16 a[82:83], v5 offset:8704
    buffer_load_dwordx4 a[56:59], v2, s[12:15], s25 offen offset:3072
    buffer_load_dwordx4 a[60:63], v2, s[16:19], s25 offen offset:3072
    s_add_u32 s25, s25, 4096
    s_waitcnt lgkmcnt(10)
    v_mfma_f32_32x32x16_bf16 v[224:239], a[0:3], a[84:87], v[224:239]
    v_mfma_f32_32x32x16_bf16 v[240:255], a[4:7], a[84:87], v[240:255]
    ds_read_b64_tr_b16 a[84:85], v5 offset:8448
    ds_read_b64_tr_b16 a[86:87], v5 offset:8960
    s_add_u32 m0, s38, 73728
    s_add_u32 s27, s24, 0
    buffer_load_dwordx4 v3, s[8:11], s27 offen lds
    s_waitcnt vmcnt(26)
    s_waitcnt lgkmcnt(10)
    v_mfma_f32_32x32x16_bf16 v[64:79], a[64:67], a[8:11], v[64:79]
    v_mfma_f32_32x32x16_bf16 v[80:95], a[64:67], a[12:15], v[80:95]
    ds_read_b64_tr_b16 a[64:65], v5 offset:12288
    ds_read_b64_tr_b16 a[66:67], v5 offset:12800
    s_waitcnt lgkmcnt(10)
    v_mfma_f32_32x32x16_bf16 v[96:111], a[68:71], a[8:11], v[96:111]
    v_mfma_f32_32x32x16_bf16 v[112:127], a[68:71], a[12:15], v[112:127]
    ds_read_b64_tr_b16 a[68:69], v5 offset:12544
    ds_read_b64_tr_b16 a[70:71], v5 offset:13056
    s_add_u32 m0, s38, 74752
    s_add_u32 s27, s24, 2048
    buffer_load_dwordx4 v3, s[8:11], s27 offen lds
    s_waitcnt lgkmcnt(10)
    v_mfma_f32_32x32x16_bf16 v[128:143], a[72:75], a[8:11], v[128:143]
    v_mfma_f32_32x32x16_bf16 v[144:159], a[72:75], a[12:15], v[144:159]
    ds_read_b64_tr_b16 a[72:73], v5 offset:13312
    ds_read_b64_tr_b16 a[74:75], v5 offset:13824
    s_add_u32 m0, s38, 75776
    s_add_u32 s27, s24, 4096
    buffer_load_dwordx4 v3, s[8:11], s27 offen lds
    s_waitcnt lgkmcnt(10)
    v_mfma_f32_32x32x16_bf16 v[160:175], a[76:79], a[8:11], v[160:175]
    v_mfma_f32_32x32x16_bf16 v[176:191], a[76:79], a[12:15], v[176:191]
    ds_read_b64_tr_b16 a[76:77], v5 offset:13568
    ds_read_b64_tr_b16 a[78:79], v5 offset:14080
    s_add_u32 m0, s38, 76800
    s_add_u32 s27, s24, 0
    buffer_load_dwordx4 v4, s[8:11], s27 offen lds
    s_waitcnt lgkmcnt(10)
    v_mfma_f32_32x32x16_bf16 v[192:207], a[8:11], a[80:83], v[192:207]
    v_mfma_f32_32x32x16_bf16 v[208:223], a[12:15], a[80:83], v[208:223]
    ds_read_b64_tr_b16 a[80:81], v5 offset:14336
    ds_read_b64_tr_b16 a[82:83], v5 offset:14848
    s_add_u32 m0, s38, 77824
    s_add_u32 s27, s24, 2048
    buffer_load_dwordx4 v4, s[8:11], s27 offen lds
    s_waitcnt lgkmcnt(10)
    v_mfma_f32_32x32x16_bf16 v[224:239], a[8:11], a[84:87], v[224:239]
    v_mfma_f32_32x32x16_bf16 v[240:255], a[12:15], a[84:87], v[240:255]
    ds_read_b64_tr_b16 a[84:85], v5 offset:14592
    ds_read_b64_tr_b16 a[86:87], v5 offset:15104
    s_add_u32 m0, s38, 78848
    s_add_u32 s27, s24, 4096
    buffer_load_dwordx4 v4, s[8:11], s27 offen lds
    buffer_load_dwordx4 a[128:131], v2, s[12:15], s25 offen offset:0
    buffer_load_dwordx4 a[132:135], v2, s[16:19], s25 offen offset:0
    s_waitcnt vmcnt(31)
    s_waitcnt lgkmcnt(10)
    v_mfma_f32_32x32x16_bf16 v[64:79], a[64:67], a[16:19], v[64:79]
    v_mfma_f32_32x32x16_bf16 v[80:95], a[64:67], a[20:23], v[80:95]
    ds_read_b64_tr_b16 a[64:65], v5 offset:18432
    ds_read_b64_tr_b16 a[66:67], v5 offset:18944
    s_waitcnt lgkmcnt(10)
    v_mfma_f32_32x32x16_bf16 v[96:111], a[68:71], a[16:19], v[96:111]
    v_mfma_f32_32x32x16_bf16 v[112:127], a[68:71], a[20:23], v[112:127]
    ds_read_b64_tr_b16 a[68:69], v5 offset:18688
    ds_read_b64_tr_b16 a[70:71], v5 offset:19200
    buffer_load_dwordx4 a[136:139], v2, s[12:15], s25 offen offset:1024
    buffer_load_dwordx4 a[140:143], v2, s[16:19], s25 offen offset:1024
    s_waitcnt lgkmcnt(10)
    v_mfma_f32_32x32x16_bf16 v[128:143], a[72:75], a[16:19], v[128:143]
    v_mfma_f32_32x32x16_bf16 v[144:159], a[72:75], a[20:23], v[144:159]
    ds_read_b64_tr_b16 a[72:73], v5 offset:19456
    ds_read_b64_tr_b16 a[74:75], v5 offset:19968
    buffer_load_dwordx4 a[144:147], v2, s[12:15], s25 offen offset:2048
    buffer_load_dwordx4 a[148:151], v2, s[16:19], s25 offen offset:2048
    s_waitcnt lgkmcnt(10)
    v_mfma_f32_32x32x16_bf16 v[160:175], a[76:79], a[16:19], v[160:175]
    v_mfma_f32_32x32x16_bf16 v[176:191], a[76:79], a[20:23], v[176:191]
    ds_read_b64_tr_b16 a[76:77], v5 offset:19712
    ds_read_b64_tr_b16 a[78:79], v5 offset:20224
    buffer_load_dwordx4 a[152:155], v2, s[12:15], s25 offen offset:3072
    buffer_load_dwordx4 a[156:159], v2, s[16:19], s25 offen offset:3072
    s_add_u32 s25, s25, 4096
    s_waitcnt lgkmcnt(10)
    v_mfma_f32_32x32x16_bf16 v[192:207], a[16:19], a[80:83], v[192:207]
    v_mfma_f32_32x32x16_bf16 v[208:223], a[20:23], a[80:83], v[208:223]
    ds_read_b64_tr_b16 a[80:81], v5 offset:20480
    ds_read_b64_tr_b16 a[82:83], v5 offset:20992
    buffer_load_dwordx4 a[160:163], v2, s[12:15], s25 offen offset:0
    buffer_load_dwordx4 a[164:167], v2, s[16:19], s25 offen offset:0
    s_waitcnt lgkmcnt(10)
    v_mfma_f32_32x32x16_bf16 v[224:239], a[16:19], a[84:87], v[224:239]
    v_mfma_f32_32x32x16_bf16 v[240:255], a[20:23], a[84:87], v[240:255]
    ds_read_b64_tr_b16 a[84:85], v5 offset:20736
    ds_read_b64_tr_b16 a[86:87], v5 offset:21248
    s_waitcnt vmcnt(34)
    s_waitcnt lgkmcnt(10)
    v_mfma_f32_32x32x16_bf16 v[64:79], a[64:67], a[24:27], v[64:79]
    v_mfma_f32_32x32x16_bf16 v[80:95], a[64:67], a[28:31], v[80:95]
    s_waitcnt vmcnt(18)
    s_barrier
    ds_read_b64_tr_b16 a[64:65], v5 offset:24576
    ds_read_b64_tr_b16 a[66:67], v5 offset:25088
    s_waitcnt lgkmcnt(10)
    v_mfma_f32_32x32x16_bf16 v[96:111], a[68:71], a[24:27], v[96:111]
    v_mfma_f32_32x32x16_bf16 v[112:127], a[68:71], a[28:31], v[112:127]
    ds_read_b64_tr_b16 a[68:69], v5 offset:30720
    ds_read_b64_tr_b16 a[70:71], v5 offset:31232
    buffer_load_dwordx4 a[168:171], v2, s[12:15], s25 offen offset:1024
    buffer_load_dwordx4 a[172:175], v2, s[16:19], s25 offen offset:1024
    s_waitcnt lgkmcnt(10)
    v_mfma_f32_32x32x16_bf16 v[128:143], a[72:75], a[24:27], v[128:143]
    v_mfma_f32_32x32x16_bf16 v[144:159], a[72:75], a[28:31], v[144:159]
    ds_read_b64_tr_b16 a[72:73], v5 offset:36864
    ds_read_b64_tr_b16 a[74:75], v5 offset:37376
    buffer_load_dwordx4 a[176:179], v2, s[12:15], s25 offen offset:2048
    buffer_load_dwordx4 a[180:183], v2, s[16:19], s25 offen offset:2048
    s_waitcnt lgkmcnt(10)
    v_mfma_f32_32x32x16_bf16 v[160:175], a[76:79], a[24:27], v[160:175]
    v_mfma_f32_32x32x16_bf16 v[176:191], a[76:79], a[28:31], v[176:191]
    ds_read_b64_tr_b16 a[76:77], v5 offset:43008
    ds_read_b64_tr_b16 a[78:79], v5 offset:43520
    buffer_load_dwordx4 a[184:187], v2, s[12:15], s25 offen offset:3072
    buffer_load_dwordx4 a[188:191], v2, s[16:19], s25 offen offset:3072
    s_waitcnt lgkmcnt(10)
    v_mfma_f32_32x32x16_bf16 v[192:207], a[24:27], a[80:83], v[192:207]
    v_mfma_f32_32x32x16_bf16 v[208:223], a[28:31], a[80:83], v[208:223]
    ds_read_b64_tr_b16 a[80:81], v7 offset:0
    ds_read_b64_tr_b16 a[82:83], v7 offset:512
    s_waitcnt lgkmcnt(10)
    v_mfma_f32_32x32x16_bf16 v[224:239], a[24:27], a[84:87], v[224:239]
    v_mfma_f32_32x32x16_bf16 v[240:255], a[28:31], a[84:87], v[240:255]
    ds_read_b64_tr_b16 a[84:85], v7 offset:6144
    ds_read_b64_tr_b16 a[86:87], v7 offset:6656
    s_waitcnt lgkmcnt(10)
    v_mfma_f32_32x32x16_bf16 v[64:79], a[64:67], a[32:35], v[64:79]
    v_mfma_f32_32x32x16_bf16 v[80:95], a[64:67], a[36:39], v[80:95]
    ds_read_b64_tr_b16 a[64:65], v7 offset:12288
    ds_read_b64_tr_b16 a[66:67], v7 offset:12800
    s_waitcnt lgkmcnt(10)
    v_mfma_f32_32x32x16_bf16 v[64:79], a[68:71], a[40:43], v[64:79]
    v_mfma_f32_32x32x16_bf16 v[80:95], a[68:71], a[44:47], v[80:95]
    ds_read_b64_tr_b16 a[68:69], v7 offset:18432
    ds_read_b64_tr_b16 a[70:71], v7 offset:18944
    s_waitcnt lgkmcnt(10)
    v_mfma_f32_32x32x16_bf16 v[64:79], a[72:75], a[48:51], v[64:79]
    v_mfma_f32_32x32x16_bf16 v[80:95], a[72:75], a[52:55], v[80:95]
    s_waitcnt vmcnt(16)
    s_barrier
    ds_read_b64_tr_b16 a[72:73], v7 offset:24576
    ds_read_b64_tr_b16 a[74:75], v7 offset:25088
    s_waitcnt lgkmcnt(10)
    v_mfma_f32_32x32x16_bf16 v[64:79], a[76:79], a[56:59], v[64:79]
    v_mfma_f32_32x32x16_bf16 v[80:95], a[76:79], a[60:63], v[80:95]
    ds_read_b64_tr_b16 a[76:77], v7 offset:30720
    ds_read_b64_tr_b16 a[78:79], v7 offset:31232
    s_waitcnt vmcnt(14)
    s_waitcnt lgkmcnt(10)
    v_mfma_f32_32x32x16_bf16 v[64:79], a[80:83], a[128:131], v[64:79]
    v_mfma_f32_32x32x16_bf16 v[80:95], a[80:83], a[132:135], v[80:95]
    ds_read_b64_tr_b16 a[80:81], v7 offset:36864
    ds_read_b64_tr_b16 a[82:83], v7 offset:37376
    s_waitcnt vmcnt(12)
    s_waitcnt lgkmcnt(10)
    v_mfma_f32_32x32x16_bf16 v[64:79], a[84:87], a[136:139], v[64:79]
    v_mfma_f32_32x32x16_bf16 v[80:95], a[84:87], a[140:143], v[80:95]
    ds_read_b64_tr_b16 a[84:85], v7 offset:43008
    ds_read_b64_tr_b16 a[86:87], v7 offset:43520
    s_waitcnt vmcnt(10)
    s_waitcnt lgkmcnt(10)
    v_mfma_f32_32x32x16_bf16 v[64:79], a[64:67], a[144:147], v[64:79]
    v_mfma_f32_32x32x16_bf16 v[80:95], a[64:67], a[148:151], v[80:95]
    ds_read_b64_tr_b16 a[64:65], v5 offset:24832
    ds_read_b64_tr_b16 a[66:67], v5 offset:25344
    s_waitcnt vmcnt(8)
    s_waitcnt lgkmcnt(10)
    v_mfma_f32_32x32x16_bf16 v[64:79], a[68:71], a[152:155], v[64:79]
    v_mfma_f32_32x32x16_bf16 v[80:95], a[68:71], a[156:159], v[80:95]
    ds_read_b64_tr_b16 a[68:69], v5 offset:30976
    ds_read_b64_tr_b16 a[70:71], v5 offset:31488
    s_waitcnt vmcnt(6)
    s_waitcnt lgkmcnt(10)
    v_mfma_f32_32x32x16_bf16 v[64:79], a[72:75], a[160:163], v[64:79]
    v_mfma_f32_32x32x16_bf16 v[80:95], a[72:75], a[164:167], v[80:95]
    ds_read_b64_tr_b16 a[72:73], v5 offset:37120
    ds_read_b64_tr_b16 a[74:75], v5 offset:37632
    s_waitcnt vmcnt(4)
    s_waitcnt lgkmcnt(10)
    v_mfma_f32_32x32x16_bf16 v[64:79], a[76:79], a[168:171], v[64:79]
    v_mfma_f32_32x32x16_bf16 v[80:95], a[76:79], a[172:175], v[80:95]
    ds_read_b64_tr_b16 a[76:77], v5 offset:43264
    ds_read_b64_tr_b16 a[78:79], v5 offset:43776
    s_waitcnt vmcnt(2)
    s_waitcnt lgkmcnt(10)
    v_mfma_f32_32x32x16_bf16 v[64:79], a[80:83], a[176:179], v[64:79]
    v_mfma_f32_32x32x16_bf16 v[80:95], a[80:83], a[180:183], v[80:95]
    ds_read_b64_tr_b16 a[80:81], v7 offset:256
    ds_read_b64_tr_b16 a[82:83], v7 offset:768
    s_waitcnt vmcnt(0)
    s_waitcnt lgkmcnt(10)
    v_mfma_f32_32x32x16_bf16 v[64:79], a[84:87], a[184:187], v[64:79]
    v_mfma_f32_32x32x16_bf16 v[80:95], a[84:87], a[188:191], v[80:95]
    ds_read_b64_tr_b16 a[84:85], v7 offset:6400
    ds_read_b64_tr_b16 a[86:87], v7 offset:6912
    s_waitcnt lgkmcnt(10)
    v_mfma_f32_32x32x16_bf16 v[96:111], a[64:67], a[32:35], v[96:111]
    v_mfma_f32_32x32x16_bf16 v[112:127], a[64:67], a[36:39], v[112:127]
    ds_read_b64_tr_b16 a[64:65], v7 offset:12544
    ds_read_b64_tr_b16 a[66:67], v7 offset:13056
    s_waitcnt lgkmcnt(10)
    v_mfma_f32_32x32x16_bf16 v[96:111], a[68:71], a[40:43], v[96:111]
    s_nop 15
    v_pk_mul_f32 v[64:65], v[64:65], v[8:9]
    v_mfma_f32_32x32x16_bf16 v[112:127], a[68:71], a[44:47], v[112:127]
    ds_read_b64_tr_b16 a[68:69], v7 offset:18688
    ds_read_b64_tr_b16 a[70:71], v7 offset:19200
    v_pk_mul_f32 v[66:67], v[66:67], v[8:9]
    v_pk_mul_f32 v[68:69], v[68:69], v[8:9]
    s_waitcnt lgkmcnt(10)
    v_mfma_f32_32x32x16_bf16 v[96:111], a[72:75], a[48:51], v[96:111]
    v_pk_mul_f32 v[70:71], v[70:71], v[8:9]
    v_pk_mul_f32 v[72:73], v[72:73], v[8:9]
    v_mfma_f32_32x32x16_bf16 v[112:127], a[72:75], a[52:55], v[112:127]
    ds_read_b64_tr_b16 a[72:73], v7 offset:24832
    ds_read_b64_tr_b16 a[74:75], v7 offset:25344
    v_pk_mul_f32 v[74:75], v[74:75], v[8:9]
    v_pk_mul_f32 v[76:77], v[76:77], v[8:9]
    s_waitcnt lgkmcnt(10)
    v_mfma_f32_32x32x16_bf16 v[96:111], a[76:79], a[56:59], v[96:111]
    v_pk_mul_f32 v[78:79], v[78:79], v[8:9]
    s_add_u32 s70, s71, 0
    v_mfma_f32_32x32x16_bf16 v[112:127], a[76:79], a[60:63], v[112:127]
    ds_read_b64_tr_b16 a[76:77], v7 offset:30976
    ds_read_b64_tr_b16 a[78:79], v7 offset:31488
    v_cvt_pk_bf16_f32 v16, v64, v65
    v_cvt_pk_bf16_f32 v17, v66, v67
    s_waitcnt lgkmcnt(10)
    v_mfma_f32_32x32x16_bf16 v[96:111], a[80:83], a[128:131], v[96:111]
    v_cvt_pk_bf16_f32 v18, v68, v69
    v_cvt_pk_bf16_f32 v19, v70, v71
    v_mfma_f32_32x32x16_bf16 v[112:127], a[80:83], a[132:135], v[112:127]
    ds_read_b64_tr_b16 a[80:81], v7 offset:37120
    ds_read_b64_tr_b16 a[82:83], v7 offset:37632
    v_cvt_pk_bf16_f32 v20, v72, v73
    v_cvt_pk_bf16_f32 v21, v74, v75
    s_waitcnt lgkmcnt(10)
    v_mfma_f32_32x32x16_bf16 v[96:111], a[84:87], a[136:139], v[96:111]
    v_cvt_pk_bf16_f32 v22, v76, v77
    v_cvt_pk_bf16_f32 v23, v78, v79
    v_mfma_f32_32x32x16_bf16 v[112:127], a[84:87], a[140:143], v[112:127]
    ds_read_b64_tr_b16 a[84:85], v7 offset:43264
    ds_read_b64_tr_b16 a[86:87], v7 offset:43776
    buffer_store_dwordx4 v[16:19], v2, s[60:63], s70 offen offset:0 sc1
    buffer_store_dwordx4 v[20:23], v2, s[60:63], s70 offen offset:1024 sc1
    s_waitcnt lgkmcnt(10)
    v_mfma_f32_32x32x16_bf16 v[96:111], a[64:67], a[144:147], v[96:111]
    v_pk_mul_f32 v[80:81], v[80:81], v[8:9]
    v_pk_mul_f32 v[82:83], v[82:83], v[8:9]
    v_mfma_f32_32x32x16_bf16 v[112:127], a[64:67], a[148:151], v[112:127]
    ds_read_b64_tr_b16 a[64:65], v5 offset:25600
    ds_read_b64_tr_b16 a[66:67], v5 offset:26112
    v_pk_mul_f32 v[84:85], v[84:85], v[8:9]
    v_pk_mul_f32 v[86:87], v[86:87], v[8:9]
    s_waitcnt lgkmcnt(10)
    v_mfma_f32_32x32x16_bf16 v[96:111], a[68:71], a[152:155], v[96:111]
    v_pk_mul_f32 v[88:89], v[88:89], v[8:9]
    v_pk_mul_f32 v[90:91], v[90:91], v[8:9]
    v_mfma_f32_32x32x16_bf16 v[112:127], a[68:71], a[156:159], v[112:127]
    ds_read_b64_tr_b16 a[68:69], v5 offset:31744
    ds_read_b64_tr_b16 a[70:71], v5 offset:32256
    v_pk_mul_f32 v[92:93], v[92:93], v[8:9]
    v_pk_mul_f32 v[94:95], v[94:95], v[8:9]
    s_waitcnt lgkmcnt(10)
    v_mfma_f32_32x32x16_bf16 v[96:111], a[72:75], a[160:163], v[96:111]
    s_add_u32 s70, s71, 2048
    v_cvt_pk_bf16_f32 v24, v80, v81
    v_mfma_f32_32x32x16_bf16 v[112:127], a[72:75], a[164:167], v[112:127]
    ds_read_b64_tr_b16 a[72:73], v5 offset:37888
    ds_read_b64_tr_b16 a[74:75], v5 offset:38400
    v_cvt_pk_bf16_f32 v25, v82, v83
    v_cvt_pk_bf16_f32 v26, v84, v85
    s_waitcnt lgkmcnt(10)
    v_mfma_f32_32x32x16_bf16 v[96:111], a[76:79], a[168:171], v[96:111]
    v_cvt_pk_bf16_f32 v27, v86, v87
    v_cvt_pk_bf16_f32 v28, v88, v89
    v_mfma_f32_32x32x16_bf16 v[112:127], a[76:79], a[172:175], v[112:127]
    ds_read_b64_tr_b16 a[76:77], v5 offset:44032
    ds_read_b64_tr_b16 a[78:79], v5 offset:44544
    v_cvt_pk_bf16_f32 v29, v90, v91
    v_cvt_pk_bf16_f32 v30, v92, v93
    s_waitcnt lgkmcnt(10)
    v_mfma_f32_32x32x16_bf16 v[96:111], a[80:83], a[176:179], v[96:111]
    v_cvt_pk_bf16_f32 v31, v94, v95
    buffer_store_dwordx4 v[24:27], v2, s[60:63], s70 offen offset:0 sc1
    v_mfma_f32_32x32x16_bf16 v[112:127], a[80:83], a[180:183], v[112:127]
    ds_read_b64_tr_b16 a[80:81], v7 offset:1024
    ds_read_b64_tr_b16 a[82:83], v7 offset:1536
    buffer_store_dwordx4 v[28:31], v2, s[60:63], s70 offen offset:1024 sc1
    s_waitcnt lgkmcnt(10)
    v_mfma_f32_32x32x16_bf16 v[96:111], a[84:87], a[184:187], v[96:111]
    v_mfma_f32_32x32x16_bf16 v[112:127], a[84:87], a[188:191], v[112:127]
    ds_read_b64_tr_b16 a[84:85], v7 offset:7168
    ds_read_b64_tr_b16 a[86:87], v7 offset:7680
    s_waitcnt lgkmcnt(10)
    v_mfma_f32_32x32x16_bf16 v[128:143], a[64:67], a[32:35], v[128:143]
    v_mfma_f32_32x32x16_bf16 v[144:159], a[64:67], a[36:39], v[144:159]
    ds_read_b64_tr_b16 a[64:65], v7 offset:13312
    ds_read_b64_tr_b16 a[66:67], v7 offset:13824
    s_waitcnt lgkmcnt(10)
    v_mfma_f32_32x32x16_bf16 v[128:143], a[68:71], a[40:43], v[128:143]
    s_nop 15
    v_pk_mul_f32 v[96:97], v[96:97], v[8:9]
    v_mfma_f32_32x32x16_bf16 v[144:159], a[68:71], a[44:47], v[144:159]
    ds_read_b64_tr_b16 a[68:69], v7 offset:19456
    ds_read_b64_tr_b16 a[70:71], v7 offset:19968
    v_pk_mul_f32 v[98:99], v[98:99], v[8:9]
    v_pk_mul_f32 v[100:101], v[100:101], v[8:9]
    s_waitcnt lgkmcnt(10)
    v_mfma_f32_32x32x16_bf16 v[128:143], a[72:75], a[48:51], v[128:143]
    v_pk_mul_f32 v[102:103], v[102:103], v[8:9]
    v_pk_mul_f32 v[104:105], v[104:105], v[8:9]
    v_mfma_f32_32x32x16_bf16 v[144:159], a[72:75], a[52:55], v[144:159]
    ds_read_b64_tr_b16 a[72:73], v7 offset:25600
    ds_read_b64_tr_b16 a[74:75], v7 offset:26112
    v_pk_mul_f32 v[106:107], v[106:107], v[8:9]
    v_pk_mul_f32 v[108:109], v[108:109], v[8:9]
    s_waitcnt lgkmcnt(10)
    v_mfma_f32_32x32x16_bf16 v[128:143], a[76:79], a[56:59], v[128:143]
    v_pk_mul_f32 v[110:111], v[110:111], v[8:9]
    s_add_u32 s70, s71, 131072
    v_mfma_f32_32x32x16_bf16 v[144:159], a[76:79], a[60:63], v[144:159]
    ds_read_b64_tr_b16 a[76:77], v7 offset:31744
    ds_read_b64_tr_b16 a[78:79], v7 offset:32256
    v_cvt_pk_bf16_f32 v16, v96, v97
    v_cvt_pk_bf16_f32 v17, v98, v99
    s_waitcnt lgkmcnt(10)
    v_mfma_f32_32x32x16_bf16 v[128:143], a[80:83], a[128:131], v[128:143]
    v_cvt_pk_bf16_f32 v18, v100, v101
    v_cvt_pk_bf16_f32 v19, v102, v103
    v_mfma_f32_32x32x16_bf16 v[144:159], a[80:83], a[132:135], v[144:159]
    ds_read_b64_tr_b16 a[80:81], v7 offset:37888
    ds_read_b64_tr_b16 a[82:83], v7 offset:38400
    v_cvt_pk_bf16_f32 v20, v104, v105
    v_cvt_pk_bf16_f32 v21, v106, v107
    s_waitcnt lgkmcnt(10)
    v_mfma_f32_32x32x16_bf16 v[128:143], a[84:87], a[136:139], v[128:143]
    v_cvt_pk_bf16_f32 v22, v108, v109
    v_cvt_pk_bf16_f32 v23, v110, v111
    v_mfma_f32_32x32x16_bf16 v[144:159], a[84:87], a[140:143], v[144:159]
    ds_read_b64_tr_b16 a[84:85], v7 offset:44032
    ds_read_b64_tr_b16 a[86:87], v7 offset:44544
    buffer_store_dwordx4 v[16:19], v2, s[60:63], s70 offen offset:0 sc1
    buffer_store_dwordx4 v[20:23], v2, s[60:63], s70 offen offset:1024 sc1
    s_waitcnt lgkmcnt(10)
    v_mfma_f32_32x32x16_bf16 v[128:143], a[64:67], a[144:147], v[128:143]
    v_pk_mul_f32 v[112:113], v[112:113], v[8:9]
    v_pk_mul_f32 v[114:115], v[114:115], v[8:9]
    v_mfma_f32_32x32x16_bf16 v[144:159], a[64:67], a[148:151], v[144:159]
    ds_read_b64_tr_b16 a[64:65], v5 offset:25856
    ds_read_b64_tr_b16 a[66:67], v5 offset:26368
    v_pk_mul_f32 v[116:117], v[116:117], v[8:9]
    v_pk_mul_f32 v[118:119], v[118:119], v[8:9]
    s_waitcnt lgkmcnt(10)
    v_mfma_f32_32x32x16_bf16 v[128:143], a[68:71], a[152:155], v[128:143]
    v_pk_mul_f32 v[120:121], v[120:121], v[8:9]
    v_pk_mul_f32 v[122:123], v[122:123], v[8:9]
    v_mfma_f32_32x32x16_bf16 v[144:159], a[68:71], a[156:159], v[144:159]
    ds_read_b64_tr_b16 a[68:69], v5 offset:32000
    ds_read_b64_tr_b16 a[70:71], v5 offset:32512
    v_pk_mul_f32 v[124:125], v[124:125], v[8:9]
    v_pk_mul_f32 v[126:127], v[126:127], v[8:9]
    s_waitcnt lgkmcnt(10)
    v_mfma_f32_32x32x16_bf16 v[128:143], a[72:75], a[160:163], v[128:143]
    s_add_u32 s70, s71, 133120
    v_cvt_pk_bf16_f32 v24, v112, v113
    v_mfma_f32_32x32x16_bf16 v[144:159], a[72:75], a[164:167], v[144:159]
    ds_read_b64_tr_b16 a[72:73], v5 offset:38144
    ds_read_b64_tr_b16 a[74:75], v5 offset:38656
    v_cvt_pk_bf16_f32 v25, v114, v115
    v_cvt_pk_bf16_f32 v26, v116, v117
    s_waitcnt lgkmcnt(10)
    v_mfma_f32_32x32x16_bf16 v[128:143], a[76:79], a[168:171], v[128:143]
    v_cvt_pk_bf16_f32 v27, v118, v119
    v_cvt_pk_bf16_f32 v28, v120, v121
    v_mfma_f32_32x32x16_bf16 v[144:159], a[76:79], a[172:175], v[144:159]
    ds_read_b64_tr_b16 a[76:77], v5 offset:44288
    ds_read_b64_tr_b16 a[78:79], v5 offset:44800
    v_cvt_pk_bf16_f32 v29, v122, v123
    v_cvt_pk_bf16_f32 v30, v124, v125
    s_waitcnt lgkmcnt(10)
    v_mfma_f32_32x32x16_bf16 v[128:143], a[80:83], a[176:179], v[128:143]
    v_cvt_pk_bf16_f32 v31, v126, v127
    buffer_store_dwordx4 v[24:27], v2, s[60:63], s70 offen offset:0 sc1
    v_mfma_f32_32x32x16_bf16 v[144:159], a[80:83], a[180:183], v[144:159]
    ds_read_b64_tr_b16 a[80:81], v7 offset:1280
    ds_read_b64_tr_b16 a[82:83], v7 offset:1792
    buffer_store_dwordx4 v[28:31], v2, s[60:63], s70 offen offset:1024 sc1
    s_waitcnt lgkmcnt(10)
    v_mfma_f32_32x32x16_bf16 v[128:143], a[84:87], a[184:187], v[128:143]
    v_mfma_f32_32x32x16_bf16 v[144:159], a[84:87], a[188:191], v[144:159]
    ds_read_b64_tr_b16 a[84:85], v7 offset:7424
    ds_read_b64_tr_b16 a[86:87], v7 offset:7936
    s_waitcnt lgkmcnt(10)
    v_mfma_f32_32x32x16_bf16 v[160:175], a[64:67], a[32:35], v[160:175]
    v_mfma_f32_32x32x16_bf16 v[176:191], a[64:67], a[36:39], v[176:191]
    ds_read_b64_tr_b16 a[64:65], v7 offset:13568
    ds_read_b64_tr_b16 a[66:67], v7 offset:14080
    s_waitcnt lgkmcnt(10)
    v_mfma_f32_32x32x16_bf16 v[160:175], a[68:71], a[40:43], v[160:175]
    s_nop 15
    v_mfma_f32_32x32x16_bf16 v[176:191], a[68:71], a[44:47], v[176:191]
    ds_read_b64_tr_b16 a[68:69], v7 offset:19712
    ds_read_b64_tr_b16 a[70:71], v7 offset:20224
    s_add_u32 s70, s72, 0
    s_waitcnt lgkmcnt(10)
    v_mfma_f32_32x32x16_bf16 v[160:175], a[72:75], a[48:51], v[160:175]
    v_cvt_pk_bf16_f32 v16, v128, v129
    v_mfma_f32_32x32x16_bf16 v[176:191], a[72:75], a[52:55], v[176:191]
    ds_read_b64_tr_b16 a[72:73], v7 offset:25856
    ds_read_b64_tr_b16 a[74:75], v7 offset:26368
    v_cvt_pk_bf16_f32 v17, v130, v131
    s_waitcnt lgkmcnt(10)
    v_mfma_f32_32x32x16_bf16 v[160:175], a[76:79], a[56:59], v[160:175]
    v_cvt_pk_bf16_f32 v18, v132, v133
    v_mfma_f32_32x32x16_bf16 v[176:191], a[76:79], a[60:63], v[176:191]
    ds_read_b64_tr_b16 a[76:77], v7 offset:32000
    ds_read_b64_tr_b16 a[78:79], v7 offset:32512
    v_cvt_pk_bf16_f32 v19, v134, v135
    s_waitcnt lgkmcnt(10)
    v_mfma_f32_32x32x16_bf16 v[160:175], a[80:83], a[128:131], v[160:175]
    v_cvt_pk_bf16_f32 v20, v136, v137
    v_mfma_f32_32x32x16_bf16 v[176:191], a[80:83], a[132:135], v[176:191]
    ds_read_b64_tr_b16 a[80:81], v7 offset:38144
    ds_read_b64_tr_b16 a[82:83], v7 offset:38656
    v_cvt_pk_bf16_f32 v21, v138, v139
    s_waitcnt lgkmcnt(10)
    v_mfma_f32_32x32x16_bf16 v[160:175], a[84:87], a[136:139], v[160:175]
    v_cvt_pk_bf16_f32 v22, v140, v141
    v_mfma_f32_32x32x16_bf16 v[176:191], a[84:87], a[140:143], v[176:191]
    ds_read_b64_tr_b16 a[84:85], v7 offset:44288
    ds_read_b64_tr_b16 a[86:87], v7 offset:44800
    v_cvt_pk_bf16_f32 v23, v142, v143
    s_waitcnt lgkmcnt(10)
    v_mfma_f32_32x32x16_bf16 v[160:175], a[64:67], a[144:147], v[160:175]
    buffer_store_dwordx4 v[16:19], v2, s[60:63], s70 offen offset:0 sc1
    v_mfma_f32_32x32x16_bf16 v[176:191], a[64:67], a[148:151], v[176:191]
    ds_read_b64_tr_b16 a[64:65], v5 offset:26624
    ds_read_b64_tr_b16 a[66:67], v5 offset:27136
    buffer_store_dwordx4 v[20:23], v2, s[60:63], s70 offen offset:1024 sc1
    s_waitcnt lgkmcnt(10)
    v_mfma_f32_32x32x16_bf16 v[160:175], a[68:71], a[152:155], v[160:175]
    s_add_u32 s70, s72, 4096
    v_mfma_f32_32x32x16_bf16 v[176:191], a[68:71], a[156:159], v[176:191]
    ds_read_b64_tr_b16 a[68:69], v5 offset:32768
    ds_read_b64_tr_b16 a[70:71], v5 offset:33280
    v_cvt_pk_bf16_f32 v24, v144, v145
    s_waitcnt lgkmcnt(10)
    v_mfma_f32_32x32x16_bf16 v[160:175], a[72:75], a[160:163], v[160:175]
    v_cvt_pk_bf16_f32 v25, v146, v147
    v_mfma_f32_32x32x16_bf16 v[176:191], a[72:75], a[164:167], v[176:191]
    ds_read_b64_tr_b16 a[72:73], v5 offset:38912
    ds_read_b64_tr_b16 a[74:75], v5 offset:39424
    v_cvt_pk_bf16_f32 v26, v148, v149
    s_waitcnt lgkmcnt(10)
    v_mfma_f32_32x32x16_bf16 v[160:175], a[76:79], a[168:171], v[160:175]
    v_cvt_pk_bf16_f32 v27, v150, v151
    v_mfma_f32_32x32x16_bf16 v[176:191], a[76:79], a[172:175], v[176:191]
    ds_read_b64_tr_b16 a[76:77], v5 offset:45056
    ds_read_b64_tr_b16 a[78:79], v5 offset:45568
    v_cvt_pk_bf16_f32 v28, v152, v153
    s_waitcnt lgkmcnt(10)
    v_mfma_f32_32x32x16_bf16 v[160:175], a[80:83], a[176:179], v[160:175]
    v_cvt_pk_bf16_f32 v29, v154, v155
    v_mfma_f32_32x32x16_bf16 v[176:191], a[80:83], a[180:183], v[176:191]
    ds_read_b64_tr_b16 a[80:81], v7 offset:2048
    ds_read_b64_tr_b16 a[82:83], v7 offset:2560
    v_cvt_pk_bf16_f32 v30, v156, v157
    s_waitcnt lgkmcnt(10)
    v_mfma_f32_32x32x16_bf16 v[160:175], a[84:87], a[184:187], v[160:175]
    v_cvt_pk_bf16_f32 v31, v158, v159
    v_mfma_f32_32x32x16_bf16 v[176:191], a[84:87], a[188:191], v[176:191]
    ds_read_b64_tr_b16 a[84:85], v7 offset:8192
    ds_read_b64_tr_b16 a[86:87], v7 offset:8704
    buffer_store_dwordx4 v[24:27], v2, s[60:63], s70 offen offset:0 sc1
    s_waitcnt lgkmcnt(10)
    v_mfma_f32_32x32x16_bf16 v[192:207], a[32:35], a[64:67], v[192:207]
    buffer_store_dwordx4 v[28:31], v2, s[60:63], s70 offen offset:1024 sc1
    v_mfma_f32_32x32x16_bf16 v[208:223], a[36:39], a[64:67], v[208:223]
    ds_read_b64_tr_b16 a[64:65], v7 offset:14336
    ds_read_b64_tr_b16 a[66:67], v7 offset:14848
    s_waitcnt lgkmcnt(10)
    v_mfma_f32_32x32x16_bf16 v[192:207], a[40:43], a[68:71], v[192:207]
    s_nop 15
    v_mfma_f32_32x32x16_bf16 v[208:223], a[44:47], a[68:71], v[208:223]
    ds_read_b64_tr_b16 a[68:69], v7 offset:20480
    ds_read_b64_tr_b16 a[70:71], v7 offset:20992
    s_add_u32 s70, s72, 262144
    s_waitcnt lgkmcnt(10)
    v_mfma_f32_32x32x16_bf16 v[192:207], a[48:51], a[72:75], v[192:207]
    v_cvt_pk_bf16_f32 v16, v160, v161
    v_mfma_f32_32x32x16_bf16 v[208:223], a[52:55], a[72:75], v[208:223]
    ds_read_b64_tr_b16 a[72:73], v7 offset:26624
    ds_read_b64_tr_b16 a[74:75], v7 offset:27136
    v_cvt_pk_bf16_f32 v17, v162, v163
    s_waitcnt lgkmcnt(10)
    v_mfma_f32_32x32x16_bf16 v[192:207], a[56:59], a[76:79], v[192:207]
    v_cvt_pk_bf16_f32 v18, v164, v165
    v_mfma_f32_32x32x16_bf16 v[208:223], a[60:63], a[76:79], v[208:223]
    ds_read_b64_tr_b16 a[76:77], v7 offset:32768
    ds_read_b64_tr_b16 a[78:79], v7 offset:33280
    v_cvt_pk_bf16_f32 v19, v166, v167
    s_waitcnt lgkmcnt(10)
    v_mfma_f32_32x32x16_bf16 v[192:207], a[128:131], a[80:83], v[192:207]
    v_cvt_pk_bf16_f32 v20, v168, v169
    v_mfma_f32_32x32x16_bf16 v[208:223], a[132:135], a[80:83], v[208:223]
    ds_read_b64_tr_b16 a[80:81], v7 offset:38912
    ds_read_b64_tr_b16 a[82:83], v7 offset:39424
    v_cvt_pk_bf16_f32 v21, v170, v171
    s_waitcnt lgkmcnt(10)
    v_mfma_f32_32x32x16_bf16 v[192:207], a[136:139], a[84:87], v[192:207]
    v_cvt_pk_bf16_f32 v22, v172, v173
    v_mfma_f32_32x32x16_bf16 v[208:223], a[140:143], a[84:87], v[208:223]
    ds_read_b64_tr_b16 a[84:85], v7 offset:45056
    ds_read_b64_tr_b16 a[86:87], v7 offset:45568
    v_cvt_pk_bf16_f32 v23, v174, v175
    s_waitcnt lgkmcnt(10)
    v_mfma_f32_32x32x16_bf16 v[192:207], a[144:147], a[64:67], v[192:207]
    buffer_store_dwordx4 v[16:19], v2, s[60:63], s70 offen offset:0 sc1
    v_mfma_f32_32x32x16_bf16 v[208:223], a[148:151], a[64:67], v[208:223]
    ds_read_b64_tr_b16 a[64:65], v5 offset:26880
    ds_read_b64_tr_b16 a[66:67], v5 offset:27392
    buffer_store_dwordx4 v[20:23], v2, s[60:63], s70 offen offset:1024 sc1
    s_waitcnt lgkmcnt(10)
    v_mfma_f32_32x32x16_bf16 v[192:207], a[152:155], a[68:71], v[192:207]
    s_add_u32 s70, s72, 266240
    v_mfma_f32_32x32x16_bf16 v[208:223], a[156:159], a[68:71], v[208:223]
    ds_read_b64_tr_b16 a[68:69], v5 offset:33024
    ds_read_b64_tr_b16 a[70:71], v5 offset:33536
    v_cvt_pk_bf16_f32 v24, v176, v177
    s_waitcnt lgkmcnt(10)
    v_mfma_f32_32x32x16_bf16 v[192:207], a[160:163], a[72:75], v[192:207]
    v_cvt_pk_bf16_f32 v25, v178, v179
    v_mfma_f32_32x32x16_bf16 v[208:223], a[164:167], a[72:75], v[208:223]
    ds_read_b64_tr_b16 a[72:73], v5 offset:39168
    ds_read_b64_tr_b16 a[74:75], v5 offset:39680
    v_cvt_pk_bf16_f32 v26, v180, v181
    s_waitcnt lgkmcnt(10)
    v_mfma_f32_32x32x16_bf16 v[192:207], a[168:171], a[76:79], v[192:207]
    v_cvt_pk_bf16_f32 v27, v182, v183
    v_mfma_f32_32x32x16_bf16 v[208:223], a[172:175], a[76:79], v[208:223]
    ds_read_b64_tr_b16 a[76:77], v5 offset:45312
    ds_read_b64_tr_b16 a[78:79], v5 offset:45824
    v_cvt_pk_bf16_f32 v28, v184, v185
    s_waitcnt lgkmcnt(10)
    v_mfma_f32_32x32x16_bf16 v[192:207], a[176:179], a[80:83], v[192:207]
    v_cvt_pk_bf16_f32 v29, v186, v187
    v_mfma_f32_32x32x16_bf16 v[208:223], a[180:183], a[80:83], v[208:223]
    ds_read_b64_tr_b16 a[80:81], v7 offset:2304
    ds_read_b64_tr_b16 a[82:83], v7 offset:2816
    v_cvt_pk_bf16_f32 v30, v188, v189
    s_waitcnt lgkmcnt(10)
    v_mfma_f32_32x32x16_bf16 v[192:207], a[184:187], a[84:87], v[192:207]
    v_cvt_pk_bf16_f32 v31, v190, v191
    v_mfma_f32_32x32x16_bf16 v[208:223], a[188:191], a[84:87], v[208:223]
    ds_read_b64_tr_b16 a[84:85], v7 offset:8448
    ds_read_b64_tr_b16 a[86:87], v7 offset:8960
    buffer_store_dwordx4 v[24:27], v2, s[60:63], s70 offen offset:0 sc1
    s_waitcnt lgkmcnt(10)
    v_mfma_f32_32x32x16_bf16 v[224:239], a[32:35], a[64:67], v[224:239]
    buffer_store_dwordx4 v[28:31], v2, s[60:63], s70 offen offset:1024 sc1
    v_mfma_f32_32x32x16_bf16 v[240:255], a[36:39], a[64:67], v[240:255]
    ds_read_b64_tr_b16 a[64:65], v7 offset:14592
    ds_read_b64_tr_b16 a[66:67], v7 offset:15104
    s_waitcnt lgkmcnt(10)
    v_mfma_f32_32x32x16_bf16 v[224:239], a[40:43], a[68:71], v[224:239]
    s_nop 15
    s_add_u32 s70, s72, 0
    v_mfma_f32_32x32x16_bf16 v[240:255], a[44:47], a[68:71], v[240:255]
    ds_read_b64_tr_b16 a[68:69], v7 offset:20736
    ds_read_b64_tr_b16 a[70:71], v7 offset:21248
    v_cvt_pk_bf16_f32 v16, v192, v193
    v_cvt_pk_bf16_f32 v17, v194, v195
    s_waitcnt lgkmcnt(10)
    v_mfma_f32_32x32x16_bf16 v[224:239], a[48:51], a[72:75], v[224:239]
    v_cvt_pk_bf16_f32 v18, v196, v197
    v_cvt_pk_bf16_f32 v19, v198, v199
    v_mfma_f32_32x32x16_bf16 v[240:255], a[52:55], a[72:75], v[240:255]
    ds_read_b64_tr_b16 a[72:73], v7 offset:26880
    ds_read_b64_tr_b16 a[74:75], v7 offset:27392
    v_cvt_pk_bf16_f32 v20, v200, v201
    v_cvt_pk_bf16_f32 v21, v202, v203
    s_waitcnt lgkmcnt(10)
    v_mfma_f32_32x32x16_bf16 v[224:239], a[56:59], a[76:79], v[224:239]
    v_cvt_pk_bf16_f32 v22, v204, v205
    v_cvt_pk_bf16_f32 v23, v206, v207
    v_mfma_f32_32x32x16_bf16 v[240:255], a[60:63], a[76:79], v[240:255]
    ds_read_b64_tr_b16 a[76:77], v7 offset:33024
    ds_read_b64_tr_b16 a[78:79], v7 offset:33536
    buffer_store_dwordx4 v[16:19], v2, s[60:63], s70 offen offset:2048 sc1
    buffer_store_dwordx4 v[20:23], v2, s[60:63], s70 offen offset:3072 sc1
    s_waitcnt lgkmcnt(10)
    v_mfma_f32_32x32x16_bf16 v[224:239], a[128:131], a[80:83], v[224:239]
    s_add_u32 s70, s72, 4096
    v_cvt_pk_bf16_f32 v24, v208, v209
    v_mfma_f32_32x32x16_bf16 v[240:255], a[132:135], a[80:83], v[240:255]
    ds_read_b64_tr_b16 a[80:81], v7 offset:39168
    ds_read_b64_tr_b16 a[82:83], v7 offset:39680
    v_cvt_pk_bf16_f32 v25, v210, v211
    v_cvt_pk_bf16_f32 v26, v212, v213
    s_waitcnt lgkmcnt(10)
    v_mfma_f32_32x32x16_bf16 v[224:239], a[136:139], a[84:87], v[224:239]
    v_cvt_pk_bf16_f32 v27, v214, v215
    v_cvt_pk_bf16_f32 v28, v216, v217
    v_mfma_f32_32x32x16_bf16 v[240:255], a[140:143], a[84:87], v[240:255]
    ds_read_b64_tr_b16 a[84:85], v7 offset:45312
    ds_read_b64_tr_b16 a[86:87], v7 offset:45824
    v_cvt_pk_bf16_f32 v29, v218, v219
    v_cvt_pk_bf16_f32 v30, v220, v221
    s_waitcnt lgkmcnt(10)
    v_mfma_f32_32x32x16_bf16 v[224:239], a[144:147], a[64:67], v[224:239]
    v_cvt_pk_bf16_f32 v31, v222, v223
    buffer_store_dwordx4 v[24:27], v2, s[60:63], s70 offen offset:2048 sc1
    v_mfma_f32_32x32x16_bf16 v[240:255], a[148:151], a[64:67], v[240:255]
    buffer_store_dwordx4 v[28:31], v2, s[60:63], s70 offen offset:3072 sc1
    s_waitcnt lgkmcnt(8)
    v_mfma_f32_32x32x16_bf16 v[224:239], a[152:155], a[68:71], v[224:239]
    v_mfma_f32_32x32x16_bf16 v[240:255], a[156:159], a[68:71], v[240:255]
    s_waitcnt lgkmcnt(6)
    v_mfma_f32_32x32x16_bf16 v[224:239], a[160:163], a[72:75], v[224:239]
    v_mfma_f32_32x32x16_bf16 v[240:255], a[164:167], a[72:75], v[240:255]
    s_waitcnt lgkmcnt(4)
    v_mfma_f32_32x32x16_bf16 v[224:239], a[168:171], a[76:79], v[224:239]
    v_mfma_f32_32x32x16_bf16 v[240:255], a[172:175], a[76:79], v[240:255]
    s_waitcnt lgkmcnt(2)
    v_mfma_f32_32x32x16_bf16 v[224:239], a[176:179], a[80:83], v[224:239]
    v_mfma_f32_32x32x16_bf16 v[240:255], a[180:183], a[80:83], v[240:255]
    s_waitcnt lgkmcnt(0)
    v_mfma_f32_32x32x16_bf16 v[224:239], a[184:187], a[84:87], v[224:239]
    v_mfma_f32_32x32x16_bf16 v[240:255], a[188:191], a[84:87], v[240:255]
    s_nop 15
    s_nop 15
    s_add_u32 s70, s72, 262144
    v_cvt_pk_bf16_f32 v16, v224, v225
    v_cvt_pk_bf16_f32 v17, v226, v227
    v_cvt_pk_bf16_f32 v18, v228, v229
    v_cvt_pk_bf16_f32 v19, v230, v231
    v_cvt_pk_bf16_f32 v20, v232, v233
    v_cvt_pk_bf16_f32 v21, v234, v235
    v_cvt_pk_bf16_f32 v22, v236, v237
    v_cvt_pk_bf16_f32 v23, v238, v239
    buffer_store_dwordx4 v[16:19], v2, s[60:63], s70 offen offset:2048 sc1
    buffer_store_dwordx4 v[20:23], v2, s[60:63], s70 offen offset:3072 sc1
    s_add_u32 s70, s72, 266240
    v_cvt_pk_bf16_f32 v24, v240, v241
    v_cvt_pk_bf16_f32 v25, v242, v243
    v_cvt_pk_bf16_f32 v26, v244, v245
    v_cvt_pk_bf16_f32 v27, v246, v247
    v_cvt_pk_bf16_f32 v28, v248, v249
    v_cvt_pk_bf16_f32 v29, v250, v251
    v_cvt_pk_bf16_f32 v30, v252, v253
    v_cvt_pk_bf16_f32 v31, v254, v255
    buffer_store_dwordx4 v[24:27], v2, s[60:63], s70 offen offset:2048 sc1
    buffer_store_dwordx4 v[28:31], v2, s[60:63], s70 offen offset:3072 sc1
    buffer_load_dword v13, v10, s[44:47], s68 offen
    buffer_load_dword v14, v12, s[44:47], s68 offen
    s_waitcnt vmcnt(0)
    s_endpgm
.globl fused_kernel
.p2align 8
.type fused_kernel,@function
fused_kernel:
    s_cmp_ge_u32 s2, 256
    s_cbranch_scc0 f_go
    s_endpgm
f_go:
    v_lshrrev_b32 v1, 6, v0
    s_nop 0
    v_readfirstlane_b32 s33, v1
    v_and_b32 v1, 63, v0
    s_cmp_ge_u32 s33, 4
    s_cbranch_scc0 f_attn
    s_sub_u32 s33, s33, 4
    s_load_dwordx2 s[4:5], s[0:1], 16
    s_load_dwordx2 s[6:7], s[0:1], 48
    s_load_dwordx2 s[28:29], s[0:1], 80
    s_load_dwordx2 s[34:35], s[0:1], 0
    s_load_dwordx2 s[40:41], s[0:1], 56
    s_load_dwordx2 s[42:43], s[0:1], 64
    s_and_b32 s3, s2, 7
    s_lshr_b32 s32, s2, 3
    s_lshr_b32 s31, s3, 1
    s_lshl_b32 s31, s31, 2
    s_and_b32 s36, s32, 3
    s_add_u32 s31, s31, s36
    s_and_b32 s30, s3, 1
    s_lshl_b32 s30, s30, 3
    s_lshr_b32 s36, s32, 2
    s_add_u32 s30, s30, s36
    s_waitcnt lgkmcnt(0)
    s_mov_b32 s8, s6
    s_mov_b32 s9, s7
    s_mov_b32 s10, 0x700000
    s_mov_b32 s11, 0x20000
    s_add_u32 s12, s28, 0x1400000
    s_addc_u32 s13, s29, 0
    s_mov_b32 s14, 0x1200000
    s_mov_b32 s15, 0x20000
    s_mov_b32 s16, s34
    s_mov_b32 s17, s35
    s_mov_b32 s18, 0x400000
    s_mov_b32 s19, 0x20000
    s_mov_b32 s20, s40
    s_mov_b32 s21, s41
    s_mov_b32 s22, 0x800
    s_mov_b32 s23, 0x20000
    v_lshlrev_b32 v9, 4, v1
    s_lshl_b32 s36, s31, 2
    s_add_u32 s37, s33, 0
    s_and_b32 s37, s37, 3
    s_add_u32 s37, s37, s36
    s_mul_i32 s37, s37, 294912
    v_add_u32 v2, s37, v9
    s_add_u32 s37, s33, 1
    s_and_b32 s37, s37, 3
    s_add_u32 s37, s37, s36
    s_mul_i32 s37, s37, 294912
    v_add_u32 v3, s37, v9
    s_add_u32 s37, s33, 2
    s_and_b32 s37, s37, 3
    s_add_u32 s37, s37, s36
    s_mul_i32 s37, s37, 294912
    v_add_u32 v4, s37, v9
    s_add_u32 s37, s33, 3
    s_and_b32 s37, s37, 3
    s_add_u32 s37, s37, s36
    s_mul_i32 s37, s37, 294912
    v_add_u32 v5, s37, v9
    v_lshrrev_b32 v6, 5, v1
    v_lshlrev_b32 v6, 2, v6
    v_bfe_u32 v7, v1, 2, 2
    v_add_u32 v6, v6, v7
    v_lshlrev_b32 v6, 11, v6
    v_bfe_u32 v7, v1, 4, 1
    v_lshl_add_u32 v6, v7, 6, v6
    v_and_b32 v7, 3, v1
    v_lshl_add_u32 v6, v7, 4, v6
    s_lshl_b32 s37, s30, 7
    v_add_u32 v6, s37, v6
    v_add_u32 v7, 15360, v6
    s_mul_i32 s38, s33, 16384
    s_add_u32 s38, s38, 65536
    v_lshrrev_b32 v8, 5, v1
    v_lshlrev_b32 v8, 9, v8
    v_bfe_u32 v10, v1, 2, 2
    v_lshl_add_u32 v8, v10, 6, v8
    v_bfe_u32 v10, v1, 4, 1
    v_lshl_add_u32 v8, v10, 5, v8
    v_and_b32 v10, 3, v1
    v_lshl_add_u32 v8, v10, 3, v8
    v_add_u32 v8, s38, v8
    s_mul_i32 s24, s33, 1835008
    s_mul_i32 s25, s33, 57344
    s_add_u32 s25, s25, 65536
    s_lshl_b32 s44, s33, 19
    s_lshl_b32 s45, s33, 14
    s_barrier
    s_add_u32 m0, s38, 0
    s_nop 0
    buffer_load_dwordx4 v6, s[8:11], s24 offen lds
    buffer_load_dwordx4 v7, s[8:11], s24 offen offset:1024 lds
    s_add_u32 s24, s24, 0x8000
    s_lshl_b32 s37, s36, 5
    s_lshl_b32 s39, s33, 5
    s_add_u32 s37, s37, s39
    v_and_b32 v10, 31, v1
    v_add_u32 v10, s37, v10
    v_lshlrev_b32 v10, 11, v10
    v_lshrrev_b32 v11, 5, v1
    v_lshlrev_b32 v11, 4, v11
    s_lshl_b32 s37, s30, 7
    v_add_u32 v11, s37, v11
    v_add_u32 v10, v10, v11
    buffer_load_dwordx4 v[16:19], v10, s[16:19], 0 offen offset:0
    buffer_load_dwordx4 v[32:35], v11, s[20:23], 0 offen offset:0
    buffer_load_dwordx4 v[20:23], v10, s[16:19], 0 offen offset:32
    buffer_load_dwordx4 v[36:39], v11, s[20:23], 0 offen offset:32
    buffer_load_dwordx4 v[24:27], v10, s[16:19], 0 offen offset:64
    buffer_load_dwordx4 v[40:43], v11, s[20:23], 0 offen offset:64
    buffer_load_dwordx4 v[28:31], v10, s[16:19], 0 offen offset:96
    buffer_load_dwordx4 v[44:47], v11, s[20:23], 0 offen offset:96
    s_add_u32 m0, s38, 2048
    s_nop 0
    buffer_load_dwordx4 v6, s[8:11], s24 offen lds
    buffer_load_dwordx4 v7, s[8:11], s24 offen offset:1024 lds
    s_add_u32 s24, s24, 0x8000
    s_add_u32 m0, s38, 4096
    s_nop 0
    buffer_load_dwordx4 v6, s[8:11], s24 offen lds
    buffer_load_dwordx4 v7, s[8:11], s24 offen offset:1024 lds
    s_add_u32 s24, s24, 0x8000
    s_add_u32 m0, s38, 6144
    s_nop 0
    buffer_load_dwordx4 v6, s[8:11], s24 offen lds
    buffer_load_dwordx4 v7, s[8:11], s24 offen offset:1024 lds
    s_add_u32 s24, s24, 0x8000
    s_add_u32 m0, s38, 8192
    s_nop 0
    buffer_load_dwordx4 v6, s[8:11], s24 offen lds
    buffer_load_dwordx4 v7, s[8:11], s24 offen offset:1024 lds
    s_add_u32 s24, s24, 0x8000
    buffer_load_dwordx4 a[0:3], v2, s[12:15], s25 offen offset:0
    buffer_load_dwordx4 a[4:7], v3, s[12:15], s25 offen offset:0
    buffer_load_dwordx4 a[8:11], v4, s[12:15], s25 offen offset:0
    buffer_load_dwordx4 a[12:15], v5, s[12:15], s25 offen offset:0
    s_add_u32 m0, s38, 10240
    s_nop 0
    buffer_load_dwordx4 v6, s[8:11], s24 offen lds
    buffer_load_dwordx4 v7, s[8:11], s24 offen offset:1024 lds
    s_add_u32 s24, s24, 0x8000
    buffer_load_dwordx4 a[16:19], v2, s[12:15], s25 offen offset:1024
    buffer_load_dwordx4 a[20:23], v3, s[12:15], s25 offen offset:1024
    buffer_load_dwordx4 a[24:27], v4, s[12:15], s25 offen offset:1024
    buffer_load_dwordx4 a[28:31], v5, s[12:15], s25 offen offset:1024
    s_add_u32 m0, s38, 12288
    s_nop 0
    buffer_load_dwordx4 v6, s[8:11], s24 offen lds
    buffer_load_dwordx4 v7, s[8:11], s24 offen offset:1024 lds
    s_add_u32 s24, s24, 0x8000
    buffer_load_dwordx4 a[32:35], v2, s[12:15], s25 offen offset:2048
    buffer_load_dwordx4 a[36:39], v3, s[12:15], s25 offen offset:2048
    buffer_load_dwordx4 a[40:43], v4, s[12:15], s25 offen offset:2048
    buffer_load_dwordx4 a[44:47], v5, s[12:15], s25 offen offset:2048
    v_mov_b32 v48, 0
    v_mov_b32 v49, 0
    v_mov_b32 v50, 0
    v_mov_b32 v51, 0
    s_nop 1
    v_mfma_f32_32x32x16_bf16 v[96:111], v[48:51], v[48:51], 0
    v_mfma_f32_32x32x16_bf16 v[112:127], v[48:51], v[48:51], 0
    v_mfma_f32_32x32x16_bf16 v[128:143], v[48:51], v[48:51], 0
    v_mfma_f32_32x32x16_bf16 v[144:159], v[48:51], v[48:51], 0
    v_mfma_f32_32x32x16_bf16 v[160:175], v[48:51], v[48:51], 0
    v_mfma_f32_32x32x16_bf16 v[176:191], v[48:51], v[48:51], 0
    s_waitcnt vmcnt(24)
    s_mov_b32 s37, 0xffff0000
    v_lshlrev_b32 v64, 16, v16
    v_and_b32 v65, s37, v16
    v_lshlrev_b32 v12, 16, v32
    v_and_b32 v13, s37, v32
    v_add_f32 v64, v64, v12
    v_add_f32 v65, v65, v13
    v_lshlrev_b32 v66, 16, v17
    v_and_b32 v67, s37, v17
    v_lshlrev_b32 v12, 16, v33
    v_and_b32 v13, s37, v33
    v_add_f32 v66, v66, v12
    v_add_f32 v67, v67, v13
    v_lshlrev_b32 v68, 16, v18
    v_and_b32 v69, s37, v18
    v_lshlrev_b32 v12, 16, v34
    v_and_b32 v13, s37, v34
    v_add_f32 v68, v68, v12
    v_add_f32 v69, v69, v13
    v_lshlrev_b32 v70, 16, v19
    v_and_b32 v71, s37, v19
    v_lshlrev_b32 v12, 16, v35
    v_and_b32 v13, s37, v35
    v_add_f32 v70, v70, v12
    v_add_f32 v71, v71, v13
    v_lshlrev_b32 v72, 16, v20
    v_and_b32 v73, s37, v20
    v_lshlrev_b32 v12, 16, v36
    v_and_b32 v13, s37, v36
    v_add_f32 v72, v72, v12
    v_add_f32 v73, v73, v13
    v_lshlrev_b32 v74, 16, v21
    v_and_b32 v75, s37, v21
    v_lshlrev_b32 v12, 16, v37
    v_and_b32 v13, s37, v37
    v_add_f32 v74, v74, v12
    v_add_f32 v75, v75, v13
    v_lshlrev_b32 v76, 16, v22
    v_and_b32 v77, s37, v22
    v_lshlrev_b32 v12, 16, v38
    v_and_b32 v13, s37, v38
    v_add_f32 v76, v76, v12
    v_add_f32 v77, v77, v13
    v_lshlrev_b32 v78, 16, v23
    v_and_b32 v79, s37, v23
    v_lshlrev_b32 v12, 16, v39
    v_and_b32 v13, s37, v39
    v_add_f32 v78, v78, v12
    v_add_f32 v79, v79, v13
    v_lshlrev_b32 v80, 16, v24
    v_and_b32 v81, s37, v24
    v_lshlrev_b32 v12, 16, v40
    v_and_b32 v13, s37, v40
    v_add_f32 v80, v80, v12
    v_add_f32 v81, v81, v13
    v_lshlrev_b32 v82, 16, v25
    v_and_b32 v83, s37, v25
    v_lshlrev_b32 v12, 16, v41
    v_and_b32 v13, s37, v41
    v_add_f32 v82, v82, v12
    v_add_f32 v83, v83, v13
    v_lshlrev_b32 v84, 16, v26
    v_and_b32 v85, s37, v26
    v_lshlrev_b32 v12, 16, v42
    v_and_b32 v13, s37, v42
    v_add_f32 v84, v84, v12
    v_add_f32 v85, v85, v13
    v_lshlrev_b32 v86, 16, v27
    v_and_b32 v87, s37, v27
    v_lshlrev_b32 v12, 16, v43
    v_and_b32 v13, s37, v43
    v_add_f32 v86, v86, v12
    v_add_f32 v87, v87, v13
    v_lshlrev_b32 v88, 16, v28
    v_and_b32 v89, s37, v28
    v_lshlrev_b32 v12, 16, v44
    v_and_b32 v13, s37, v44
    v_add_f32 v88, v88, v12
    v_add_f32 v89, v89, v13
    v_lshlrev_b32 v90, 16, v29
    v_and_b32 v91, s37, v29
    v_lshlrev_b32 v12, 16, v45
    v_and_b32 v13, s37, v45
    v_add_f32 v90, v90, v12
    v_add_f32 v91, v91, v13
    v_lshlrev_b32 v92, 16, v30
    v_and_b32 v93, s37, v30
    v_lshlrev_b32 v12, 16, v46
    v_and_b32 v13, s37, v46
    v_add_f32 v92, v92, v12
    v_add_f32 v93, v93, v13
    v_lshlrev_b32 v94, 16, v31
    v_and_b32 v95, s37, v31
    v_lshlrev_b32 v12, 16, v47
    v_and_b32 v13, s37, v47
    v_add_f32 v94, v94, v12
    v_add_f32 v95, v95, v13
    s_nop 1
    v_permlane32_swap_b32 v64, v68
    v_permlane32_swap_b32 v65, v69
    v_permlane32_swap_b32 v66, v70
    v_permlane32_swap_b32 v67, v71
    v_permlane32_swap_b32 v72, v76
    v_permlane32_swap_b32 v73, v77
    v_permlane32_swap_b32 v74, v78
    v_permlane32_swap_b32 v75, v79
    v_permlane32_swap_b32 v80, v84
    v_permlane32_swap_b32 v81, v85
    v_permlane32_swap_b32 v82, v86
    v_permlane32_swap_b32 v83, v87
    v_permlane32_swap_b32 v88, v92
    v_permlane32_swap_b32 v89, v93
    v_permlane32_swap_b32 v90, v94
    v_permlane32_swap_b32 v91, v95
    s_add_u32 s16, s28, 0x2900000
    s_addc_u32 s17, s29, 0
    s_mov_b32 s18, 0x440000
    s_mov_b32 s19, 0x20000
    s_lshl_b32 s37, s31, 2
    s_add_u32 s37, s37, s33
    s_and_b32 s39, s30, 15
    s_lshl_b32 s39, s39, 6
    s_add_u32 s37, s37, s39
    s_mul_i32 s37, s37, 4352
    v_and_b32 v12, 15, v1
    v_lshlrev_b32 v12, 2, v12
    v_add_u32 v12, s37, v12
    s_waitcnt vmcnt(32)
    ds_read_b64_tr_b16 a[48:49], v8 offset:0
    ds_read_b64_tr_b16 a[50:51], v8 offset:1024
    ds_read_b64_tr_b16 a[52:53], v8 offset:256
    ds_read_b64_tr_b16 a[54:55], v8 offset:1280
    s_mov_b32 s26, 0
g2_loop:
    s_waitcnt vmcnt(12) lgkmcnt(0)
    v_mfma_f32_32x32x16_bf16 v[64:79], a[48:51], a[0:3], v[64:79]
    s_add_u32 m0, s38, 14336
    s_nop 0
    buffer_load_dwordx4 v6, s[8:11], s24 offen lds
    v_mfma_f32_32x32x16_bf16 v[96:111], a[48:51], a[4:7], v[96:111]
    buffer_load_dwordx4 v7, s[8:11], s24 offen offset:1024 lds
    s_add_u32 s24, s24, 0x8000
    v_mfma_f32_32x32x16_bf16 v[128:143], a[48:51], a[8:11], v[128:143]
    s_waitcnt vmcnt(24)
    ds_read_b64_tr_b16 a[56:57], v8 offset:2048
    ds_read_b64_tr_b16 a[58:59], v8 offset:3072
    v_mfma_f32_32x32x16_bf16 v[160:175], a[48:51], a[12:15], v[160:175]
    ds_read_b64_tr_b16 a[60:61], v8 offset:2304
    ds_read_b64_tr_b16 a[62:63], v8 offset:3328
    v_mfma_f32_32x32x16_bf16 v[80:95], a[52:55], a[0:3], v[80:95]
    buffer_load_dwordx4 v[48:51], v2, s[12:15], s25 offen offset:3072
    v_mfma_f32_32x32x16_bf16 v[112:127], a[52:55], a[4:7], v[112:127]
    buffer_load_dwordx4 v[52:55], v3, s[12:15], s25 offen offset:3072
    v_mfma_f32_32x32x16_bf16 v[144:159], a[52:55], a[8:11], v[144:159]
    buffer_load_dwordx4 v[56:59], v4, s[12:15], s25 offen offset:3072
    v_mfma_f32_32x32x16_bf16 v[176:191], a[52:55], a[12:15], v[176:191]
    buffer_load_dwordx4 v[60:63], v5, s[12:15], s25 offen offset:3072
    s_add_u32 s25, s25, 4096
    s_waitcnt vmcnt(12) lgkmcnt(0)
    v_mfma_f32_32x32x16_bf16 v[64:79], a[56:59], a[16:19], v[64:79]
    s_add_u32 m0, s38, 0
    s_nop 0
    buffer_load_dwordx4 v6, s[8:11], s24 offen lds
    v_mfma_f32_32x32x16_bf16 v[96:111], a[56:59], a[20:23], v[96:111]
    buffer_load_dwordx4 v7, s[8:11], s24 offen offset:1024 lds
    s_add_u32 s24, s24, 0x8000
    v_mfma_f32_32x32x16_bf16 v[128:143], a[56:59], a[24:27], v[128:143]
    s_waitcnt vmcnt(28)
    ds_read_b64_tr_b16 a[48:49], v8 offset:4096
    ds_read_b64_tr_b16 a[50:51], v8 offset:5120
    v_mfma_f32_32x32x16_bf16 v[160:175], a[56:59], a[28:31], v[160:175]
    ds_read_b64_tr_b16 a[52:53], v8 offset:4352
    ds_read_b64_tr_b16 a[54:55], v8 offset:5376
    v_mfma_f32_32x32x16_bf16 v[80:95], a[60:63], a[16:19], v[80:95]
    buffer_load_dwordx4 a[0:3], v2, s[12:15], s25 offen offset:0
    v_mfma_f32_32x32x16_bf16 v[112:127], a[60:63], a[20:23], v[112:127]
    buffer_load_dwordx4 a[4:7], v3, s[12:15], s25 offen offset:0
    v_mfma_f32_32x32x16_bf16 v[144:159], a[60:63], a[24:27], v[144:159]
    buffer_load_dwordx4 a[8:11], v4, s[12:15], s25 offen offset:0
    v_mfma_f32_32x32x16_bf16 v[176:191], a[60:63], a[28:31], v[176:191]
    buffer_load_dwordx4 a[12:15], v5, s[12:15], s25 offen offset:0
    s_waitcnt vmcnt(12) lgkmcnt(0)
    v_mfma_f32_32x32x16_bf16 v[64:79], a[48:51], a[32:35], v[64:79]
    s_add_u32 m0, s38, 2048
    s_nop 0
    buffer_load_dwordx4 v6, s[8:11], s24 offen lds
    v_mfma_f32_32x32x16_bf16 v[96:111], a[48:51], a[36:39], v[96:111]
    buffer_load_dwordx4 v7, s[8:11], s24 offen offset:1024 lds
    s_add_u32 s24, s24, 0x8000
    v_mfma_f32_32x32x16_bf16 v[128:143], a[48:51], a[40:43], v[128:143]
    s_waitcnt vmcnt(32)
    ds_read_b64_tr_b16 a[56:57], v8 offset:6144
    ds_read_b64_tr_b16 a[58:59], v8 offset:7168
    v_mfma_f32_32x32x16_bf16 v[160:175], a[48:51], a[44:47], v[160:175]
    ds_read_b64_tr_b16 a[60:61], v8 offset:6400
    ds_read_b64_tr_b16 a[62:63], v8 offset:7424
    v_mfma_f32_32x32x16_bf16 v[80:95], a[52:55], a[32:35], v[80:95]
    buffer_load_dwordx4 a[16:19], v2, s[12:15], s25 offen offset:1024
    v_mfma_f32_32x32x16_bf16 v[112:127], a[52:55], a[36:39], v[112:127]
    buffer_load_dwordx4 a[20:23], v3, s[12:15], s25 offen offset:1024
    v_mfma_f32_32x32x16_bf16 v[144:159], a[52:55], a[40:43], v[144:159]
    buffer_load_dwordx4 a[24:27], v4, s[12:15], s25 offen offset:1024
    v_mfma_f32_32x32x16_bf16 v[176:191], a[52:55], a[44:47], v[176:191]
    buffer_load_dwordx4 a[28:31], v5, s[12:15], s25 offen offset:1024
    s_waitcnt vmcnt(12) lgkmcnt(0)
    v_mfma_f32_32x32x16_bf16 v[64:79], a[56:59], v[48:51], v[64:79]
    s_add_u32 m0, s38, 4096
    s_nop 0
    buffer_load_dwordx4 v6, s[8:11], s24 offen lds
    v_mfma_f32_32x32x16_bf16 v[96:111], a[56:59], v[52:55], v[96:111]
    buffer_load_dwordx4 v7, s[8:11], s24 offen offset:1024 lds
    s_add_u32 s24, s24, 0x8000
    v_mfma_f32_32x32x16_bf16 v[128:143], a[56:59], v[56:59], v[128:143]
    s_waitcnt vmcnt(36)
    ds_read_b64_tr_b16 a[48:49], v8 offset:8192
    ds_read_b64_tr_b16 a[50:51], v8 offset:9216
    v_mfma_f32_32x32x16_bf16 v[160:175], a[56:59], v[60:63], v[160:175]
    ds_read_b64_tr_b16 a[52:53], v8 offset:8448
    ds_read_b64_tr_b16 a[54:55], v8 offset:9472
    v_mfma_f32_32x32x16_bf16 v[80:95], a[60:63], v[48:51], v[80:95]
    buffer_load_dwordx4 a[32:35], v2, s[12:15], s25 offen offset:2048
    v_mfma_f32_32x32x16_bf16 v[112:127], a[60:63], v[52:55], v[112:127]
    buffer_load_dwordx4 a[36:39], v3, s[12:15], s25 offen offset:2048
    v_mfma_f32_32x32x16_bf16 v[144:159], a[60:63], v[56:59], v[144:159]
    buffer_load_dwordx4 a[40:43], v4, s[12:15], s25 offen offset:2048
    v_mfma_f32_32x32x16_bf16 v[176:191], a[60:63], v[60:63], v[176:191]
    buffer_load_dwordx4 a[44:47], v5, s[12:15], s25 offen offset:2048
    s_waitcnt vmcnt(12) lgkmcnt(0)
    v_mfma_f32_32x32x16_bf16 v[64:79], a[48:51], a[0:3], v[64:79]
    s_add_u32 m0, s38, 6144
    s_nop 0
    buffer_load_dwordx4 v6, s[8:11], s24 offen lds
    v_mfma_f32_32x32x16_bf16 v[96:111], a[48:51], a[4:7], v[96:111]
    buffer_load_dwordx4 v7, s[8:11], s24 offen offset:1024 lds
    s_add_u32 s24, s24, 0x8000
    v_mfma_f32_32x32x16_bf16 v[128:143], a[48:51], a[8:11], v[128:143]
    s_waitcnt vmcnt(36)
    ds_read_b64_tr_b16 a[56:57], v8 offset:10240
    ds_read_b64_tr_b16 a[58:59], v8 offset:11264
    v_mfma_f32_32x32x16_bf16 v[160:175], a[48:51], a[12:15], v[160:175]
    ds_read_b64_tr_b16 a[60:61], v8 offset:10496
    ds_read_b64_tr_b16 a[62:63], v8 offset:11520
    v_mfma_f32_32x32x16_bf16 v[80:95], a[52:55], a[0:3], v[80:95]
    buffer_load_dwordx4 v[48:51], v2, s[12:15], s25 offen offset:3072
    v_mfma_f32_32x32x16_bf16 v[112:127], a[52:55], a[4:7], v[112:127]
    buffer_load_dwordx4 v[52:55], v3, s[12:15], s25 offen offset:3072
    v_mfma_f32_32x32x16_bf16 v[144:159], a[52:55], a[8:11], v[144:159]
    buffer_load_dwordx4 v[56:59], v4, s[12:15], s25 offen offset:3072
    v_mfma_f32_32x32x16_bf16 v[176:191], a[52:55], a[12:15], v[176:191]
    buffer_load_dwordx4 v[60:63], v5, s[12:15], s25 offen offset:3072
    s_add_u32 s25, s25, 4096
    s_waitcnt vmcnt(12) lgkmcnt(0)
    v_mfma_f32_32x32x16_bf16 v[64:79], a[56:59], a[16:19], v[64:79]
    s_add_u32 m0, s38, 8192
    s_nop 0
    buffer_load_dwordx4 v6, s[8:11], s24 offen lds
    v_mfma_f32_32x32x16_bf16 v[96:111], a[56:59], a[20:23], v[96:111]
    buffer_load_dwordx4 v7, s[8:11], s24 offen offset:1024 lds
    s_add_u32 s24, s24, 0x8000
    v_mfma_f32_32x32x16_bf16 v[128:143], a[56:59], a[24:27], v[128:143]
    s_waitcnt vmcnt(36)
    ds_read_b64_tr_b16 a[48:49], v8 offset:12288
    ds_read_b64_tr_b16 a[50:51], v8 offset:13312
    v_mfma_f32_32x32x16_bf16 v[160:175], a[56:59], a[28:31], v[160:175]
    ds_read_b64_tr_b16 a[52:53], v8 offset:12544
    ds_read_b64_tr_b16 a[54:55], v8 offset:13568
    v_mfma_f32_32x32x16_bf16 v[80:95], a[60:63], a[16:19], v[80:95]
    buffer_load_dwordx4 a[0:3], v2, s[12:15], s25 offen offset:0
    v_mfma_f32_32x32x16_bf16 v[112:127], a[60:63], a[20:23], v[112:127]
    buffer_load_dwordx4 a[4:7], v3, s[12:15], s25 offen offset:0
    v_mfma_f32_32x32x16_bf16 v[144:159], a[60:63], a[24:27], v[144:159]
    buffer_load_dwordx4 a[8:11], v4, s[12:15], s25 offen offset:0
    v_mfma_f32_32x32x16_bf16 v[176:191], a[60:63], a[28:31], v[176:191]
    buffer_load_dwordx4 a[12:15], v5, s[12:15], s25 offen offset:0
    s_waitcnt vmcnt(12) lgkmcnt(0)
    v_mfma_f32_32x32x16_bf16 v[64:79], a[48:51], a[32:35], v[64:79]
    s_add_u32 m0, s38, 10240
    s_nop 0
    buffer_load_dwordx4 v6, s[8:11], s24 offen lds
    v_mfma_f32_32x32x16_bf16 v[96:111], a[48:51], a[36:39], v[96:111]
    buffer_load_dwordx4 v7, s[8:11], s24 offen offset:1024 lds
    s_add_u32 s24, s24, 0x8000
    v_mfma_f32_32x32x16_bf16 v[128:143], a[48:51], a[40:43], v[128:143]
    s_waitcnt vmcnt(36)
    ds_read_b64_tr_b16 a[56:57], v8 offset:14336
    ds_read_b64_tr_b16 a[58:59], v8 offset:15360
    v_mfma_f32_32x32x16_bf16 v[160:175], a[48:51], a[44:47], v[160:175]
    ds_read_b64_tr_b16 a[60:61], v8 offset:14592
    ds_read_b64_tr_b16 a[62:63], v8 offset:15616
    v_mfma_f32_32x32x16_bf16 v[80:95], a[52:55], a[32:35], v[80:95]
    buffer_load_dwordx4 a[16:19], v2, s[12:15], s25 offen offset:1024
    v_mfma_f32_32x32x16_bf16 v[112:127], a[52:55], a[36:39], v[112:127]
    buffer_load_dwordx4 a[20:23], v3, s[12:15], s25 offen offset:1024
    v_mfma_f32_32x32x16_bf16 v[144:159], a[52:55], a[40:43], v[144:159]
    buffer_load_dwordx4 a[24:27], v4, s[12:15], s25 offen offset:1024
    v_mfma_f32_32x32x16_bf16 v[176:191], a[52:55], a[44:47], v[176:191]
    buffer_load_dwordx4 a[28:31], v5, s[12:15], s25 offen offset:1024
    s_waitcnt vmcnt(12) lgkmcnt(0)
    v_mfma_f32_32x32x16_bf16 v[64:79], a[56:59], v[48:51], v[64:79]
    s_add_u32 m0, s38, 12288
    s_nop 0
    buffer_load_dwordx4 v6, s[8:11], s24 offen lds
    v_mfma_f32_32x32x16_bf16 v[96:111], a[56:59], v[52:55], v[96:111]
    buffer_load_dwordx4 v7, s[8:11], s24 offen offset:1024 lds
    s_add_u32 s24, s24, 0x8000
    v_mfma_f32_32x32x16_bf16 v[128:143], a[56:59], v[56:59], v[128:143]
    s_waitcnt vmcnt(36)
    ds_read_b64_tr_b16 a[48:49], v8 offset:0
    ds_read_b64_tr_b16 a[50:51], v8 offset:1024
    v_mfma_f32_32x32x16_bf16 v[160:175], a[56:59], v[60:63], v[160:175]
    ds_read_b64_tr_b16 a[52:53], v8 offset:256
    ds_read_b64_tr_b16 a[54:55], v8 offset:1280
    v_mfma_f32_32x32x16_bf16 v[80:95], a[60:63], v[48:51], v[80:95]
    buffer_load_dwordx4 a[32:35], v2, s[12:15], s25 offen offset:2048
    v_mfma_f32_32x32x16_bf16 v[112:127], a[60:63], v[52:55], v[112:127]
    buffer_load_dwordx4 a[36:39], v3, s[12:15], s25 offen offset:2048
    v_mfma_f32_32x32x16_bf16 v[144:159], a[60:63], v[56:59], v[144:159]
    buffer_load_dwordx4 a[40:43], v4, s[12:15], s25 offen offset:2048
    v_mfma_f32_32x32x16_bf16 v[176:191], a[60:63], v[60:63], v[176:191]
    buffer_load_dwordx4 a[44:47], v5, s[12:15], s25 offen offset:2048
    s_add_u32 s26, s26, 1
    s_cmp_lt_u32 s26, 6
    s_cbranch_scc1 g2_loop
    s_mov_b32 s20, s4
    s_mov_b32 s21, s5
    s_mov_b32 s22, 0x200000
    s_mov_b32 s23, 0x20000
    s_and_b32 s37, s31, 3
    s_lshl_b32 s37, s37, 1
    v_lshrrev_b32 v14, 5, v1
    v_add_u32 v14, s37, v14
    v_lshlrev_b32 v14, 2, v14
    v_add_u32 v14, s33, v14
    v_and_b32 v15, 31, v1
    v_lshl_add_u32 v14, v14, 5, v15
    v_lshlrev_b32 v14, 11, v14
    s_lshl_b32 s37, s30, 7
    buffer_load_dword v0, v14, s[20:23], s37 offen
    s_waitcnt vmcnt(13) lgkmcnt(0)
    v_mfma_f32_32x32x16_bf16 v[64:79], a[48:51], a[0:3], v[64:79]
    s_add_u32 m0, s38, 14336
    s_nop 0
    buffer_load_dwordx4 v6, s[8:11], s24 offen lds
    v_mfma_f32_32x32x16_bf16 v[96:111], a[48:51], a[4:7], v[96:111]
    buffer_load_dwordx4 v7, s[8:11], s24 offen offset:1024 lds
    s_add_u32 s24, s24, 0x8000
    v_mfma_f32_32x32x16_bf16 v[128:143], a[48:51], a[8:11], v[128:143]
    s_waitcnt vmcnt(37)
    ds_read_b64_tr_b16 a[56:57], v8 offset:2048
    ds_read_b64_tr_b16 a[58:59], v8 offset:3072
    v_mfma_f32_32x32x16_bf16 v[160:175], a[48:51], a[12:15], v[160:175]
    ds_read_b64_tr_b16 a[60:61], v8 offset:2304
    ds_read_b64_tr_b16 a[62:63], v8 offset:3328
    v_mfma_f32_32x32x16_bf16 v[80:95], a[52:55], a[0:3], v[80:95]
    buffer_load_dwordx4 v[48:51], v2, s[12:15], s25 offen offset:3072
    v_mfma_f32_32x32x16_bf16 v[112:127], a[52:55], a[4:7], v[112:127]
    buffer_load_dwordx4 v[52:55], v3, s[12:15], s25 offen offset:3072
    v_mfma_f32_32x32x16_bf16 v[144:159], a[52:55], a[8:11], v[144:159]
    buffer_load_dwordx4 v[56:59], v4, s[12:15], s25 offen offset:3072
    v_mfma_f32_32x32x16_bf16 v[176:191], a[52:55], a[12:15], v[176:191]
    buffer_load_dwordx4 v[60:63], v5, s[12:15], s25 offen offset:3072
    s_add_u32 s25, s25, 4096
    s_waitcnt vmcnt(13) lgkmcnt(0)
    v_mfma_f32_32x32x16_bf16 v[64:79], a[56:59], a[16:19], v[64:79]
    v_mfma_f32_32x32x16_bf16 v[96:111], a[56:59], a[20:23], v[96:111]
    v_mfma_f32_32x32x16_bf16 v[128:143], a[56:59], a[24:27], v[128:143]
    s_waitcnt vmcnt(35)
    ds_read_b64_tr_b16 a[48:49], v8 offset:4096
    ds_read_b64_tr_b16 a[50:51], v8 offset:5120
    v_mfma_f32_32x32x16_bf16 v[160:175], a[56:59], a[28:31], v[160:175]
    ds_read_b64_tr_b16 a[52:53], v8 offset:4352
    ds_read_b64_tr_b16 a[54:55], v8 offset:5376
    v_mfma_f32_32x32x16_bf16 v[80:95], a[60:63], a[16:19], v[80:95]
    buffer_load_dwordx4 a[0:3], v2, s[12:15], s25 offen offset:0
    v_mfma_f32_32x32x16_bf16 v[112:127], a[60:63], a[20:23], v[112:127]
    buffer_load_dwordx4 a[4:7], v3, s[12:15], s25 offen offset:0
    v_mfma_f32_32x32x16_bf16 v[144:159], a[60:63], a[24:27], v[144:159]
    buffer_load_dwordx4 a[8:11], v4, s[12:15], s25 offen offset:0
    v_mfma_f32_32x32x16_bf16 v[176:191], a[60:63], a[28:31], v[176:191]
    buffer_load_dwordx4 a[12:15], v5, s[12:15], s25 offen offset:0
    s_waitcnt vmcnt(11) lgkmcnt(0)
    v_mfma_f32_32x32x16_bf16 v[64:79], a[48:51], a[32:35], v[64:79]
    v_mfma_f32_32x32x16_bf16 v[96:111], a[48:51], a[36:39], v[96:111]
    v_mfma_f32_32x32x16_bf16 v[128:143], a[48:51], a[40:43], v[128:143]
    s_waitcnt vmcnt(33)
    ds_read_b64_tr_b16 a[56:57], v8 offset:6144
    ds_read_b64_tr_b16 a[58:59], v8 offset:7168
    v_mfma_f32_32x32x16_bf16 v[160:175], a[48:51], a[44:47], v[160:175]
    ds_read_b64_tr_b16 a[60:61], v8 offset:6400
    ds_read_b64_tr_b16 a[62:63], v8 offset:7424
    v_mfma_f32_32x32x16_bf16 v[80:95], a[52:55], a[32:35], v[80:95]
    buffer_load_dwordx4 a[16:19], v2, s[12:15], s25 offen offset:1024
    v_mfma_f32_32x32x16_bf16 v[112:127], a[52:55], a[36:39], v[112:127]
    buffer_load_dwordx4 a[20:23], v3, s[12:15], s25 offen offset:1024
    v_mfma_f32_32x32x16_bf16 v[144:159], a[52:55], a[40:43], v[144:159]
    buffer_load_dwordx4 a[24:27], v4, s[12:15], s25 offen offset:1024
    v_mfma_f32_32x32x16_bf16 v[176:191], a[52:55], a[44:47], v[176:191]
    buffer_load_dwordx4 a[28:31], v5, s[12:15], s25 offen offset:1024
    s_waitcnt vmcnt(8) lgkmcnt(0)
    v_mfma_f32_32x32x16_bf16 v[64:79], a[56:59], v[48:51], v[64:79]
    v_mfma_f32_32x32x16_bf16 v[96:111], a[56:59], v[52:55], v[96:111]
    v_mfma_f32_32x32x16_bf16 v[128:143], a[56:59], v[56:59], v[128:143]
    s_waitcnt vmcnt(31)
    ds_read_b64_tr_b16 a[48:49], v8 offset:8192
    ds_read_b64_tr_b16 a[50:51], v8 offset:9216
    v_mfma_f32_32x32x16_bf16 v[160:175], a[56:59], v[60:63], v[160:175]
    ds_read_b64_tr_b16 a[52:53], v8 offset:8448
    ds_read_b64_tr_b16 a[54:55], v8 offset:9472
    v_mfma_f32_32x32x16_bf16 v[80:95], a[60:63], v[48:51], v[80:95]
    buffer_load_dwordx4 a[32:35], v2, s[12:15], s25 offen offset:2048
    v_mfma_f32_32x32x16_bf16 v[112:127], a[60:63], v[52:55], v[112:127]
    buffer_load_dwordx4 a[36:39], v3, s[12:15], s25 offen offset:2048
    v_mfma_f32_32x32x16_bf16 v[144:159], a[60:63], v[56:59], v[144:159]
    buffer_load_dwordx4 a[40:43], v4, s[12:15], s25 offen offset:2048
    v_mfma_f32_32x32x16_bf16 v[176:191], a[60:63], v[60:63], v[176:191]
    buffer_load_dwordx4 a[44:47], v5, s[12:15], s25 offen offset:2048
    s_waitcnt vmcnt(8) lgkmcnt(0)
    v_mfma_f32_32x32x16_bf16 v[64:79], a[48:51], a[0:3], v[64:79]
    v_mfma_f32_32x32x16_bf16 v[96:111], a[48:51], a[4:7], v[96:111]
    v_mfma_f32_32x32x16_bf16 v[128:143], a[48:51], a[8:11], v[128:143]
    s_waitcnt vmcnt(29)
    ds_read_b64_tr_b16 a[56:57], v8 offset:10240
    ds_read_b64_tr_b16 a[58:59], v8 offset:11264
    v_mfma_f32_32x32x16_bf16 v[160:175], a[48:51], a[12:15], v[160:175]
    ds_read_b64_tr_b16 a[60:61], v8 offset:10496
    ds_read_b64_tr_b16 a[62:63], v8 offset:11520
    v_mfma_f32_32x32x16_bf16 v[80:95], a[52:55], a[0:3], v[80:95]
    buffer_load_dwordx4 v[48:51], v2, s[12:15], s25 offen offset:3072
    v_mfma_f32_32x32x16_bf16 v[112:127], a[52:55], a[4:7], v[112:127]
    buffer_load_dwordx4 v[52:55], v3, s[12:15], s25 offen offset:3072
    v_mfma_f32_32x32x16_bf16 v[144:159], a[52:55], a[8:11], v[144:159]
    buffer_load_dwordx4 v[56:59], v4, s[12:15], s25 offen offset:3072
    v_mfma_f32_32x32x16_bf16 v[176:191], a[52:55], a[12:15], v[176:191]
    buffer_load_dwordx4 v[60:63], v5, s[12:15], s25 offen offset:3072
    s_add_u32 s25, s25, 4096
    s_waitcnt vmcnt(8) lgkmcnt(0)
    v_mfma_f32_32x32x16_bf16 v[64:79], a[56:59], a[16:19], v[64:79]
    v_mfma_f32_32x32x16_bf16 v[96:111], a[56:59], a[20:23], v[96:111]
    v_mfma_f32_32x32x16_bf16 v[128:143], a[56:59], a[24:27], v[128:143]
    s_waitcnt vmcnt(27)
    ds_read_b64_tr_b16 a[48:49], v8 offset:12288
    ds_read_b64_tr_b16 a[50:51], v8 offset:13312
    v_mfma_f32_32x32x16_bf16 v[160:175], a[56:59], a[28:31], v[160:175]
    ds_read_b64_tr_b16 a[52:53], v8 offset:12544
    ds_read_b64_tr_b16 a[54:55], v8 offset:13568
    v_mfma_f32_32x32x16_bf16 v[80:95], a[60:63], a[16:19], v[80:95]
    v_mfma_f32_32x32x16_bf16 v[112:127], a[60:63], a[20:23], v[112:127]
    v_mfma_f32_32x32x16_bf16 v[144:159], a[60:63], a[24:27], v[144:159]
    v_mfma_f32_32x32x16_bf16 v[176:191], a[60:63], a[28:31], v[176:191]
    buffer_load_dword v13, v12, s[16:19], 0 offen sc1
    s_waitcnt vmcnt(5) lgkmcnt(0)
    v_mfma_f32_32x32x16_bf16 v[64:79], a[48:51], a[32:35], v[64:79]
    v_mfma_f32_32x32x16_bf16 v[96:111], a[48:51], a[36:39], v[96:111]
    v_mfma_f32_32x32x16_bf16 v[128:143], a[48:51], a[40:43], v[128:143]
    s_waitcnt vmcnt(21)
    ds_read_b64_tr_b16 a[56:57], v8 offset:14336
    ds_read_b64_tr_b16 a[58:59], v8 offset:15360
    v_mfma_f32_32x32x16_bf16 v[160:175], a[48:51], a[44:47], v[160:175]
    ds_read_b64_tr_b16 a[60:61], v8 offset:14592
    ds_read_b64_tr_b16 a[62:63], v8 offset:15616
    v_mfma_f32_32x32x16_bf16 v[80:95], a[52:55], a[32:35], v[80:95]
    v_mfma_f32_32x32x16_bf16 v[112:127], a[52:55], a[36:39], v[112:127]
    v_mfma_f32_32x32x16_bf16 v[144:159], a[52:55], a[40:43], v[144:159]
    v_mfma_f32_32x32x16_bf16 v[176:191], a[52:55], a[44:47], v[176:191]
    s_waitcnt vmcnt(1) lgkmcnt(0)
    v_mfma_f32_32x32x16_bf16 v[64:79], a[56:59], v[48:51], v[64:79]
    v_mfma_f32_32x32x16_bf16 v[96:111], a[56:59], v[52:55], v[96:111]
    v_mfma_f32_32x32x16_bf16 v[128:143], a[56:59], v[56:59], v[128:143]
    v_mfma_f32_32x32x16_bf16 v[160:175], a[56:59], v[60:63], v[160:175]
    v_mfma_f32_32x32x16_bf16 v[80:95], a[60:63], v[48:51], v[80:95]
    v_mfma_f32_32x32x16_bf16 v[112:127], a[60:63], v[52:55], v[112:127]
    v_mfma_f32_32x32x16_bf16 v[144:159], a[60:63], v[56:59], v[144:159]
    v_mfma_f32_32x32x16_bf16 v[176:191], a[60:63], v[60:63], v[176:191]
    s_mov_b32 s8, s4
    s_mov_b32 s9, s5
    s_mov_b32 s10, 0x200000
    s_mov_b32 s11, 0x20000
    s_mov_b32 s46, 0x5555
    s_mov_b32 s26, 0
    s_add_u32 s24, s33, 0
    s_lshl_b32 s24, s24, 16
    s_add_u32 m0, s38, 0
    s_nop 0
    buffer_load_dwordx4 v6, s[8:11], s24 offen lds
    buffer_load_dwordx4 v7, s[8:11], s24 offen offset:1024 lds
    s_add_u32 s24, s24, 0x8000
    s_add_u32 m0, s38, 2048
    s_nop 0
    buffer_load_dwordx4 v6, s[8:11], s24 offen lds
    buffer_load_dwordx4 v7, s[8:11], s24 offen offset:1024 lds
    s_add_u32 s24, s24, 0x8000
    s_add_u32 s24, s33, 4
    s_lshl_b32 s24, s24, 16
    s_add_u32 m0, s38, 4096
    s_nop 0
    buffer_load_dwordx4 v6, s[8:11], s24 offen lds
    buffer_load_dwordx4 v7, s[8:11], s24 offen offset:1024 lds
    s_add_u32 s24, s24, 0x8000
    s_add_u32 m0, s38, 6144
    s_nop 0
    buffer_load_dwordx4 v6, s[8:11], s24 offen lds
    buffer_load_dwordx4 v7, s[8:11], s24 offen offset:1024 lds
    s_add_u32 s24, s24, 0x8000
    s_add_u32 s24, s33, 8
    s_lshl_b32 s24, s24, 16
    s_add_u32 m0, s38, 8192
    s_nop 0
    buffer_load_dwordx4 v6, s[8:11], s24 offen lds
    buffer_load_dwordx4 v7, s[8:11], s24 offen offset:1024 lds
    s_add_u32 s24, s24, 0x8000
    s_add_u32 m0, s38, 10240
    s_nop 0
    buffer_load_dwordx4 v6, s[8:11], s24 offen lds
    buffer_load_dwordx4 v7, s[8:11], s24 offen offset:1024 lds
    s_add_u32 s24, s24, 0x8000
    s_add_u32 s24, s33, 12
    s_lshl_b32 s24, s24, 16
    s_add_u32 m0, s38, 12288
    s_nop 0
    buffer_load_dwordx4 v6, s[8:11], s24 offen lds
    buffer_load_dwordx4 v7, s[8:11], s24 offen offset:1024 lds
    s_add_u32 s24, s24, 0x8000
    s_add_u32 m0, s38, 14336
    s_nop 0
    buffer_load_dwordx4 v6, s[8:11], s24 offen lds
    buffer_load_dwordx4 v7, s[8:11], s24 offen offset:1024 lds
    s_add_u32 s24, s24, 0x8000
    s_mov_b32 s49, 0x55
    s_waitcnt vmcnt(16)
g2_o0:
    v_cmp_ne_u32 vcc, 0, v13
    s_add_u32 s26, s26, 1
    s_lshr_b32 s37, vcc_lo, 1
    s_and_b32 s37, s37, vcc_lo
    s_cmp_ge_u32 s26, 0x8000
    s_cselect_b32 s37, s46, s37
    s_and_b32 s37, s37, s46
    s_cbranch_scc1 g2_o0_go
    buffer_load_dword v13, v12, s[16:19], 0 offen sc1
    s_waitcnt vmcnt(0)
    s_branch g2_o0
g2_o0_go:
    s_and_b32 s52, s37, s51
    s_andn2_b32 s51, s51, s37
    s_ff1_i32_b32 s37, s37
    s_bitset0_b32 s46, s37
    s_bitset0_b32 s52, s37
    s_lshl_b32 s44, s37, 11
    s_and_b32 s39, s49, s46
    s_ff1_i32_b32 s39, s39
    s_lshl_b32 s50, s39, 11
    s_lshl_b32 s39, 1, s39
    s_add_u32 s48, s38, s50
    s_bitcmp1_b32 s49, s37
    s_cselect_b32 s44, s44, s50
    s_cselect_b32 s10, 0, 2097152
    s_cselect_b32 s48, 131136, s48
    s_cselect_b32 s39, 0, s39
    s_andn2_b32 s49, s49, s39
    s_lshl_b32 s37, s37, 1
    s_add_u32 s37, s37, s33
    s_lshl_b32 s25, s37, 11
    s_lshl_b32 s24, s37, 16
    buffer_load_dword v0, v12, s[16:19], 0 offen sc1
    buffer_load_dwordx4 a[0:3], v2, s[12:15], s25 offen offset:0
    buffer_load_dwordx4 a[4:7], v3, s[12:15], s25 offen offset:0
    buffer_load_dwordx4 a[8:11], v4, s[12:15], s25 offen offset:0
    buffer_load_dwordx4 a[12:15], v5, s[12:15], s25 offen offset:0
    buffer_load_dwordx4 a[16:19], v2, s[12:15], s25 offen offset:1024
    buffer_load_dwordx4 a[20:23], v3, s[12:15], s25 offen offset:1024
    buffer_load_dwordx4 a[24:27], v4, s[12:15], s25 offen offset:1024
    buffer_load_dwordx4 a[28:31], v5, s[12:15], s25 offen offset:1024
    s_cmp_eq_u32 s10, 0
    s_cbranch_scc1 g2_d00
    s_add_u32 m0, s48, 0
    s_nop 0
    buffer_load_dwordx4 v6, s[8:11], s24 offen lds
    buffer_load_dwordx4 v7, s[8:11], s24 offen offset:1024 lds
    s_add_u32 s24, s24, 0x8000
g2_d00:
    s_cmp_eq_u32 s10, 0
    s_cbranch_scc1 g2_d01
    s_add_u32 m0, s48, 2048
    s_nop 0
    buffer_load_dwordx4 v6, s[8:11], s24 offen lds
    buffer_load_dwordx4 v7, s[8:11], s24 offen offset:1024 lds
    s_add_u32 s24, s24, 0x8000
g2_d01:
    v_cmp_ne_u32 vcc, 0, v13
    s_nop 0
    s_lshr_b32 s37, vcc_lo, 1
    s_and_b32 s37, s37, vcc_lo
    s_and_b32 s37, s37, s46
    s_cbranch_scc1 g2_o1_go
    s_waitcnt vmcnt(8)
g2_o1:
    v_cmp_ne_u32 vcc, 0, v0
    s_add_u32 s26, s26, 1
    s_lshr_b32 s37, vcc_lo, 1
    s_and_b32 s37, s37, vcc_lo
    s_cmp_ge_u32 s26, 0x8000
    s_cselect_b32 s37, s46, s37
    s_and_b32 s37, s37, s46
    s_cbranch_scc1 g2_o1_go
    buffer_load_dword v0, v12, s[16:19], 0 offen sc1
    s_waitcnt vmcnt(0)
    s_branch g2_o1
g2_o1_go:
    s_and_b32 s52, s37, s51
    s_andn2_b32 s51, s51, s37
    s_ff1_i32_b32 s37, s37
    s_bitset0_b32 s46, s37
    s_bitset0_b32 s52, s37
    s_lshl_b32 s45, s37, 11
    s_and_b32 s39, s49, s46
    s_ff1_i32_b32 s39, s39
    s_lshl_b32 s50, s39, 11
    s_lshl_b32 s39, 1, s39
    s_add_u32 s48, s38, s50
    s_bitcmp1_b32 s49, s37
    s_cselect_b32 s45, s45, s50
    s_cselect_b32 s10, 0, 2097152
    s_cselect_b32 s48, 131136, s48
    s_cselect_b32 s39, 0, s39
    s_andn2_b32 s49, s49, s39
    s_lshl_b32 s37, s37, 1
    s_add_u32 s37, s37, s33
    s_lshl_b32 s25, s37, 11
    s_lshl_b32 s24, s37, 16
    buffer_load_dword v13, v12, s[16:19], 0 offen sc1
    buffer_load_dwordx4 a[32:35], v2, s[12:15], s25 offen offset:0
    buffer_load_dwordx4 a[36:39], v3, s[12:15], s25 offen offset:0
    buffer_load_dwordx4 a[40:43], v4, s[12:15], s25 offen offset:0
    buffer_load_dwordx4 a[44:47], v5, s[12:15], s25 offen offset:0
    buffer_load_dwordx4 v[48:51], v2, s[12:15], s25 offen offset:1024
    buffer_load_dwordx4 v[52:55], v3, s[12:15], s25 offen offset:1024
    buffer_load_dwordx4 v[56:59], v4, s[12:15], s25 offen offset:1024
    buffer_load_dwordx4 v[60:63], v5, s[12:15], s25 offen offset:1024
    s_cmp_eq_u32 s10, 0
    s_cbranch_scc1 g2_d10
    s_add_u32 m0, s48, 0
    s_nop 0
    buffer_load_dwordx4 v6, s[8:11], s24 offen lds
    buffer_load_dwordx4 v7, s[8:11], s24 offen offset:1024 lds
    s_add_u32 s24, s24, 0x8000
g2_d10:
    s_cmp_eq_u32 s10, 0
    s_cbranch_scc1 g2_d11
    s_add_u32 m0, s48, 2048
    s_nop 0
    buffer_load_dwordx4 v6, s[8:11], s24 offen lds
    buffer_load_dwordx4 v7, s[8:11], s24 offen offset:1024 lds
    s_add_u32 s24, s24, 0x8000
g2_d11:
    v_add_u32 v11, s44, v8
    s_waitcnt vmcnt(13)
    s_cmp_lg_u32 s10, 0
    s_cbranch_scc1 g2_w2
    s_waitcnt vmcnt(9)
g2_w2:
    ds_read_b64_tr_b16 a[48:49], v11 offset:0
    ds_read_b64_tr_b16 a[50:51], v11 offset:1024
    ds_read_b64_tr_b16 a[52:53], v11 offset:256
    ds_read_b64_tr_b16 a[54:55], v11 offset:1280
    v_cmp_ne_u32 vcc, 0, v0
    s_nop 0
    s_lshr_b32 s37, vcc_lo, 1
    s_and_b32 s37, s37, vcc_lo
    s_and_b32 s37, s37, s46
    s_cbranch_scc1 g2_o2_go
    s_waitcnt vmcnt(8)
g2_o2:
    v_cmp_ne_u32 vcc, 0, v13
    s_add_u32 s26, s26, 1
    s_lshr_b32 s37, vcc_lo, 1
    s_and_b32 s37, s37, vcc_lo
    s_cmp_ge_u32 s26, 0x8000
    s_cselect_b32 s37, s46, s37
    s_and_b32 s37, s37, s46
    s_cbranch_scc1 g2_o2_go
    buffer_load_dword v13, v12, s[16:19], 0 offen sc1
    s_waitcnt vmcnt(0)
    s_branch g2_o2
g2_o2_go:
    s_and_b32 s52, s37, s51
    s_andn2_b32 s51, s51, s37
    s_ff1_i32_b32 s37, s37
    s_bitset0_b32 s46, s37
    s_bitset0_b32 s52, s37
    s_lshl_b32 s47, s37, 11
    s_add_u32 s48, s38, s44
    s_bitcmp1_b32 s49, s37
    s_cselect_b32 s47, s47, s44
    s_cselect_b32 s10, 0, 2097152
    s_cselect_b32 s48, 131136, s48
    s_lshl_b32 s37, s37, 1
    s_add_u32 s37, s37, s33
    s_lshl_b32 s25, s37, 11
    s_lshl_b32 s24, s37, 16
    s_waitcnt lgkmcnt(0)
    v_mfma_f32_32x32x16_bf16 v[64:79], a[48:51], a[0:3], v[64:79]
    buffer_load_dword v0, v12, s[16:19], 0 offen sc1
    v_mfma_f32_32x32x16_bf16 v[96:111], a[48:51], a[4:7], v[96:111]
    buffer_load_dwordx4 v[16:19], v2, s[12:15], s25 offen offset:0
    v_mfma_f32_32x32x16_bf16 v[128:143], a[48:51], a[8:11], v[128:143]
    ds_read_b64_tr_b16 a[56:57], v11 offset:2048
    ds_read_b64_tr_b16 a[58:59], v11 offset:3072
    buffer_load_dwordx4 v[20:23], v3, s[12:15], s25 offen offset:0
    v_mfma_f32_32x32x16_bf16 v[160:175], a[48:51], a[12:15], v[160:175]
    ds_read_b64_tr_b16 a[60:61], v11 offset:2304
    ds_read_b64_tr_b16 a[62:63], v11 offset:3328
    buffer_load_dwordx4 v[24:27], v4, s[12:15], s25 offen offset:0
    v_mfma_f32_32x32x16_bf16 v[80:95], a[52:55], a[0:3], v[80:95]
    buffer_load_dwordx4 v[28:31], v5, s[12:15], s25 offen offset:0
    v_mfma_f32_32x32x16_bf16 v[112:127], a[52:55], a[4:7], v[112:127]
    buffer_load_dwordx4 v[32:35], v2, s[12:15], s25 offen offset:1024
    v_mfma_f32_32x32x16_bf16 v[144:159], a[52:55], a[8:11], v[144:159]
    buffer_load_dwordx4 v[36:39], v3, s[12:15], s25 offen offset:1024
    v_mfma_f32_32x32x16_bf16 v[176:191], a[52:55], a[12:15], v[176:191]
    buffer_load_dwordx4 v[40:43], v4, s[12:15], s25 offen offset:1024
    s_waitcnt lgkmcnt(0)
    v_mfma_f32_32x32x16_bf16 v[64:79], a[56:59], a[16:19], v[64:79]
    buffer_load_dwordx4 v[44:47], v5, s[12:15], s25 offen offset:1024
    v_mfma_f32_32x32x16_bf16 v[96:111], a[56:59], a[20:23], v[96:111]
    s_cmp_eq_u32 s10, 0
    s_cbranch_scc1 g2_d20
    s_add_u32 m0, s48, 0
    s_nop 0
    buffer_load_dwordx4 v6, s[8:11], s24 offen lds
    buffer_load_dwordx4 v7, s[8:11], s24 offen offset:1024 lds
    s_add_u32 s24, s24, 0x8000
g2_d20:
    v_mfma_f32_32x32x16_bf16 v[128:143], a[56:59], a[24:27], v[128:143]
    v_mfma_f32_32x32x16_bf16 v[160:175], a[56:59], a[28:31], v[160:175]
    s_cmp_eq_u32 s10, 0
    s_cbranch_scc1 g2_d21
    s_add_u32 m0, s48, 2048
    s_nop 0
    buffer_load_dwordx4 v6, s[8:11], s24 offen lds
    buffer_load_dwordx4 v7, s[8:11], s24 offen offset:1024 lds
    s_add_u32 s24, s24, 0x8000
g2_d21:
    v_mfma_f32_32x32x16_bf16 v[80:95], a[60:63], a[16:19], v[80:95]
    v_mfma_f32_32x32x16_bf16 v[112:127], a[60:63], a[20:23], v[112:127]
    v_mfma_f32_32x32x16_bf16 v[144:159], a[60:63], a[24:27], v[144:159]
    v_mfma_f32_32x32x16_bf16 v[176:191], a[60:63], a[28:31], v[176:191]
    v_add_u32 v11, s45, v8
    s_waitcnt vmcnt(13)
    s_cmp_lg_u32 s10, 0
    s_cbranch_scc1 g2_w3
    s_waitcnt vmcnt(9)
g2_w3:
    ds_read_b64_tr_b16 a[48:49], v11 offset:0
    ds_read_b64_tr_b16 a[50:51], v11 offset:1024
    ds_read_b64_tr_b16 a[52:53], v11 offset:256
    ds_read_b64_tr_b16 a[54:55], v11 offset:1280
    v_cmp_ne_u32 vcc, 0, v13
    s_nop 0
    s_lshr_b32 s37, vcc_lo, 1
    s_and_b32 s37, s37, vcc_lo
    s_and_b32 s37, s37, s46
    s_cbranch_scc1 g2_o3_go
    s_waitcnt vmcnt(8)
g2_o3:
    v_cmp_ne_u32 vcc, 0, v0
    s_add_u32 s26, s26, 1
    s_lshr_b32 s37, vcc_lo, 1
    s_and_b32 s37, s37, vcc_lo
    s_cmp_ge_u32 s26, 0x8000
    s_cselect_b32 s37, s46, s37
    s_and_b32 s37, s37, s46
    s_cbranch_scc1 g2_o3_go
    buffer_load_dword v0, v12, s[16:19], 0 offen sc1
    s_waitcnt vmcnt(0)
    s_branch g2_o3
g2_o3_go:
    s_and_b32 s52, s37, s51
    s_andn2_b32 s51, s51, s37
    s_ff1_i32_b32 s37, s37
    s_bitset0_b32 s46, s37
    s_bitset0_b32 s52, s37
    s_lshl_b32 s44, s37, 11
    s_add_u32 s48, s38, s45
    s_bitcmp1_b32 s49, s37
    s_cselect_b32 s44, s44, s45
    s_cselect_b32 s10, 0, 2097152
    s_cselect_b32 s48, 131136, s48
    s_lshl_b32 s37, s37, 1
    s_add_u32 s37, s37, s33
    s_lshl_b32 s25, s37, 11
    s_lshl_b32 s24, s37, 16
    s_waitcnt lgkmcnt(0)
    v_mfma_f32_32x32x16_bf16 v[64:79], a[48:51], a[32:35], v[64:79]
    buffer_load_dword v13, v12, s[16:19], 0 offen sc1
    v_mfma_f32_32x32x16_bf16 v[96:111], a[48:51], a[36:39], v[96:111]
    buffer_load_dwordx4 a[0:3], v2, s[12:15], s25 offen offset:0
    v_mfma_f32_32x32x16_bf16 v[128:143], a[48:51], a[40:43], v[128:143]
    ds_read_b64_tr_b16 a[56:57], v11 offset:2048
    ds_read_b64_tr_b16 a[58:59], v11 offset:3072
    buffer_load_dwordx4 a[4:7], v3, s[12:15], s25 offen offset:0
    v_mfma_f32_32x32x16_bf16 v[160:175], a[48:51], a[44:47], v[160:175]
    ds_read_b64_tr_b16 a[60:61], v11 offset:2304
    ds_read_b64_tr_b16 a[62:63], v11 offset:3328
    buffer_load_dwordx4 a[8:11], v4, s[12:15], s25 offen offset:0
    v_mfma_f32_32x32x16_bf16 v[80:95], a[52:55], a[32:35], v[80:95]
    buffer_load_dwordx4 a[12:15], v5, s[12:15], s25 offen offset:0
    v_mfma_f32_32x32x16_bf16 v[112:127], a[52:55], a[36:39], v[112:127]
    buffer_load_dwordx4 a[16:19], v2, s[12:15], s25 offen offset:1024
    v_mfma_f32_32x32x16_bf16 v[144:159], a[52:55], a[40:43], v[144:159]
    buffer_load_dwordx4 a[20:23], v3, s[12:15], s25 offen offset:1024
    v_mfma_f32_32x32x16_bf16 v[176:191], a[52:55], a[44:47], v[176:191]
    buffer_load_dwordx4 a[24:27], v4, s[12:15], s25 offen offset:1024
    s_waitcnt lgkmcnt(0)
    v_mfma_f32_32x32x16_bf16 v[64:79], a[56:59], v[48:51], v[64:79]
    buffer_load_dwordx4 a[28:31], v5, s[12:15], s25 offen offset:1024
    v_mfma_f32_32x32x16_bf16 v[96:111], a[56:59], v[52:55], v[96:111]
    s_cmp_eq_u32 s10, 0
    s_cbranch_scc1 g2_d30
    s_add_u32 m0, s48, 0
    s_nop 0
    buffer_load_dwordx4 v6, s[8:11], s24 offen lds
    buffer_load_dwordx4 v7, s[8:11], s24 offen offset:1024 lds
    s_add_u32 s24, s24, 0x8000
g2_d30:
    v_mfma_f32_32x32x16_bf16 v[128:143], a[56:59], v[56:59], v[128:143]
    v_mfma_f32_32x32x16_bf16 v[160:175], a[56:59], v[60:63], v[160:175]
    s_cmp_eq_u32 s10, 0
    s_cbranch_scc1 g2_d31
    s_add_u32 m0, s48, 2048
    s_nop 0
    buffer_load_dwordx4 v6, s[8:11], s24 offen lds
    buffer_load_dwordx4 v7, s[8:11], s24 offen offset:1024 lds
    s_add_u32 s24, s24, 0x8000
g2_d31:
    v_mfma_f32_32x32x16_bf16 v[80:95], a[60:63], v[48:51], v[80:95]
    v_mfma_f32_32x32x16_bf16 v[112:127], a[60:63], v[52:55], v[112:127]
    v_mfma_f32_32x32x16_bf16 v[144:159], a[60:63], v[56:59], v[144:159]
    v_mfma_f32_32x32x16_bf16 v[176:191], a[60:63], v[60:63], v[176:191]
    v_add_u32 v11, s47, v8
    s_waitcnt vmcnt(13)
    s_cmp_lg_u32 s10, 0
    s_cbranch_scc1 g2_w4
    s_waitcnt vmcnt(9)
g2_w4:
    ds_read_b64_tr_b16 a[48:49], v11 offset:0
    ds_read_b64_tr_b16 a[50:51], v11 offset:1024
    ds_read_b64_tr_b16 a[52:53], v11 offset:256
    ds_read_b64_tr_b16 a[54:55], v11 offset:1280
    v_cmp_ne_u32 vcc, 0, v0
    s_nop 0
    s_lshr_b32 s37, vcc_lo, 1
    s_and_b32 s37, s37, vcc_lo
    s_and_b32 s37, s37, s46
    s_cbranch_scc1 g2_o4_go
    s_waitcnt vmcnt(8)
g2_o4:
    v_cmp_ne_u32 vcc, 0, v13
    s_add_u32 s26, s26, 1
    s_lshr_b32 s37, vcc_lo, 1
    s_and_b32 s37, s37, vcc_lo
    s_cmp_ge_u32 s26, 0x8000
    s_cselect_b32 s37, s46, s37
    s_and_b32 s37, s37, s46
    s_cbranch_scc1 g2_o4_go
    buffer_load_dword v13, v12, s[16:19], 0 offen sc1
    s_waitcnt vmcnt(0)
    s_branch g2_o4
g2_o4_go:
    s_and_b32 s52, s37, s51
    s_andn2_b32 s51, s51, s37
    s_ff1_i32_b32 s37, s37
    s_bitset0_b32 s46, s37
    s_bitset0_b32 s52, s37
    s_lshl_b32 s45, s37, 11
    s_add_u32 s48, s38, s47
    s_bitcmp1_b32 s49, s37
    s_cselect_b32 s45, s45, s47
    s_cselect_b32 s10, 0, 2097152
    s_cselect_b32 s48, 131136, s48
    s_lshl_b32 s37, s37, 1
    s_add_u32 s37, s37, s33
    s_lshl_b32 s25, s37, 11
    s_lshl_b32 s24, s37, 16
    s_waitcnt lgkmcnt(0)
    v_mfma_f32_32x32x16_bf16 v[64:79], a[48:51], v[16:19], v[64:79]
    buffer_load_dword v0, v12, s[16:19], 0 offen sc1
    v_mfma_f32_32x32x16_bf16 v[96:111], a[48:51], v[20:23], v[96:111]
    buffer_load_dwordx4 a[32:35], v2, s[12:15], s25 offen offset:0
    v_mfma_f32_32x32x16_bf16 v[128:143], a[48:51], v[24:27], v[128:143]
    ds_read_b64_tr_b16 a[56:57], v11 offset:2048
    ds_read_b64_tr_b16 a[58:59], v11 offset:3072
    buffer_load_dwordx4 a[36:39], v3, s[12:15], s25 offen offset:0
    v_mfma_f32_32x32x16_bf16 v[160:175], a[48:51], v[28:31], v[160:175]
    ds_read_b64_tr_b16 a[60:61], v11 offset:2304
    ds_read_b64_tr_b16 a[62:63], v11 offset:3328
    buffer_load_dwordx4 a[40:43], v4, s[12:15], s25 offen offset:0
    v_mfma_f32_32x32x16_bf16 v[80:95], a[52:55], v[16:19], v[80:95]
    buffer_load_dwordx4 a[44:47], v5, s[12:15], s25 offen offset:0
    v_mfma_f32_32x32x16_bf16 v[112:127], a[52:55], v[20:23], v[112:127]
    buffer_load_dwordx4 v[48:51], v2, s[12:15], s25 offen offset:1024
    v_mfma_f32_32x32x16_bf16 v[144:159], a[52:55], v[24:27], v[144:159]
    buffer_load_dwordx4 v[52:55], v3, s[12:15], s25 offen offset:1024
    v_mfma_f32_32x32x16_bf16 v[176:191], a[52:55], v[28:31], v[176:191]
    buffer_load_dwordx4 v[56:59], v4, s[12:15], s25 offen offset:1024
    s_waitcnt lgkmcnt(0)
    v_mfma_f32_32x32x16_bf16 v[64:79], a[56:59], v[32:35], v[64:79]
    buffer_load_dwordx4 v[60:63], v5, s[12:15], s25 offen offset:1024
    v_mfma_f32_32x32x16_bf16 v[96:111], a[56:59], v[36:39], v[96:111]
    s_cmp_eq_u32 s10, 0
    s_cbranch_scc1 g2_d40
    s_add_u32 m0, s48, 0
    s_nop 0
    buffer_load_dwordx4 v6, s[8:11], s24 offen lds
    buffer_load_dwordx4 v7, s[8:11], s24 offen offset:1024 lds
    s_add_u32 s24, s24, 0x8000
g2_d40:
    v_mfma_f32_32x32x16_bf16 v[128:143], a[56:59], v[40:43], v[128:143]
    v_mfma_f32_32x32x16_bf16 v[160:175], a[56:59], v[44:47], v[160:175]
    s_cmp_eq_u32 s10, 0
    s_cbranch_scc1 g2_d41
    s_add_u32 m0, s48, 2048
    s_nop 0
    buffer_load_dwordx4 v6, s[8:11], s24 offen lds
    buffer_load_dwordx4 v7, s[8:11], s24 offen offset:1024 lds
    s_add_u32 s24, s24, 0x8000
g2_d41:
    v_mfma_f32_32x32x16_bf16 v[80:95], a[60:63], v[32:35], v[80:95]
    v_mfma_f32_32x32x16_bf16 v[112:127], a[60:63], v[36:39], v[112:127]
    v_mfma_f32_32x32x16_bf16 v[144:159], a[60:63], v[40:43], v[144:159]
    v_mfma_f32_32x32x16_bf16 v[176:191], a[60:63], v[44:47], v[176:191]
    v_add_u32 v11, s44, v8
    s_waitcnt vmcnt(13)
    s_cmp_lg_u32 s10, 0
    s_cbranch_scc1 g2_w5
    s_waitcnt vmcnt(9)
g2_w5:
    ds_read_b64_tr_b16 a[48:49], v11 offset:0
    ds_read_b64_tr_b16 a[50:51], v11 offset:1024
    ds_read_b64_tr_b16 a[52:53], v11 offset:256
    ds_read_b64_tr_b16 a[54:55], v11 offset:1280
    v_cmp_ne_u32 vcc, 0, v13
    s_nop 0
    s_lshr_b32 s37, vcc_lo, 1
    s_and_b32 s37, s37, vcc_lo
    s_and_b32 s37, s37, s46
    s_cbranch_scc1 g2_o5_go
    s_waitcnt vmcnt(8)
g2_o5:
    v_cmp_ne_u32 vcc, 0, v0
    s_add_u32 s26, s26, 1
    s_lshr_b32 s37, vcc_lo, 1
    s_and_b32 s37, s37, vcc_lo
    s_cmp_ge_u32 s26, 0x8000
    s_cselect_b32 s37, s46, s37
    s_and_b32 s37, s37, s46
    s_cbranch_scc1 g2_o5_go
    buffer_load_dword v0, v12, s[16:19], 0 offen sc1
    s_waitcnt vmcnt(0)
    s_branch g2_o5
g2_o5_go:
    s_and_b32 s52, s37, s51
    s_andn2_b32 s51, s51, s37
    s_ff1_i32_b32 s37, s37
    s_bitset0_b32 s46, s37
    s_bitset0_b32 s52, s37
    s_lshl_b32 s47, s37, 11
    s_add_u32 s48, s38, s44
    s_bitcmp1_b32 s49, s37
    s_cselect_b32 s47, s47, s44
    s_cselect_b32 s10, 0, 2097152
    s_cselect_b32 s48, 131136, s48
    s_lshl_b32 s37, s37, 1
    s_add_u32 s37, s37, s33
    s_lshl_b32 s25, s37, 11
    s_lshl_b32 s24, s37, 16
    s_waitcnt lgkmcnt(0)
    v_mfma_f32_32x32x16_bf16 v[64:79], a[48:51], a[0:3], v[64:79]
    buffer_load_dword v13, v12, s[16:19], 0 offen sc1
    v_mfma_f32_32x32x16_bf16 v[96:111], a[48:51], a[4:7], v[96:111]
    buffer_load_dwordx4 v[16:19], v2, s[12:15], s25 offen offset:0
    v_mfma_f32_32x32x16_bf16 v[128:143], a[48:51], a[8:11], v[128:143]
    ds_read_b64_tr_b16 a[56:57], v11 offset:2048
    ds_read_b64_tr_b16 a[58:59], v11 offset:3072
    buffer_load_dwordx4 v[20:23], v3, s[12:15], s25 offen offset:0
    v_mfma_f32_32x32x16_bf16 v[160:175], a[48:51], a[12:15], v[160:175]
    ds_read_b64_tr_b16 a[60:61], v11 offset:2304
    ds_read_b64_tr_b16 a[62:63], v11 offset:3328
    buffer_load_dwordx4 v[24:27], v4, s[12:15], s25 offen offset:0
    v_mfma_f32_32x32x16_bf16 v[80:95], a[52:55], a[0:3], v[80:95]
    buffer_load_dwordx4 v[28:31], v5, s[12:15], s25 offen offset:0
    v_mfma_f32_32x32x16_bf16 v[112:127], a[52:55], a[4:7], v[112:127]
    buffer_load_dwordx4 v[32:35], v2, s[12:15], s25 offen offset:1024
    v_mfma_f32_32x32x16_bf16 v[144:159], a[52:55], a[8:11], v[144:159]
    buffer_load_dwordx4 v[36:39], v3, s[12:15], s25 offen offset:1024
    v_mfma_f32_32x32x16_bf16 v[176:191], a[52:55], a[12:15], v[176:191]
    buffer_load_dwordx4 v[40:43], v4, s[12:15], s25 offen offset:1024
    s_waitcnt lgkmcnt(0)
    v_mfma_f32_32x32x16_bf16 v[64:79], a[56:59], a[16:19], v[64:79]
    buffer_load_dwordx4 v[44:47], v5, s[12:15], s25 offen offset:1024
    v_mfma_f32_32x32x16_bf16 v[96:111], a[56:59], a[20:23], v[96:111]
    s_cmp_eq_u32 s10, 0
    s_cbranch_scc1 g2_d50
    s_add_u32 m0, s48, 0
    s_nop 0
    buffer_load_dwordx4 v6, s[8:11], s24 offen lds
    buffer_load_dwordx4 v7, s[8:11], s24 offen offset:1024 lds
    s_add_u32 s24, s24, 0x8000
g2_d50:
    v_mfma_f32_32x32x16_bf16 v[128:143], a[56:59], a[24:27], v[128:143]
    v_mfma_f32_32x32x16_bf16 v[160:175], a[56:59], a[28:31], v[160:175]
    s_cmp_eq_u32 s10, 0
    s_cbranch_scc1 g2_d51
    s_add_u32 m0, s48, 2048
    s_nop 0
    buffer_load_dwordx4 v6, s[8:11], s24 offen lds
    buffer_load_dwordx4 v7, s[8:11], s24 offen offset:1024 lds
    s_add_u32 s24, s24, 0x8000
g2_d51:
    v_mfma_f32_32x32x16_bf16 v[80:95], a[60:63], a[16:19], v[80:95]
    v_mfma_f32_32x32x16_bf16 v[112:127], a[60:63], a[20:23], v[112:127]
    v_mfma_f32_32x32x16_bf16 v[144:159], a[60:63], a[24:27], v[144:159]
    v_mfma_f32_32x32x16_bf16 v[176:191], a[60:63], a[28:31], v[176:191]
    v_add_u32 v11, s45, v8
    s_waitcnt vmcnt(13)
    s_cmp_lg_u32 s10, 0
    s_cbranch_scc1 g2_w6
    s_waitcnt vmcnt(9)
g2_w6:
    ds_read_b64_tr_b16 a[48:49], v11 offset:0
    ds_read_b64_tr_b16 a[50:51], v11 offset:1024
    ds_read_b64_tr_b16 a[52:53], v11 offset:256
    ds_read_b64_tr_b16 a[54:55], v11 offset:1280
    v_cmp_ne_u32 vcc, 0, v0
    s_nop 0
    s_lshr_b32 s37, vcc_lo, 1
    s_and_b32 s37, s37, vcc_lo
    s_and_b32 s37, s37, s46
    s_cbranch_scc1 g2_o6_go
    s_waitcnt vmcnt(8)
g2_o6:
    v_cmp_ne_u32 vcc, 0, v13
    s_add_u32 s26, s26, 1
    s_lshr_b32 s37, vcc_lo, 1
    s_and_b32 s37, s37, vcc_lo
    s_cmp_ge_u32 s26, 0x8000
    s_cselect_b32 s37, s46, s37
    s_and_b32 s37, s37, s46
    s_cbranch_scc1 g2_o6_go
    buffer_load_dword v13, v12, s[16:19], 0 offen sc1
    s_waitcnt vmcnt(0)
    s_branch g2_o6
g2_o6_go:
    s_and_b32 s52, s37, s51
    s_andn2_b32 s51, s51, s37
    s_ff1_i32_b32 s37, s37
    s_bitset0_b32 s46, s37
    s_bitset0_b32 s52, s37
    s_lshl_b32 s44, s37, 11
    s_add_u32 s48, s38, s45
    s_bitcmp1_b32 s49, s37
    s_cselect_b32 s44, s44, s45
    s_cselect_b32 s10, 0, 2097152
    s_cselect_b32 s48, 131136, s48
    s_lshl_b32 s37, s37, 1
    s_add_u32 s37, s37, s33
    s_lshl_b32 s25, s37, 11
    s_lshl_b32 s24, s37, 16
    s_waitcnt lgkmcnt(0)
    v_mfma_f32_32x32x16_bf16 v[64:79], a[48:51], a[32:35], v[64:79]
    buffer_load_dword v0, v12, s[16:19], 0 offen sc1
    v_mfma_f32_32x32x16_bf16 v[96:111], a[48:51], a[36:39], v[96:111]
    buffer_load_dwordx4 a[0:3], v2, s[12:15], s25 offen offset:0
    v_mfma_f32_32x32x16_bf16 v[128:143], a[48:51], a[40:43], v[128:143]
    ds_read_b64_tr_b16 a[56:57], v11 offset:2048
    ds_read_b64_tr_b16 a[58:59], v11 offset:3072
    buffer_load_dwordx4 a[4:7], v3, s[12:15], s25 offen offset:0
    v_mfma_f32_32x32x16_bf16 v[160:175], a[48:51], a[44:47], v[160:175]
    ds_read_b64_tr_b16 a[60:61], v11 offset:2304
    ds_read_b64_tr_b16 a[62:63], v11 offset:3328
    buffer_load_dwordx4 a[8:11], v4, s[12:15], s25 offen offset:0
    v_mfma_f32_32x32x16_bf16 v[80:95], a[52:55], a[32:35], v[80:95]
    buffer_load_dwordx4 a[12:15], v5, s[12:15], s25 offen offset:0
    v_mfma_f32_32x32x16_bf16 v[112:127], a[52:55], a[36:39], v[112:127]
    buffer_load_dwordx4 a[16:19], v2, s[12:15], s25 offen offset:1024
    v_mfma_f32_32x32x16_bf16 v[144:159], a[52:55], a[40:43], v[144:159]
    buffer_load_dwordx4 a[20:23], v3, s[12:15], s25 offen offset:1024
    v_mfma_f32_32x32x16_bf16 v[176:191], a[52:55], a[44:47], v[176:191]
    buffer_load_dwordx4 a[24:27], v4, s[12:15], s25 offen offset:1024
    s_waitcnt lgkmcnt(0)
    v_mfma_f32_32x32x16_bf16 v[64:79], a[56:59], v[48:51], v[64:79]
    buffer_load_dwordx4 a[28:31], v5, s[12:15], s25 offen offset:1024
    v_mfma_f32_32x32x16_bf16 v[96:111], a[56:59], v[52:55], v[96:111]
    s_cmp_eq_u32 s10, 0
    s_cbranch_scc1 g2_d60
    s_add_u32 m0, s48, 0
    s_nop 0
    buffer_load_dwordx4 v6, s[8:11], s24 offen lds
    buffer_load_dwordx4 v7, s[8:11], s24 offen offset:1024 lds
    s_add_u32 s24, s24, 0x8000
g2_d60:
    v_mfma_f32_32x32x16_bf16 v[128:143], a[56:59], v[56:59], v[128:143]
    v_mfma_f32_32x32x16_bf16 v[160:175], a[56:59], v[60:63], v[160:175]
    s_cmp_eq_u32 s10, 0
    s_cbranch_scc1 g2_d61
    s_add_u32 m0, s48, 2048
    s_nop 0
    buffer_load_dwordx4 v6, s[8:11], s24 offen lds
    buffer_load_dwordx4 v7, s[8:11], s24 offen offset:1024 lds
    s_add_u32 s24, s24, 0x8000
g2_d61:
    v_mfma_f32_32x32x16_bf16 v[80:95], a[60:63], v[48:51], v[80:95]
    v_mfma_f32_32x32x16_bf16 v[112:127], a[60:63], v[52:55], v[112:127]
    v_mfma_f32_32x32x16_bf16 v[144:159], a[60:63], v[56:59], v[144:159]
    v_mfma_f32_32x32x16_bf16 v[176:191], a[60:63], v[60:63], v[176:191]
    v_add_u32 v11, s47, v8
    s_waitcnt vmcnt(13)
    s_cmp_lg_u32 s10, 0
    s_cbranch_scc1 g2_w7
    s_waitcnt vmcnt(9)
g2_w7:
    ds_read_b64_tr_b16 a[48:49], v11 offset:0
    ds_read_b64_tr_b16 a[50:51], v11 offset:1024
    ds_read_b64_tr_b16 a[52:53], v11 offset:256
    ds_read_b64_tr_b16 a[54:55], v11 offset:1280
    v_cmp_ne_u32 vcc, 0, v13
    s_nop 0
    s_lshr_b32 s37, vcc_lo, 1
    s_and_b32 s37, s37, vcc_lo
    s_and_b32 s37, s37, s46
    s_cbranch_scc1 g2_o7_go
    s_waitcnt vmcnt(8)
g2_o7:
    v_cmp_ne_u32 vcc, 0, v0
    s_add_u32 s26, s26, 1
    s_lshr_b32 s37, vcc_lo, 1
    s_and_b32 s37, s37, vcc_lo
    s_cmp_ge_u32 s26, 0x8000
    s_cselect_b32 s37, s46, s37
    s_and_b32 s37, s37, s46
    s_cbranch_scc1 g2_o7_go
    buffer_load_dword v0, v12, s[16:19], 0 offen sc1
    s_waitcnt vmcnt(0)
    s_branch g2_o7
g2_o7_go:
    s_and_b32 s52, s37, s51
    s_andn2_b32 s51, s51, s37
    s_ff1_i32_b32 s37, s37
    s_bitset0_b32 s46, s37
    s_bitset0_b32 s52, s37
    s_lshl_b32 s45, s37, 11
    s_add_u32 s48, s38, s47
    s_bitcmp1_b32 s49, s37
    s_cselect_b32 s45, s45, s47
    s_cselect_b32 s10, 0, 2097152
    s_cselect_b32 s48, 131136, s48
    s_lshl_b32 s37, s37, 1
    s_add_u32 s37, s37, s33
    s_lshl_b32 s25, s37, 11
    s_lshl_b32 s24, s37, 16
    s_waitcnt lgkmcnt(0)
    v_mfma_f32_32x32x16_bf16 v[64:79], a[48:51], v[16:19], v[64:79]
    v_mfma_f32_32x32x16_bf16 v[96:111], a[48:51], v[20:23], v[96:111]
    buffer_load_dwordx4 a[32:35], v2, s[12:15], s25 offen offset:0
    v_mfma_f32_32x32x16_bf16 v[128:143], a[48:51], v[24:27], v[128:143]
    ds_read_b64_tr_b16 a[56:57], v11 offset:2048
    ds_read_b64_tr_b16 a[58:59], v11 offset:3072
    buffer_load_dwordx4 a[36:39], v3, s[12:15], s25 offen offset:0
    v_mfma_f32_32x32x16_bf16 v[160:175], a[48:51], v[28:31], v[160:175]
    ds_read_b64_tr_b16 a[60:61], v11 offset:2304
    ds_read_b64_tr_b16 a[62:63], v11 offset:3328
    buffer_load_dwordx4 a[40:43], v4, s[12:15], s25 offen offset:0
    v_mfma_f32_32x32x16_bf16 v[80:95], a[52:55], v[16:19], v[80:95]
    buffer_load_dwordx4 a[44:47], v5, s[12:15], s25 offen offset:0
    v_mfma_f32_32x32x16_bf16 v[112:127], a[52:55], v[20:23], v[112:127]
    buffer_load_dwordx4 v[48:51], v2, s[12:15], s25 offen offset:1024
    v_mfma_f32_32x32x16_bf16 v[144:159], a[52:55], v[24:27], v[144:159]
    buffer_load_dwordx4 v[52:55], v3, s[12:15], s25 offen offset:1024
    v_mfma_f32_32x32x16_bf16 v[176:191], a[52:55], v[28:31], v[176:191]
    buffer_load_dwordx4 v[56:59], v4, s[12:15], s25 offen offset:1024
    s_waitcnt lgkmcnt(0)
    v_mfma_f32_32x32x16_bf16 v[64:79], a[56:59], v[32:35], v[64:79]
    buffer_load_dwordx4 v[60:63], v5, s[12:15], s25 offen offset:1024
    v_mfma_f32_32x32x16_bf16 v[96:111], a[56:59], v[36:39], v[96:111]
    s_cmp_eq_u32 s10, 0
    s_cbranch_scc1 g2_d70
    s_add_u32 m0, s48, 0
    s_nop 0
    buffer_load_dwordx4 v6, s[8:11], s24 offen lds
    buffer_load_dwordx4 v7, s[8:11], s24 offen offset:1024 lds
    s_add_u32 s24, s24, 0x8000
g2_d70:
    v_mfma_f32_32x32x16_bf16 v[128:143], a[56:59], v[40:43], v[128:143]
    v_mfma_f32_32x32x16_bf16 v[160:175], a[56:59], v[44:47], v[160:175]
    s_cmp_eq_u32 s10, 0
    s_cbranch_scc1 g2_d71
    s_add_u32 m0, s48, 2048
    s_nop 0
    buffer_load_dwordx4 v6, s[8:11], s24 offen lds
    buffer_load_dwordx4 v7, s[8:11], s24 offen offset:1024 lds
    s_add_u32 s24, s24, 0x8000
g2_d71:
    v_mfma_f32_32x32x16_bf16 v[80:95], a[60:63], v[32:35], v[80:95]
    v_mfma_f32_32x32x16_bf16 v[112:127], a[60:63], v[36:39], v[112:127]
    v_mfma_f32_32x32x16_bf16 v[144:159], a[60:63], v[40:43], v[144:159]
    v_mfma_f32_32x32x16_bf16 v[176:191], a[60:63], v[44:47], v[176:191]
    v_add_u32 v11, s44, v8
    s_waitcnt vmcnt(12)
    s_cmp_lg_u32 s10, 0
    s_cbranch_scc1 g2_w8
    s_waitcnt vmcnt(8)
g2_w8:
    ds_read_b64_tr_b16 a[48:49], v11 offset:0
    ds_read_b64_tr_b16 a[50:51], v11 offset:1024
    ds_read_b64_tr_b16 a[52:53], v11 offset:256
    ds_read_b64_tr_b16 a[54:55], v11 offset:1280
    s_waitcnt lgkmcnt(0)
    v_mfma_f32_32x32x16_bf16 v[64:79], a[48:51], a[0:3], v[64:79]
    v_mfma_f32_32x32x16_bf16 v[96:111], a[48:51], a[4:7], v[96:111]
    v_mfma_f32_32x32x16_bf16 v[128:143], a[48:51], a[8:11], v[128:143]
    ds_read_b64_tr_b16 a[56:57], v11 offset:2048
    ds_read_b64_tr_b16 a[58:59], v11 offset:3072
    v_mfma_f32_32x32x16_bf16 v[160:175], a[48:51], a[12:15], v[160:175]
    ds_read_b64_tr_b16 a[60:61], v11 offset:2304
    ds_read_b64_tr_b16 a[62:63], v11 offset:3328
    v_mfma_f32_32x32x16_bf16 v[80:95], a[52:55], a[0:3], v[80:95]
    v_mfma_f32_32x32x16_bf16 v[112:127], a[52:55], a[4:7], v[112:127]
    v_mfma_f32_32x32x16_bf16 v[144:159], a[52:55], a[8:11], v[144:159]
    v_mfma_f32_32x32x16_bf16 v[176:191], a[52:55], a[12:15], v[176:191]
    s_waitcnt lgkmcnt(0)
    v_mfma_f32_32x32x16_bf16 v[64:79], a[56:59], a[16:19], v[64:79]
    v_mfma_f32_32x32x16_bf16 v[96:111], a[56:59], a[20:23], v[96:111]
    v_mfma_f32_32x32x16_bf16 v[128:143], a[56:59], a[24:27], v[128:143]
    v_mfma_f32_32x32x16_bf16 v[160:175], a[56:59], a[28:31], v[160:175]
    v_mfma_f32_32x32x16_bf16 v[80:95], a[60:63], a[16:19], v[80:95]
    v_mfma_f32_32x32x16_bf16 v[112:127], a[60:63], a[20:23], v[112:127]
    v_mfma_f32_32x32x16_bf16 v[144:159], a[60:63], a[24:27], v[144:159]
    v_mfma_f32_32x32x16_bf16 v[176:191], a[60:63], a[28:31], v[176:191]
    v_add_u32 v11, s45, v8
    s_waitcnt vmcnt(0)
    ds_read_b64_tr_b16 a[48:49], v11 offset:0
    ds_read_b64_tr_b16 a[50:51], v11 offset:1024
    ds_read_b64_tr_b16 a[52:53], v11 offset:256
    ds_read_b64_tr_b16 a[54:55], v11 offset:1280
    s_waitcnt lgkmcnt(0)
    v_mfma_f32_32x32x16_bf16 v[64:79], a[48:51], a[32:35], v[64:79]
    v_mfma_f32_32x32x16_bf16 v[96:111], a[48:51], a[36:39], v[96:111]
    v_mfma_f32_32x32x16_bf16 v[128:143], a[48:51], a[40:43], v[128:143]
    ds_read_b64_tr_b16 a[56:57], v11 offset:2048
    ds_read_b64_tr_b16 a[58:59], v11 offset:3072
    v_mfma_f32_32x32x16_bf16 v[160:175], a[48:51], a[44:47], v[160:175]
    ds_read_b64_tr_b16 a[60:61], v11 offset:2304
    ds_read_b64_tr_b16 a[62:63], v11 offset:3328
    v_mfma_f32_32x32x16_bf16 v[80:95], a[52:55], a[32:35], v[80:95]
    v_mfma_f32_32x32x16_bf16 v[112:127], a[52:55], a[36:39], v[112:127]
    v_mfma_f32_32x32x16_bf16 v[144:159], a[52:55], a[40:43], v[144:159]
    v_mfma_f32_32x32x16_bf16 v[176:191], a[52:55], a[44:47], v[176:191]
    s_waitcnt lgkmcnt(0)
    v_mfma_f32_32x32x16_bf16 v[64:79], a[56:59], v[48:51], v[64:79]
    v_mfma_f32_32x32x16_bf16 v[96:111], a[56:59], v[52:55], v[96:111]
    v_mfma_f32_32x32x16_bf16 v[128:143], a[56:59], v[56:59], v[128:143]
    v_mfma_f32_32x32x16_bf16 v[160:175], a[56:59], v[60:63], v[160:175]
    v_mfma_f32_32x32x16_bf16 v[80:95], a[60:63], v[48:51], v[80:95]
    v_mfma_f32_32x32x16_bf16 v[112:127], a[60:63], v[52:55], v[112:127]
    v_mfma_f32_32x32x16_bf16 v[144:159], a[60:63], v[56:59], v[144:159]
    v_mfma_f32_32x32x16_bf16 v[176:191], a[60:63], v[60:63], v[176:191]
    s_mov_b32 s8, s42
    s_mov_b32 s9, s43
    s_mov_b32 s10, 0x400000
    s_mov_b32 s11, 0x20000
    v_add_u32 v2, s38, v9
    s_lshl_b32 s37, s33, 13
    v_add_u32 v6, s37, v9
    v_mov_b32 v7, 131072
g2_free:
    ds_read_b32 v8, v7 offset:4
    s_waitcnt lgkmcnt(0)
    v_readfirstlane_b32 s37, v8
    s_cmp_ge_u32 s37, 32
    s_cbranch_scc0 g2_free
    s_sub_u32 s37, s33, 1
    s_and_b32 s37, s37, 3
    s_mul_i32 s37, s37, 16384
    s_add_u32 s37, s37, 65536
    v_add_u32 v3, s37, v9
    s_sub_u32 s37, s33, 2
    s_and_b32 s37, s37, 3
    s_mul_i32 s37, s37, 16384
    s_add_u32 s37, s37, 73728
    v_add_u32 v4, s37, v9
    s_sub_u32 s37, s33, 3
    s_and_b32 s37, s37, 3
    s_mul_i32 s37, s37, 8192
    s_add_u32 s37, s37, 0
    v_add_u32 v5, s37, v9
    ds_write_b128 v2, v[96:99] offset:0
    ds_write_b128 v2, v[100:103] offset:1024
    ds_write_b128 v2, v[104:107] offset:2048
    ds_write_b128 v2, v[108:111] offset:3072
    ds_write_b128 v2, v[128:131] offset:8192
    ds_write_b128 v2, v[132:135] offset:9216
    ds_write_b128 v2, v[136:139] offset:10240
    ds_write_b128 v2, v[140:143] offset:11264
    ds_write_b128 v6, v[160:163] offset:0
    ds_write_b128 v6, v[164:167] offset:1024
    ds_write_b128 v6, v[168:171] offset:2048
    ds_write_b128 v6, v[172:175] offset:3072
    s_nop 7
    ds_write_b128 v2, v[112:115] offset:4096
    ds_write_b128 v2, v[116:119] offset:5120
    ds_write_b128 v2, v[120:123] offset:6144
    ds_write_b128 v2, v[124:127] offset:7168
    ds_write_b128 v2, v[144:147] offset:12288
    ds_write_b128 v2, v[148:151] offset:13312
    ds_write_b128 v2, v[152:155] offset:14336
    ds_write_b128 v2, v[156:159] offset:15360
    ds_write_b128 v6, v[176:179] offset:4096
    ds_write_b128 v6, v[180:183] offset:5120
    ds_write_b128 v6, v[184:187] offset:6144
    ds_write_b128 v6, v[188:191] offset:7168
    s_waitcnt lgkmcnt(0)
    s_barrier
    ds_read_b128 v[96:99], v3 offset:0
    ds_read_b128 v[100:103], v3 offset:1024
    ds_read_b128 v[104:107], v3 offset:2048
    ds_read_b128 v[108:111], v3 offset:3072
    ds_read_b128 v[112:115], v3 offset:4096
    ds_read_b128 v[116:119], v3 offset:5120
    ds_read_b128 v[120:123], v3 offset:6144
    ds_read_b128 v[124:127], v3 offset:7168
    ds_read_b128 v[128:131], v4 offset:0
    ds_read_b128 v[132:135], v4 offset:1024
    ds_read_b128 v[136:139], v4 offset:2048
    ds_read_b128 v[140:143], v4 offset:3072
    ds_read_b128 v[144:147], v4 offset:4096
    ds_read_b128 v[148:151], v4 offset:5120
    ds_read_b128 v[152:155], v4 offset:6144
    ds_read_b128 v[156:159], v4 offset:7168
    ds_read_b128 v[160:163], v5 offset:0
    ds_read_b128 v[164:167], v5 offset:1024
    ds_read_b128 v[168:171], v5 offset:2048
    ds_read_b128 v[172:175], v5 offset:3072
    ds_read_b128 v[176:179], v5 offset:4096
    ds_read_b128 v[180:183], v5 offset:5120
    ds_read_b128 v[184:187], v5 offset:6144
    ds_read_b128 v[188:191], v5 offset:7168
    s_waitcnt lgkmcnt(15)
    v_pk_add_f32 v[64:65], v[64:65], v[96:97]
    v_pk_add_f32 v[66:67], v[66:67], v[98:99]
    v_pk_add_f32 v[68:69], v[68:69], v[100:101]
    v_pk_add_f32 v[70:71], v[70:71], v[102:103]
    v_pk_add_f32 v[72:73], v[72:73], v[104:105]
    v_pk_add_f32 v[74:75], v[74:75], v[106:107]
    v_pk_add_f32 v[76:77], v[76:77], v[108:109]
    v_pk_add_f32 v[78:79], v[78:79], v[110:111]
    v_pk_add_f32 v[80:81], v[80:81], v[112:113]
    v_pk_add_f32 v[82:83], v[82:83], v[114:115]
    v_pk_add_f32 v[84:85], v[84:85], v[116:117]
    v_pk_add_f32 v[86:87], v[86:87], v[118:119]
    v_pk_add_f32 v[88:89], v[88:89], v[120:121]
    v_pk_add_f32 v[90:91], v[90:91], v[122:123]
    v_pk_add_f32 v[92:93], v[92:93], v[124:125]
    v_pk_add_f32 v[94:95], v[94:95], v[126:127]
    s_waitcnt lgkmcnt(8)
    v_pk_add_f32 v[64:65], v[64:65], v[128:129]
    v_pk_add_f32 v[66:67], v[66:67], v[130:131]
    v_pk_add_f32 v[68:69], v[68:69], v[132:133]
    v_pk_add_f32 v[70:71], v[70:71], v[134:135]
    v_pk_add_f32 v[72:73], v[72:73], v[136:137]
    v_pk_add_f32 v[74:75], v[74:75], v[138:139]
    v_pk_add_f32 v[76:77], v[76:77], v[140:141]
    v_pk_add_f32 v[78:79], v[78:79], v[142:143]
    v_pk_add_f32 v[80:81], v[80:81], v[144:145]
    v_pk_add_f32 v[82:83], v[82:83], v[146:147]
    v_pk_add_f32 v[84:85], v[84:85], v[148:149]
    v_pk_add_f32 v[86:87], v[86:87], v[150:151]
    v_pk_add_f32 v[88:89], v[88:89], v[152:153]
    v_pk_add_f32 v[90:91], v[90:91], v[154:155]
    v_pk_add_f32 v[92:93], v[92:93], v[156:157]
    v_pk_add_f32 v[94:95], v[94:95], v[158:159]
    s_waitcnt lgkmcnt(0)
    v_pk_add_f32 v[64:65], v[64:65], v[160:161]
    v_pk_add_f32 v[66:67], v[66:67], v[162:163]
    v_pk_add_f32 v[68:69], v[68:69], v[164:165]
    v_pk_add_f32 v[70:71], v[70:71], v[166:167]
    v_pk_add_f32 v[72:73], v[72:73], v[168:169]
    v_pk_add_f32 v[74:75], v[74:75], v[170:171]
    v_pk_add_f32 v[76:77], v[76:77], v[172:173]
    v_pk_add_f32 v[78:79], v[78:79], v[174:175]
    v_pk_add_f32 v[80:81], v[80:81], v[176:177]
    v_pk_add_f32 v[82:83], v[82:83], v[178:179]
    v_pk_add_f32 v[84:85], v[84:85], v[180:181]
    v_pk_add_f32 v[86:87], v[86:87], v[182:183]
    v_pk_add_f32 v[88:89], v[88:89], v[184:185]
    v_pk_add_f32 v[90:91], v[90:91], v[186:187]
    v_pk_add_f32 v[92:93], v[92:93], v[188:189]
    v_pk_add_f32 v[94:95], v[94:95], v[190:191]
    v_cvt_pk_bf16_f32 v16, v64, v65
    v_cvt_pk_bf16_f32 v17, v66, v67
    v_cvt_pk_bf16_f32 v18, v68, v69
    v_cvt_pk_bf16_f32 v19, v70, v71
    v_cvt_pk_bf16_f32 v20, v72, v73
    v_cvt_pk_bf16_f32 v21, v74, v75
    v_cvt_pk_bf16_f32 v22, v76, v77
    v_cvt_pk_bf16_f32 v23, v78, v79
    v_cvt_pk_bf16_f32 v24, v80, v81
    v_cvt_pk_bf16_f32 v25, v82, v83
    v_cvt_pk_bf16_f32 v26, v84, v85
    v_cvt_pk_bf16_f32 v27, v86, v87
    v_cvt_pk_bf16_f32 v28, v88, v89
    v_cvt_pk_bf16_f32 v29, v90, v91
    v_cvt_pk_bf16_f32 v30, v92, v93
    v_cvt_pk_bf16_f32 v31, v94, v95
    s_nop 1
    v_permlane32_swap_b32 v16, v18
    v_permlane32_swap_b32 v17, v19
    v_permlane32_swap_b32 v20, v22
    v_permlane32_swap_b32 v21, v23
    v_permlane32_swap_b32 v24, v26
    v_permlane32_swap_b32 v25, v27
    v_permlane32_swap_b32 v28, v30
    v_permlane32_swap_b32 v29, v31
    s_nop 1
    buffer_store_dwordx4 v[16:19], v10, s[8:11], 0 offen offset:0
    buffer_store_dwordx4 v[20:23], v10, s[8:11], 0 offen offset:32
    buffer_store_dwordx4 v[24:27], v10, s[8:11], 0 offen offset:64
    buffer_store_dwordx4 v[28:31], v10, s[8:11], 0 offen offset:96
    s_endpgm
f_attn:
    s_load_dwordx2 s[28:29], s[0:1], 80
    s_and_b32 s3, s2, 7
    s_lshr_b32 s31, s2, 3
    s_lshr_b32 s30, s31, 3
    s_lshl_b32 s3, s3, 2
    s_add_u32 s30, s30, s3
    s_and_b32 s31, s31, 7
    s_waitcnt lgkmcnt(0)
    s_lshl_b32 s36, s31, 3
    s_lshl_b32 s37, s33, 1
    s_add_u32 s36, s36, s37
    s_lshl_b32 s37, s30, 17
    s_lshl_b32 s38, s36, 11
    s_add_u32 s37, s37, s38
    s_add_u32 s37, s37, 0x800000
    s_add_u32 s8, s28, s37
    s_addc_u32 s9, s29, 0
    s_mov_b32 s10, 4096
    s_mov_b32 s11, 0x20000
    s_lshl_b32 s37, s30, 18
    s_add_u32 s37, s37, 0xc00000
    s_add_u32 s12, s28, s37
    s_addc_u32 s13, s29, 0
    s_mov_b32 s14, 0x40000
    s_mov_b32 s15, 0x20000
    v_lshlrev_b32 v2, 4, v1
    buffer_load_dwordx4 v[16:19], v2, s[8:11], 0 offen offset:0
    buffer_load_dwordx4 v[20:23], v2, s[8:11], 0 offen offset:1024
    buffer_load_dwordx4 v[24:27], v2, s[8:11], 0 offen offset:2048
    buffer_load_dwordx4 v[28:31], v2, s[8:11], 0 offen offset:3072
    buffer_load_dwordx4 v[152:155], v2, s[12:15], 0 offen offset:0
    buffer_load_dwordx4 v[156:159], v2, s[12:15], 0 offen offset:1024
    s_lshl_b32 s38, s33, 13
    s_add_u32 s24, s38, 2048
    s_add_u32 s25, s38, 0
    s_add_u32 m0, s25, 0
    s_add_u32 s39, s24, 0
    buffer_load_dwordx4 v2, s[12:15], s39 offen offset:0 lds
    buffer_load_dwordx4 v2, s[12:15], s39 offen offset:1024 lds
    buffer_load_dwordx4 v2, s[12:15], s39 offen offset:2048 lds
    buffer_load_dwordx4 v2, s[12:15], s39 offen offset:3072 lds
    s_add_u32 m0, s25, 4096
    s_add_u32 s39, s24, 4096
    buffer_load_dwordx4 v2, s[12:15], s39 offen offset:0 lds
    buffer_load_dwordx4 v2, s[12:15], s39 offen offset:1024 lds
    buffer_load_dwordx4 v2, s[12:15], s39 offen offset:2048 lds
    buffer_load_dwordx4 v2, s[12:15], s39 offen offset:3072 lds
    s_add_u32 s24, s24, 0x8000
    s_xor_b32 s25, s25, 0x8000
    v_mov_b32 v8, 131072
    v_mov_b32 v10, 1
    v_mov_b32 v4, 0
    v_mov_b32 v5, 0
    ds_write_b64 v8, v[4:5]
    s_mov_b32 s42, 4
    s_mov_b32 s43, 0
    s_waitcnt lgkmcnt(0)
    s_barrier
    v_and_b32 v4, 3, v1
    v_bfe_u32 v5, v1, 2, 1
    v_bfe_u32 v6, v1, 4, 1
    v_xor_b32 v5, v5, v6
    v_or_b32 v4, v4, v5
    v_cmp_eq_u32 vcc, 0, v4
    v_mov_b32 v5, 0x3f803f80
    s_nop 0
    v_cndmask_b32 v184, 0, v5, vcc
    v_mov_b32 v185, v184
    v_mov_b32 v186, v184
    v_mov_b32 v187, v184
    v_mov_b32 v112, 0
    v_mov_b32 v113, 0
    v_mov_b32 v114, 0
    v_mov_b32 v115, 0
    v_mov_b32 v116, 0
    v_mov_b32 v117, 0
    v_mov_b32 v118, 0
    v_mov_b32 v119, 0
    v_mov_b32 v120, 0
    v_mov_b32 v121, 0
    v_mov_b32 v122, 0
    v_mov_b32 v123, 0
    v_mov_b32 v124, 0
    v_mov_b32 v125, 0
    v_mov_b32 v126, 0
    v_mov_b32 v127, 0
    v_mov_b32 v144, 0
    v_mov_b32 v145, 0
    v_mov_b32 v146, 0
    v_mov_b32 v147, 0
    v_mov_b32 v128, 0
    v_mov_b32 v129, 0
    v_mov_b32 v130, 0
    v_mov_b32 v131, 0
    v_mov_b32 v132, 0
    v_mov_b32 v133, 0
    v_mov_b32 v134, 0
    v_mov_b32 v135, 0
    v_mov_b32 v136, 0
    v_mov_b32 v137, 0
    v_mov_b32 v138, 0
    v_mov_b32 v139, 0
    v_mov_b32 v140, 0
    v_mov_b32 v141, 0
    v_mov_b32 v142, 0
    v_mov_b32 v143, 0
    v_mov_b32 v148, 0
    v_mov_b32 v149, 0
    v_mov_b32 v150, 0
    v_mov_b32 v151, 0
    v_mov_b32 v104, 0
    v_mov_b32 v176, 0
    v_mov_b32 v105, 0
    v_mov_b32 v177, 0
    v_mov_b32 v106, 0
    v_mov_b32 v178, 0
    v_mov_b32 v107, 0
    v_mov_b32 v179, 0
    v_mov_b32 v108, 0
    v_mov_b32 v180, 0
    v_mov_b32 v109, 0
    v_mov_b32 v181, 0
    v_mov_b32 v110, 0
    v_mov_b32 v182, 0
    v_mov_b32 v111, 0
    v_mov_b32 v183, 0
    v_mov_b32 v3, v2
    s_waitcnt vmcnt(8)
    v_mfma_f32_32x32x16_bf16 v[64:79], v[152:155], v[16:19], 0
    v_mfma_f32_32x32x16_bf16 v[64:79], v[156:159], v[20:23], v[64:79]
    v_mfma_f32_32x32x16_bf16 v[80:95], v[152:155], v[24:27], 0
    v_mfma_f32_32x32x16_bf16 v[80:95], v[156:159], v[28:31], v[80:95]
    s_nop 11
    v_max3_f32 v4, v64, v65, v66
    v_max3_f32 v4, v4, v67, v68
    v_max3_f32 v4, v4, v69, v70
    v_max3_f32 v4, v4, v71, v72
    v_max3_f32 v4, v4, v73, v74
    v_max3_f32 v4, v4, v75, v76
    v_max3_f32 v4, v4, v77, v78
    v_max_f32 v4, v4, v79
    v_max3_f32 v5, v80, v81, v82
    v_max3_f32 v5, v5, v83, v84
    v_max3_f32 v5, v5, v85, v86
    v_max3_f32 v5, v5, v87, v88
    v_max3_f32 v5, v5, v89, v90
    v_max3_f32 v5, v5, v91, v92
    v_max3_f32 v5, v5, v93, v94
    v_max_f32 v5, v5, v95
    v_mov_b32 v6, v4
    s_nop 1
    v_permlane32_swap_b32 v6, v4
    s_nop 1
    v_max_f32 v4, v4, v6
    v_sub_f32 v4, 0, v4
    v_mov_b32 v32, v4
    v_mov_b32 v33, v4
    v_mov_b32 v34, v4
    v_mov_b32 v35, v4
    v_mov_b32 v36, v4
    v_mov_b32 v37, v4
    v_mov_b32 v38, v4
    v_mov_b32 v39, v4
    v_mov_b32 v40, v4
    v_mov_b32 v41, v4
    v_mov_b32 v42, v4
    v_mov_b32 v43, v4
    v_mov_b32 v44, v4
    v_mov_b32 v45, v4
    v_mov_b32 v46, v4
    v_mov_b32 v47, v4
    v_mov_b32 v6, v5
    s_nop 1
    v_permlane32_swap_b32 v6, v5
    s_nop 1
    v_max_f32 v5, v5, v6
    v_sub_f32 v5, 0, v5
    v_mov_b32 v48, v5
    v_mov_b32 v49, v5
    v_mov_b32 v50, v5
    v_mov_b32 v51, v5
    v_mov_b32 v52, v5
    v_mov_b32 v53, v5
    v_mov_b32 v54, v5
    v_mov_b32 v55, v5
    v_mov_b32 v56, v5
    v_mov_b32 v57, v5
    v_mov_b32 v58, v5
    v_mov_b32 v59, v5
    v_mov_b32 v60, v5
    v_mov_b32 v61, v5
    v_mov_b32 v62, v5
    v_mov_b32 v63, v5
    s_waitcnt vmcnt(0)
    s_mov_b64 exec, 1
    ds_add_u32 v8, v10 offset:0
    s_mov_b64 exec, -1
    ds_read_b32 v9, v8 offset:0
    s_waitcnt lgkmcnt(0)
    v_readfirstlane_b32 s37, v9
    s_cmp_ge_u32 s37, s42
    s_cbranch_scc1 at_i_ok
at_i_spin:
    ds_read_b32 v9, v8 offset:0
    s_waitcnt lgkmcnt(0)
    v_readfirstlane_b32 s37, v9
    s_cmp_ge_u32 s37, s42
    s_cbranch_scc0 at_i_spin
at_i_ok:
    s_add_u32 s42, s42, 4
    ds_read_b128 v[160:163], v3 offset:2048
    ds_read_b128 v[164:167], v3 offset:3072
    ds_read_b128 v[168:171], v3 offset:0
    ds_read_b128 v[172:175], v3 offset:1024
    v_mfma_f32_32x32x16_bf16 v[64:79], v[152:155], v[16:19], v[32:47]
    v_mfma_f32_32x32x16_bf16 v[64:79], v[156:159], v[20:23], v[64:79]
    s_nop 9
    s_mov_b32 s26, 0
at_loop:
    v_mfma_f32_32x32x16_bf16 v[80:95], v[152:155], v[24:27], v[48:63]
    v_exp_f32 v64, v64
    v_exp_f32 v65, v65
    v_exp_f32 v66, v66
    v_exp_f32 v67, v67
    v_mfma_f32_32x32x16_bf16 v[80:95], v[156:159], v[28:31], v[80:95]
    v_cvt_pk_bf16_f32 v96, v64, v65
    v_exp_f32 v68, v68
    v_exp_f32 v69, v69
    v_cvt_pk_bf16_f32 v97, v66, v67
    v_mfma_f32_32x32x16_bf16 v[128:143], v[176:179], v[104:107], v[128:143]
    v_exp_f32 v70, v70
    v_exp_f32 v71, v71
    v_cvt_pk_bf16_f32 v98, v68, v69
    v_exp_f32 v72, v72
    v_exp_f32 v73, v73
    ds_read_b32 v9, v8 offset:4
    ds_read_b128 v[152:155], v3 offset:6144
    ds_read_b128 v[156:159], v3 offset:7168
    v_mfma_f32_16x16x32_bf16 v[148:151], v[184:187], v[104:107], v[148:151]
    v_cvt_pk_bf16_f32 v99, v70, v71
    v_exp_f32 v74, v74
    v_mfma_f32_32x32x16_bf16 v[128:143], v[180:183], v[108:111], v[128:143]
    v_exp_f32 v75, v75
    v_cvt_pk_bf16_f32 v100, v72, v73
    v_exp_f32 v76, v76
    v_exp_f32 v77, v77
    v_cvt_pk_bf16_f32 v101, v74, v75
    v_mfma_f32_16x16x32_bf16 v[148:151], v[184:187], v[108:111], v[148:151]
    v_exp_f32 v78, v78
    v_exp_f32 v79, v79
    v_cvt_pk_bf16_f32 v102, v76, v77
    v_cvt_pk_bf16_f32 v103, v78, v79
    s_waitcnt lgkmcnt(2)
    v_mfma_f32_32x32x16_bf16 v[64:79], v[160:163], v[16:19], v[32:47]
    v_exp_f32 v80, v80
    v_exp_f32 v81, v81
    v_exp_f32 v82, v82
    v_exp_f32 v83, v83
    ds_read_b128 v[176:179], v3 offset:4096
    ds_read_b128 v[180:183], v3 offset:5120
    v_mfma_f32_32x32x16_bf16 v[64:79], v[164:167], v[20:23], v[64:79]
    v_cvt_pk_bf16_f32 v104, v80, v81
    v_exp_f32 v84, v84
    v_exp_f32 v85, v85
    v_cvt_pk_bf16_f32 v105, v82, v83
    v_readfirstlane_b32 s37, v9
    s_cmp_ge_u32 s37, s43
    s_cbranch_scc1 at_f_ok
at_f_spin:
    ds_read_b32 v9, v8 offset:4
    s_waitcnt lgkmcnt(0)
    v_readfirstlane_b32 s37, v9
    s_cmp_ge_u32 s37, s43
    s_cbranch_scc0 at_f_spin
at_f_ok:
    s_add_u32 s43, s43, 4
    s_add_u32 m0, s25, 0
    s_add_u32 s39, s24, 0
    buffer_load_dwordx4 v2, s[12:15], s39 offen offset:0 lds
    buffer_load_dwordx4 v2, s[12:15], s39 offen offset:1024 lds
    v_mfma_f32_32x32x16_bf16 v[112:127], v[168:171], v[96:99], v[112:127]
    v_exp_f32 v86, v86
    v_exp_f32 v87, v87
    v_cvt_pk_bf16_f32 v106, v84, v85
    v_exp_f32 v88, v88
    v_exp_f32 v89, v89
    buffer_load_dwordx4 v2, s[12:15], s39 offen offset:2048 lds
    buffer_load_dwordx4 v2, s[12:15], s39 offen offset:3072 lds
    v_mfma_f32_16x16x32_bf16 v[144:147], v[184:187], v[96:99], v[144:147]
    v_cvt_pk_bf16_f32 v107, v86, v87
    v_exp_f32 v90, v90
    v_mfma_f32_32x32x16_bf16 v[112:127], v[172:175], v[100:103], v[112:127]
    v_exp_f32 v91, v91
    v_cvt_pk_bf16_f32 v108, v88, v89
    v_exp_f32 v92, v92
    v_exp_f32 v93, v93
    v_cvt_pk_bf16_f32 v109, v90, v91
    v_mfma_f32_16x16x32_bf16 v[144:147], v[184:187], v[100:103], v[144:147]
    v_exp_f32 v94, v94
    v_exp_f32 v95, v95
    v_cvt_pk_bf16_f32 v110, v92, v93
    v_cvt_pk_bf16_f32 v111, v94, v95
    v_mfma_f32_32x32x16_bf16 v[80:95], v[160:163], v[24:27], v[48:63]
    v_exp_f32 v64, v64
    v_exp_f32 v65, v65
    v_exp_f32 v66, v66
    v_exp_f32 v67, v67
    s_add_u32 m0, s25, 4096
    s_add_u32 s39, s24, 4096
    buffer_load_dwordx4 v2, s[12:15], s39 offen offset:0 lds
    buffer_load_dwordx4 v2, s[12:15], s39 offen offset:1024 lds
    v_mfma_f32_32x32x16_bf16 v[80:95], v[164:167], v[28:31], v[80:95]
    v_cvt_pk_bf16_f32 v96, v64, v65
    v_exp_f32 v68, v68
    v_exp_f32 v69, v69
    v_cvt_pk_bf16_f32 v97, v66, v67
    v_mfma_f32_32x32x16_bf16 v[128:143], v[168:171], v[104:107], v[128:143]
    v_exp_f32 v70, v70
    v_exp_f32 v71, v71
    v_cvt_pk_bf16_f32 v98, v68, v69
    v_exp_f32 v72, v72
    v_exp_f32 v73, v73
    ds_read_b128 v[160:163], v3 offset:10240
    ds_read_b128 v[164:167], v3 offset:11264
    v_mfma_f32_16x16x32_bf16 v[148:151], v[184:187], v[104:107], v[148:151]
    v_cvt_pk_bf16_f32 v99, v70, v71
    v_exp_f32 v74, v74
    buffer_load_dwordx4 v2, s[12:15], s39 offen offset:2048 lds
    buffer_load_dwordx4 v2, s[12:15], s39 offen offset:3072 lds
    s_add_u32 s24, s24, 0x8000
    s_xor_b32 s25, s25, 0x8000
    v_mfma_f32_32x32x16_bf16 v[128:143], v[172:175], v[108:111], v[128:143]
    v_exp_f32 v75, v75
    v_cvt_pk_bf16_f32 v100, v72, v73
    v_exp_f32 v76, v76
    v_exp_f32 v77, v77
    v_cvt_pk_bf16_f32 v101, v74, v75
    v_mfma_f32_16x16x32_bf16 v[148:151], v[184:187], v[108:111], v[148:151]
    v_exp_f32 v78, v78
    v_exp_f32 v79, v79
    v_cvt_pk_bf16_f32 v102, v76, v77
    v_cvt_pk_bf16_f32 v103, v78, v79
    s_waitcnt lgkmcnt(2)
    v_mfma_f32_32x32x16_bf16 v[64:79], v[152:155], v[16:19], v[32:47]
    v_exp_f32 v80, v80
    v_exp_f32 v81, v81
    v_exp_f32 v82, v82
    v_exp_f32 v83, v83
    ds_read_b128 v[168:171], v3 offset:8192
    ds_read_b128 v[172:175], v3 offset:9216
    v_mfma_f32_32x32x16_bf16 v[64:79], v[156:159], v[20:23], v[64:79]
    v_cvt_pk_bf16_f32 v104, v80, v81
    v_exp_f32 v84, v84
    v_exp_f32 v85, v85
    v_cvt_pk_bf16_f32 v105, v82, v83
    v_mfma_f32_32x32x16_bf16 v[112:127], v[176:179], v[96:99], v[112:127]
    v_exp_f32 v86, v86
    v_exp_f32 v87, v87
    v_cvt_pk_bf16_f32 v106, v84, v85
    v_exp_f32 v88, v88
    v_exp_f32 v89, v89
    v_mfma_f32_16x16x32_bf16 v[144:147], v[184:187], v[96:99], v[144:147]
    v_cvt_pk_bf16_f32 v107, v86, v87
    v_exp_f32 v90, v90
    v_mfma_f32_32x32x16_bf16 v[112:127], v[180:183], v[100:103], v[112:127]
    v_exp_f32 v91, v91
    v_cvt_pk_bf16_f32 v108, v88, v89
    v_exp_f32 v92, v92
    v_exp_f32 v93, v93
    v_cvt_pk_bf16_f32 v109, v90, v91
    v_mfma_f32_16x16x32_bf16 v[144:147], v[184:187], v[100:103], v[144:147]
    v_exp_f32 v94, v94
    v_exp_f32 v95, v95
    v_cvt_pk_bf16_f32 v110, v92, v93
    v_cvt_pk_bf16_f32 v111, v94, v95
    v_mfma_f32_32x32x16_bf16 v[80:95], v[152:155], v[24:27], v[48:63]
    v_exp_f32 v64, v64
    v_exp_f32 v65, v65
    v_exp_f32 v66, v66
    v_exp_f32 v67, v67
    v_mfma_f32_32x32x16_bf16 v[80:95], v[156:159], v[28:31], v[80:95]
    v_cvt_pk_bf16_f32 v96, v64, v65
    v_exp_f32 v68, v68
    v_exp_f32 v69, v69
    v_cvt_pk_bf16_f32 v97, v66, v67
    v_mfma_f32_32x32x16_bf16 v[128:143], v[176:179], v[104:107], v[128:143]
    v_exp_f32 v70, v70
    v_exp_f32 v71, v71
    v_cvt_pk_bf16_f32 v98, v68, v69
    v_exp_f32 v72, v72
    v_exp_f32 v73, v73
    ds_read_b128 v[152:155], v3 offset:14336
    ds_read_b128 v[156:159], v3 offset:15360
    v_mfma_f32_16x16x32_bf16 v[148:151], v[184:187], v[104:107], v[148:151]
    v_cvt_pk_bf16_f32 v99, v70, v71
    v_exp_f32 v74, v74
    v_mfma_f32_32x32x16_bf16 v[128:143], v[180:183], v[108:111], v[128:143]
    v_exp_f32 v75, v75
    v_cvt_pk_bf16_f32 v100, v72, v73
    v_exp_f32 v76, v76
    v_exp_f32 v77, v77
    v_cvt_pk_bf16_f32 v101, v74, v75
    v_mfma_f32_16x16x32_bf16 v[148:151], v[184:187], v[108:111], v[148:151]
    v_exp_f32 v78, v78
    v_exp_f32 v79, v79
    v_cvt_pk_bf16_f32 v102, v76, v77
    v_cvt_pk_bf16_f32 v103, v78, v79
    s_waitcnt lgkmcnt(2)
    v_mfma_f32_32x32x16_bf16 v[64:79], v[160:163], v[16:19], v[32:47]
    v_exp_f32 v80, v80
    v_exp_f32 v81, v81
    v_exp_f32 v82, v82
    v_exp_f32 v83, v83
    ds_read_b128 v[176:179], v3 offset:12288
    ds_read_b128 v[180:183], v3 offset:13312
    v_mfma_f32_32x32x16_bf16 v[64:79], v[164:167], v[20:23], v[64:79]
    v_cvt_pk_bf16_f32 v104, v80, v81
    v_exp_f32 v84, v84
    v_exp_f32 v85, v85
    v_cvt_pk_bf16_f32 v105, v82, v83
    v_mfma_f32_32x32x16_bf16 v[112:127], v[168:171], v[96:99], v[112:127]
    v_exp_f32 v86, v86
    v_exp_f32 v87, v87
    v_cvt_pk_bf16_f32 v106, v84, v85
    v_exp_f32 v88, v88
    v_exp_f32 v89, v89
    v_mfma_f32_16x16x32_bf16 v[144:147], v[184:187], v[96:99], v[144:147]
    v_cvt_pk_bf16_f32 v107, v86, v87
    v_exp_f32 v90, v90
    v_mfma_f32_32x32x16_bf16 v[112:127], v[172:175], v[100:103], v[112:127]
    v_exp_f32 v91, v91
    v_cvt_pk_bf16_f32 v108, v88, v89
    v_exp_f32 v92, v92
    v_exp_f32 v93, v93
    v_cvt_pk_bf16_f32 v109, v90, v91
    v_mfma_f32_16x16x32_bf16 v[144:147], v[184:187], v[100:103], v[144:147]
    v_exp_f32 v94, v94
    v_exp_f32 v95, v95
    v_cvt_pk_bf16_f32 v110, v92, v93
    v_cvt_pk_bf16_f32 v111, v94, v95
    v_mfma_f32_32x32x16_bf16 v[80:95], v[160:163], v[24:27], v[48:63]
    v_exp_f32 v64, v64
    v_exp_f32 v65, v65
    v_exp_f32 v66, v66
    v_exp_f32 v67, v67
    v_mfma_f32_32x32x16_bf16 v[80:95], v[164:167], v[28:31], v[80:95]
    v_cvt_pk_bf16_f32 v96, v64, v65
    v_exp_f32 v68, v68
    v_exp_f32 v69, v69
    v_cvt_pk_bf16_f32 v97, v66, v67
    v_mfma_f32_32x32x16_bf16 v[128:143], v[168:171], v[104:107], v[128:143]
    v_exp_f32 v70, v70
    v_exp_f32 v71, v71
    v_cvt_pk_bf16_f32 v98, v68, v69
    v_exp_f32 v72, v72
    v_exp_f32 v73, v73
    ds_read_b128 v[160:163], v3 offset:18432
    ds_read_b128 v[164:167], v3 offset:19456
    v_mfma_f32_16x16x32_bf16 v[148:151], v[184:187], v[104:107], v[148:151]
    v_cvt_pk_bf16_f32 v99, v70, v71
    v_exp_f32 v74, v74
    v_mfma_f32_32x32x16_bf16 v[128:143], v[172:175], v[108:111], v[128:143]
    v_exp_f32 v75, v75
    v_cvt_pk_bf16_f32 v100, v72, v73
    v_exp_f32 v76, v76
    v_exp_f32 v77, v77
    v_cvt_pk_bf16_f32 v101, v74, v75
    v_mfma_f32_16x16x32_bf16 v[148:151], v[184:187], v[108:111], v[148:151]
    v_exp_f32 v78, v78
    v_exp_f32 v79, v79
    v_cvt_pk_bf16_f32 v102, v76, v77
    v_cvt_pk_bf16_f32 v103, v78, v79
    s_waitcnt lgkmcnt(2)
    v_mfma_f32_32x32x16_bf16 v[64:79], v[152:155], v[16:19], v[32:47]
    v_exp_f32 v80, v80
    v_exp_f32 v81, v81
    v_exp_f32 v82, v82
    v_exp_f32 v83, v83
    ds_read_b128 v[168:171], v3 offset:16384
    ds_read_b128 v[172:175], v3 offset:17408
    v_mfma_f32_32x32x16_bf16 v[64:79], v[156:159], v[20:23], v[64:79]
    v_cvt_pk_bf16_f32 v104, v80, v81
    v_exp_f32 v84, v84
    v_exp_f32 v85, v85
    v_cvt_pk_bf16_f32 v105, v82, v83
    v_mfma_f32_32x32x16_bf16 v[112:127], v[176:179], v[96:99], v[112:127]
    v_exp_f32 v86, v86
    v_exp_f32 v87, v87
    v_cvt_pk_bf16_f32 v106, v84, v85
    v_exp_f32 v88, v88
    v_exp_f32 v89, v89
    v_mfma_f32_16x16x32_bf16 v[144:147], v[184:187], v[96:99], v[144:147]
    v_cvt_pk_bf16_f32 v107, v86, v87
    v_exp_f32 v90, v90
    v_mfma_f32_32x32x16_bf16 v[112:127], v[180:183], v[100:103], v[112:127]
    v_exp_f32 v91, v91
    v_cvt_pk_bf16_f32 v108, v88, v89
    v_exp_f32 v92, v92
    v_exp_f32 v93, v93
    v_cvt_pk_bf16_f32 v109, v90, v91
    v_mfma_f32_16x16x32_bf16 v[144:147], v[184:187], v[100:103], v[144:147]
    v_exp_f32 v94, v94
    v_exp_f32 v95, v95
    v_cvt_pk_bf16_f32 v110, v92, v93
    v_cvt_pk_bf16_f32 v111, v94, v95
    v_mfma_f32_32x32x16_bf16 v[80:95], v[152:155], v[24:27], v[48:63]
    v_exp_f32 v64, v64
    v_exp_f32 v65, v65
    v_exp_f32 v66, v66
    v_exp_f32 v67, v67
    v_mfma_f32_32x32x16_bf16 v[80:95], v[156:159], v[28:31], v[80:95]
    v_cvt_pk_bf16_f32 v96, v64, v65
    v_exp_f32 v68, v68
    v_exp_f32 v69, v69
    v_cvt_pk_bf16_f32 v97, v66, v67
    v_mfma_f32_32x32x16_bf16 v[128:143], v[176:179], v[104:107], v[128:143]
    v_exp_f32 v70, v70
    v_exp_f32 v71, v71
    v_cvt_pk_bf16_f32 v98, v68, v69
    v_exp_f32 v72, v72
    v_exp_f32 v73, v73
    ds_read_b128 v[152:155], v3 offset:22528
    ds_read_b128 v[156:159], v3 offset:23552
    v_mfma_f32_16x16x32_bf16 v[148:151], v[184:187], v[104:107], v[148:151]
    v_cvt_pk_bf16_f32 v99, v70, v71
    v_exp_f32 v74, v74
    v_mfma_f32_32x32x16_bf16 v[128:143], v[180:183], v[108:111], v[128:143]
    v_exp_f32 v75, v75
    v_cvt_pk_bf16_f32 v100, v72, v73
    v_exp_f32 v76, v76
    v_exp_f32 v77, v77
    v_cvt_pk_bf16_f32 v101, v74, v75
    v_mfma_f32_16x16x32_bf16 v[148:151], v[184:187], v[108:111], v[148:151]
    v_exp_f32 v78, v78
    v_exp_f32 v79, v79
    v_cvt_pk_bf16_f32 v102, v76, v77
    v_cvt_pk_bf16_f32 v103, v78, v79
    s_waitcnt lgkmcnt(2)
    v_mfma_f32_32x32x16_bf16 v[64:79], v[160:163], v[16:19], v[32:47]
    v_exp_f32 v80, v80
    v_exp_f32 v81, v81
    v_exp_f32 v82, v82
    v_exp_f32 v83, v83
    ds_read_b128 v[176:179], v3 offset:20480
    ds_read_b128 v[180:183], v3 offset:21504
    v_mfma_f32_32x32x16_bf16 v[64:79], v[164:167], v[20:23], v[64:79]
    v_cvt_pk_bf16_f32 v104, v80, v81
    v_exp_f32 v84, v84
    v_exp_f32 v85, v85
    v_cvt_pk_bf16_f32 v105, v82, v83
    v_mfma_f32_32x32x16_bf16 v[112:127], v[168:171], v[96:99], v[112:127]
    v_exp_f32 v86, v86
    v_exp_f32 v87, v87
    v_cvt_pk_bf16_f32 v106, v84, v85
    v_exp_f32 v88, v88
    v_exp_f32 v89, v89
    v_mfma_f32_16x16x32_bf16 v[144:147], v[184:187], v[96:99], v[144:147]
    v_cvt_pk_bf16_f32 v107, v86, v87
    v_exp_f32 v90, v90
    v_mfma_f32_32x32x16_bf16 v[112:127], v[172:175], v[100:103], v[112:127]
    v_exp_f32 v91, v91
    v_cvt_pk_bf16_f32 v108, v88, v89
    v_exp_f32 v92, v92
    v_exp_f32 v93, v93
    v_cvt_pk_bf16_f32 v109, v90, v91
    v_mfma_f32_16x16x32_bf16 v[144:147], v[184:187], v[100:103], v[144:147]
    v_exp_f32 v94, v94
    v_exp_f32 v95, v95
    v_cvt_pk_bf16_f32 v110, v92, v93
    v_cvt_pk_bf16_f32 v111, v94, v95
    v_mfma_f32_32x32x16_bf16 v[80:95], v[160:163], v[24:27], v[48:63]
    v_exp_f32 v64, v64
    v_exp_f32 v65, v65
    v_exp_f32 v66, v66
    v_exp_f32 v67, v67
    s_waitcnt vmcnt(0)
    s_mov_b64 exec, 1
    ds_add_u32 v8, v10 offset:0
    s_mov_b64 exec, -1
    v_mfma_f32_32x32x16_bf16 v[80:95], v[164:167], v[28:31], v[80:95]
    v_cvt_pk_bf16_f32 v96, v64, v65
    v_exp_f32 v68, v68
    v_exp_f32 v69, v69
    v_cvt_pk_bf16_f32 v97, v66, v67
    v_mfma_f32_32x32x16_bf16 v[128:143], v[168:171], v[104:107], v[128:143]
    v_exp_f32 v70, v70
    v_exp_f32 v71, v71
    v_cvt_pk_bf16_f32 v98, v68, v69
    v_exp_f32 v72, v72
    v_exp_f32 v73, v73
    ds_read_b128 v[160:163], v3 offset:26624
    ds_read_b128 v[164:167], v3 offset:27648
    v_mfma_f32_16x16x32_bf16 v[148:151], v[184:187], v[104:107], v[148:151]
    v_cvt_pk_bf16_f32 v99, v70, v71
    v_exp_f32 v74, v74
    v_mfma_f32_32x32x16_bf16 v[128:143], v[172:175], v[108:111], v[128:143]
    v_exp_f32 v75, v75
    v_cvt_pk_bf16_f32 v100, v72, v73
    v_exp_f32 v76, v76
    v_exp_f32 v77, v77
    v_cvt_pk_bf16_f32 v101, v74, v75
    v_mfma_f32_16x16x32_bf16 v[148:151], v[184:187], v[108:111], v[148:151]
    v_exp_f32 v78, v78
    v_exp_f32 v79, v79
    v_cvt_pk_bf16_f32 v102, v76, v77
    v_cvt_pk_bf16_f32 v103, v78, v79
    s_waitcnt lgkmcnt(2)
    v_mfma_f32_32x32x16_bf16 v[64:79], v[152:155], v[16:19], v[32:47]
    v_exp_f32 v80, v80
    v_exp_f32 v81, v81
    v_exp_f32 v82, v82
    v_exp_f32 v83, v83
    ds_read_b128 v[168:171], v3 offset:24576
    ds_read_b128 v[172:175], v3 offset:25600
    v_mfma_f32_32x32x16_bf16 v[64:79], v[156:159], v[20:23], v[64:79]
    v_cvt_pk_bf16_f32 v104, v80, v81
    v_exp_f32 v84, v84
    v_exp_f32 v85, v85
    v_cvt_pk_bf16_f32 v105, v82, v83
    v_mfma_f32_32x32x16_bf16 v[112:127], v[176:179], v[96:99], v[112:127]
    v_exp_f32 v86, v86
    v_exp_f32 v87, v87
    v_cvt_pk_bf16_f32 v106, v84, v85
    v_exp_f32 v88, v88
    v_exp_f32 v89, v89
    v_mfma_f32_16x16x32_bf16 v[144:147], v[184:187], v[96:99], v[144:147]
    v_cvt_pk_bf16_f32 v107, v86, v87
    v_exp_f32 v90, v90
    v_mfma_f32_32x32x16_bf16 v[112:127], v[180:183], v[100:103], v[112:127]
    v_exp_f32 v91, v91
    v_cvt_pk_bf16_f32 v108, v88, v89
    v_exp_f32 v92, v92
    v_exp_f32 v93, v93
    v_cvt_pk_bf16_f32 v109, v90, v91
    v_mfma_f32_16x16x32_bf16 v[144:147], v[184:187], v[100:103], v[144:147]
    v_exp_f32 v94, v94
    v_exp_f32 v95, v95
    v_cvt_pk_bf16_f32 v110, v92, v93
    v_cvt_pk_bf16_f32 v111, v94, v95
    v_mfma_f32_32x32x16_bf16 v[80:95], v[152:155], v[24:27], v[48:63]
    v_exp_f32 v64, v64
    v_exp_f32 v65, v65
    v_exp_f32 v66, v66
    v_exp_f32 v67, v67
    v_mfma_f32_32x32x16_bf16 v[80:95], v[156:159], v[28:31], v[80:95]
    v_cvt_pk_bf16_f32 v96, v64, v65
    v_exp_f32 v68, v68
    v_exp_f32 v69, v69
    v_cvt_pk_bf16_f32 v97, v66, v67
    v_mfma_f32_32x32x16_bf16 v[128:143], v[176:179], v[104:107], v[128:143]
    v_exp_f32 v70, v70
    v_exp_f32 v71, v71
    v_cvt_pk_bf16_f32 v98, v68, v69
    v_exp_f32 v72, v72
    v_exp_f32 v73, v73
    ds_read_b128 v[152:155], v3 offset:30720
    ds_read_b128 v[156:159], v3 offset:31744
    v_mfma_f32_16x16x32_bf16 v[148:151], v[184:187], v[104:107], v[148:151]
    v_cvt_pk_bf16_f32 v99, v70, v71
    v_exp_f32 v74, v74
    v_mfma_f32_32x32x16_bf16 v[128:143], v[180:183], v[108:111], v[128:143]
    v_exp_f32 v75, v75
    v_cvt_pk_bf16_f32 v100, v72, v73
    v_exp_f32 v76, v76
    v_exp_f32 v77, v77
    v_cvt_pk_bf16_f32 v101, v74, v75
    v_mfma_f32_16x16x32_bf16 v[148:151], v[184:187], v[108:111], v[148:151]
    v_exp_f32 v78, v78
    v_exp_f32 v79, v79
    v_cvt_pk_bf16_f32 v102, v76, v77
    v_cvt_pk_bf16_f32 v103, v78, v79
    s_waitcnt lgkmcnt(2)
    v_mfma_f32_32x32x16_bf16 v[64:79], v[160:163], v[16:19], v[32:47]
    v_exp_f32 v80, v80
    v_exp_f32 v81, v81
    v_exp_f32 v82, v82
    v_exp_f32 v83, v83
    ds_read_b32 v9, v8 offset:0
    ds_read_b128 v[176:179], v3 offset:28672
    ds_read_b128 v[180:183], v3 offset:29696
    v_mfma_f32_32x32x16_bf16 v[64:79], v[164:167], v[20:23], v[64:79]
    v_cvt_pk_bf16_f32 v104, v80, v81
    v_exp_f32 v84, v84
    v_exp_f32 v85, v85
    v_cvt_pk_bf16_f32 v105, v82, v83
    v_mfma_f32_32x32x16_bf16 v[112:127], v[168:171], v[96:99], v[112:127]
    v_exp_f32 v86, v86
    v_exp_f32 v87, v87
    v_cvt_pk_bf16_f32 v106, v84, v85
    v_exp_f32 v88, v88
    v_exp_f32 v89, v89
    v_mfma_f32_16x16x32_bf16 v[144:147], v[184:187], v[96:99], v[144:147]
    v_cvt_pk_bf16_f32 v107, v86, v87
    v_exp_f32 v90, v90
    v_mfma_f32_32x32x16_bf16 v[112:127], v[172:175], v[100:103], v[112:127]
    v_exp_f32 v91, v91
    v_cvt_pk_bf16_f32 v108, v88, v89
    v_exp_f32 v92, v92
    v_exp_f32 v93, v93
    v_cvt_pk_bf16_f32 v109, v90, v91
    v_mfma_f32_16x16x32_bf16 v[144:147], v[184:187], v[100:103], v[144:147]
    v_exp_f32 v94, v94
    v_exp_f32 v95, v95
    v_cvt_pk_bf16_f32 v110, v92, v93
    v_cvt_pk_bf16_f32 v111, v94, v95
    v_mfma_f32_32x32x16_bf16 v[80:95], v[160:163], v[24:27], v[48:63]
    v_exp_f32 v64, v64
    v_exp_f32 v65, v65
    v_exp_f32 v66, v66
    v_exp_f32 v67, v67
    v_mfma_f32_32x32x16_bf16 v[80:95], v[164:167], v[28:31], v[80:95]
    v_cvt_pk_bf16_f32 v96, v64, v65
    v_exp_f32 v68, v68
    v_exp_f32 v69, v69
    v_cvt_pk_bf16_f32 v97, v66, v67
    s_waitcnt lgkmcnt(0)
    v_readfirstlane_b32 s37, v9
    s_cmp_ge_u32 s37, s42
    s_cbranch_scc1 at_r_ok
at_r_spin:
    ds_read_b32 v9, v8 offset:0
    s_waitcnt lgkmcnt(0)
    v_readfirstlane_b32 s37, v9
    s_cmp_ge_u32 s37, s42
    s_cbranch_scc0 at_r_spin
at_r_ok:
    s_add_u32 s42, s42, 4
    s_mov_b64 exec, 1
    ds_add_u32 v8, v10 offset:4
    s_mov_b64 exec, -1
    v_xor_b32 v3, 0x8000, v3
    v_mfma_f32_32x32x16_bf16 v[128:143], v[168:171], v[104:107], v[128:143]
    v_exp_f32 v70, v70
    v_exp_f32 v71, v71
    v_cvt_pk_bf16_f32 v98, v68, v69
    v_exp_f32 v72, v72
    v_exp_f32 v73, v73
    ds_read_b128 v[160:163], v3 offset:2048
    ds_read_b128 v[164:167], v3 offset:3072
    v_mfma_f32_16x16x32_bf16 v[148:151], v[184:187], v[104:107], v[148:151]
    v_cvt_pk_bf16_f32 v99, v70, v71
    v_exp_f32 v74, v74
    v_mfma_f32_32x32x16_bf16 v[128:143], v[172:175], v[108:111], v[128:143]
    v_exp_f32 v75, v75
    v_cvt_pk_bf16_f32 v100, v72, v73
    v_exp_f32 v76, v76
    v_exp_f32 v77, v77
    v_cvt_pk_bf16_f32 v101, v74, v75
    v_mfma_f32_16x16x32_bf16 v[148:151], v[184:187], v[108:111], v[148:151]
    v_exp_f32 v78, v78
    v_exp_f32 v79, v79
    v_cvt_pk_bf16_f32 v102, v76, v77
    v_cvt_pk_bf16_f32 v103, v78, v79
    s_waitcnt lgkmcnt(2)
    v_mfma_f32_32x32x16_bf16 v[64:79], v[152:155], v[16:19], v[32:47]
    v_exp_f32 v80, v80
    v_exp_f32 v81, v81
    v_exp_f32 v82, v82
    v_exp_f32 v83, v83
    ds_read_b128 v[168:171], v3 offset:0
    ds_read_b128 v[172:175], v3 offset:1024
    v_mfma_f32_32x32x16_bf16 v[64:79], v[156:159], v[20:23], v[64:79]
    v_cvt_pk_bf16_f32 v104, v80, v81
    v_exp_f32 v84, v84
    v_exp_f32 v85, v85
    v_cvt_pk_bf16_f32 v105, v82, v83
    v_mfma_f32_32x32x16_bf16 v[112:127], v[176:179], v[96:99], v[112:127]
    v_exp_f32 v86, v86
    v_exp_f32 v87, v87
    v_cvt_pk_bf16_f32 v106, v84, v85
    v_exp_f32 v88, v88
    v_exp_f32 v89, v89
    v_mfma_f32_16x16x32_bf16 v[144:147], v[184:187], v[96:99], v[144:147]
    v_cvt_pk_bf16_f32 v107, v86, v87
    v_exp_f32 v90, v90
    v_mfma_f32_32x32x16_bf16 v[112:127], v[180:183], v[100:103], v[112:127]
    v_exp_f32 v91, v91
    v_cvt_pk_bf16_f32 v108, v88, v89
    v_exp_f32 v92, v92
    v_exp_f32 v93, v93
    v_cvt_pk_bf16_f32 v109, v90, v91
    v_mfma_f32_16x16x32_bf16 v[144:147], v[184:187], v[100:103], v[144:147]
    v_exp_f32 v94, v94
    v_exp_f32 v95, v95
    v_cvt_pk_bf16_f32 v110, v92, v93
    v_cvt_pk_bf16_f32 v111, v94, v95
    s_add_u32 s26, s26, 1
    s_cmp_lt_u32 s26, 8
    s_cbranch_scc1 at_loop
    v_mfma_f32_32x32x16_bf16 v[128:143], v[176:179], v[104:107], v[128:143]
    v_mfma_f32_16x16x32_bf16 v[148:151], v[184:187], v[104:107], v[148:151]
    v_mfma_f32_32x32x16_bf16 v[128:143], v[180:183], v[108:111], v[128:143]
    v_mfma_f32_16x16x32_bf16 v[148:151], v[184:187], v[108:111], v[148:151]
    s_waitcnt lgkmcnt(0)
    s_mov_b32 s37, 0x4e800000
    s_nop 11
    v_cmp_nle_f32 vcc, v144, s37
    v_cmp_nle_f32 s[40:41], v148, s37
    s_nop 3
    s_or_b64 vcc, vcc, s[40:41]
    s_cbranch_vccnz at_slow
at_fin:
    s_add_u32 s8, s28, 0x1400000
    s_addc_u32 s9, s29, 0
    s_mov_b32 s10, 0x1200000
    s_mov_b32 s11, 0x20000
    s_mul_i32 s37, s36, 294912
    s_lshl_b32 s38, s30, 11
    s_add_u32 s37, s37, s38
    s_add_u32 s38, s37, 294912
    v_rcp_f32 v4, v144
    s_nop 0
    v_mov_b32 v5, v4
    v_pk_mul_f32 v[112:113], v[112:113], v[4:5]
    v_pk_mul_f32 v[114:115], v[114:115], v[4:5]
    v_pk_mul_f32 v[116:117], v[116:117], v[4:5]
    v_pk_mul_f32 v[118:119], v[118:119], v[4:5]
    v_pk_mul_f32 v[120:121], v[120:121], v[4:5]
    v_pk_mul_f32 v[122:123], v[122:123], v[4:5]
    v_pk_mul_f32 v[124:125], v[124:125], v[4:5]
    v_pk_mul_f32 v[126:127], v[126:127], v[4:5]
    v_cvt_pk_bf16_f32 v96, v112, v113
    v_cvt_pk_bf16_f32 v97, v114, v115
    v_cvt_pk_bf16_f32 v98, v116, v117
    v_cvt_pk_bf16_f32 v99, v118, v119
    v_cvt_pk_bf16_f32 v100, v120, v121
    v_cvt_pk_bf16_f32 v101, v122, v123
    v_cvt_pk_bf16_f32 v102, v124, v125
    v_cvt_pk_bf16_f32 v103, v126, v127
    buffer_store_dwordx4 v[96:99], v2, s[8:11], s37 offen offset:0 sc1
    buffer_store_dwordx4 v[100:103], v2, s[8:11], s37 offen offset:1024 sc1
    v_rcp_f32 v4, v148
    s_nop 0
    v_mov_b32 v5, v4
    v_pk_mul_f32 v[128:129], v[128:129], v[4:5]
    v_pk_mul_f32 v[130:131], v[130:131], v[4:5]
    v_pk_mul_f32 v[132:133], v[132:133], v[4:5]
    v_pk_mul_f32 v[134:135], v[134:135], v[4:5]
    v_pk_mul_f32 v[136:137], v[136:137], v[4:5]
    v_pk_mul_f32 v[138:139], v[138:139], v[4:5]
    v_pk_mul_f32 v[140:141], v[140:141], v[4:5]
    v_pk_mul_f32 v[142:143], v[142:143], v[4:5]
    v_cvt_pk_bf16_f32 v104, v128, v129
    v_cvt_pk_bf16_f32 v105, v130, v131
    v_cvt_pk_bf16_f32 v106, v132, v133
    v_cvt_pk_bf16_f32 v107, v134, v135
    v_cvt_pk_bf16_f32 v108, v136, v137
    v_cvt_pk_bf16_f32 v109, v138, v139
    v_cvt_pk_bf16_f32 v110, v140, v141
    v_cvt_pk_bf16_f32 v111, v142, v143
    buffer_store_dwordx4 v[104:107], v2, s[8:11], s38 offen offset:0 sc1
    buffer_store_dwordx4 v[108:111], v2, s[8:11], s38 offen offset:1024 sc1
    s_add_u32 s8, s28, 0x2900000
    s_addc_u32 s9, s29, 0
    s_mov_b32 s10, 0x440000
    s_mov_b32 s11, 0x20000
    s_lshr_b32 s37, s36, 2
    s_lshl_b32 s37, s37, 2
    s_and_b32 s38, s30, 3
    s_add_u32 s37, s37, s38
    s_mul_i32 s37, s37, 4352
    s_lshr_b32 s38, s30, 2
    s_lshl_b32 s38, s38, 1
    s_and_b32 s39, s33, 1
    s_add_u32 s38, s38, s39
    s_lshl_b32 s38, s38, 2
    s_add_u32 s37, s37, s38
    v_mul_u32_u24 v4, 278528, v1
    v_add_u32 v4, s37, v4
    v_mov_b32 v5, 1
    s_mov_b64 exec, 65535
    s_waitcnt vmcnt(0)
    buffer_store_dword v5, v4, s[8:11], 0 offen sc1
    s_endpgm
at_slow:
    s_waitcnt vmcnt(0)
    s_mov_b32 s39, 0
    v_mov_b32 v4, 0xff800000
    v_mov_b32 v5, 0xff800000
at_slow_max:
    buffer_load_dwordx4 v[152:155], v2, s[12:15], s39 offen offset:0
    buffer_load_dwordx4 v[156:159], v2, s[12:15], s39 offen offset:1024
    s_waitcnt vmcnt(0)
    v_mfma_f32_32x32x16_bf16 v[64:79], v[152:155], v[16:19], 0
    v_mfma_f32_32x32x16_bf16 v[64:79], v[156:159], v[20:23], v[64:79]
    v_mfma_f32_32x32x16_bf16 v[80:95], v[152:155], v[24:27], 0
    v_mfma_f32_32x32x16_bf16 v[80:95], v[156:159], v[28:31], v[80:95]
    s_nop 11
    v_max3_f32 v4, v4, v64, v65
    v_max3_f32 v4, v4, v66, v67
    v_max3_f32 v4, v4, v68, v69
    v_max3_f32 v4, v4, v70, v71
    v_max3_f32 v4, v4, v72, v73
    v_max3_f32 v4, v4, v74, v75
    v_max3_f32 v4, v4, v76, v77
    v_max3_f32 v4, v4, v78, v79
    v_max3_f32 v5, v5, v80, v81
    v_max3_f32 v5, v5, v82, v83
    v_max3_f32 v5, v5, v84, v85
    v_max3_f32 v5, v5, v86, v87
    v_max3_f32 v5, v5, v88, v89
    v_max3_f32 v5, v5, v90, v91
    v_max3_f32 v5, v5, v92, v93
    v_max3_f32 v5, v5, v94, v95
    s_add_u32 s39, s39, 4096
    s_cmp_lt_u32 s39, 0x40000
    s_cbranch_scc1 at_slow_max
    v_mov_b32 v6, v4
    s_nop 1
    v_permlane32_swap_b32 v6, v4
    s_nop 1
    v_max_f32 v4, v4, v6
    v_sub_f32 v4, 0, v4
    v_mov_b32 v32, v4
    v_mov_b32 v33, v4
    v_mov_b32 v34, v4
    v_mov_b32 v35, v4
    v_mov_b32 v36, v4
    v_mov_b32 v37, v4
    v_mov_b32 v38, v4
    v_mov_b32 v39, v4
    v_mov_b32 v40, v4
    v_mov_b32 v41, v4
    v_mov_b32 v42, v4
    v_mov_b32 v43, v4
    v_mov_b32 v44, v4
    v_mov_b32 v45, v4
    v_mov_b32 v46, v4
    v_mov_b32 v47, v4
    v_mov_b32 v6, v5
    s_nop 1
    v_permlane32_swap_b32 v6, v5
    s_nop 1
    v_max_f32 v5, v5, v6
    v_sub_f32 v5, 0, v5
    v_mov_b32 v48, v5
    v_mov_b32 v49, v5
    v_mov_b32 v50, v5
    v_mov_b32 v51, v5
    v_mov_b32 v52, v5
    v_mov_b32 v53, v5
    v_mov_b32 v54, v5
    v_mov_b32 v55, v5
    v_mov_b32 v56, v5
    v_mov_b32 v57, v5
    v_mov_b32 v58, v5
    v_mov_b32 v59, v5
    v_mov_b32 v60, v5
    v_mov_b32 v61, v5
    v_mov_b32 v62, v5
    v_mov_b32 v63, v5
    v_mov_b32 v112, 0
    v_mov_b32 v113, 0
    v_mov_b32 v114, 0
    v_mov_b32 v115, 0
    v_mov_b32 v116, 0
    v_mov_b32 v117, 0
    v_mov_b32 v118, 0
    v_mov_b32 v119, 0
    v_mov_b32 v120, 0
    v_mov_b32 v121, 0
    v_mov_b32 v122, 0
    v_mov_b32 v123, 0
    v_mov_b32 v124, 0
    v_mov_b32 v125, 0
    v_mov_b32 v126, 0
    v_mov_b32 v127, 0
    v_mov_b32 v144, 0
    v_mov_b32 v145, 0
    v_mov_b32 v146, 0
    v_mov_b32 v147, 0
    v_mov_b32 v128, 0
    v_mov_b32 v129, 0
    v_mov_b32 v130, 0
    v_mov_b32 v131, 0
    v_mov_b32 v132, 0
    v_mov_b32 v133, 0
    v_mov_b32 v134, 0
    v_mov_b32 v135, 0
    v_mov_b32 v136, 0
    v_mov_b32 v137, 0
    v_mov_b32 v138, 0
    v_mov_b32 v139, 0
    v_mov_b32 v140, 0
    v_mov_b32 v141, 0
    v_mov_b32 v142, 0
    v_mov_b32 v143, 0
    v_mov_b32 v148, 0
    v_mov_b32 v149, 0
    v_mov_b32 v150, 0
    v_mov_b32 v151, 0
    s_mov_b32 s39, 0
at_slow_pv:
    buffer_load_dwordx4 v[152:155], v2, s[12:15], s39 offen offset:0
    buffer_load_dwordx4 v[168:171], v2, s[12:15], s39 offen offset:2048
    buffer_load_dwordx4 v[156:159], v2, s[12:15], s39 offen offset:1024
    buffer_load_dwordx4 v[172:175], v2, s[12:15], s39 offen offset:3072
    s_waitcnt vmcnt(0)
    v_mfma_f32_32x32x16_bf16 v[64:79], v[152:155], v[16:19], v[32:47]
    v_mfma_f32_32x32x16_bf16 v[64:79], v[156:159], v[20:23], v[64:79]
    v_mfma_f32_32x32x16_bf16 v[80:95], v[152:155], v[24:27], v[48:63]
    v_mfma_f32_32x32x16_bf16 v[80:95], v[156:159], v[28:31], v[80:95]
    s_nop 11
    v_exp_f32 v64, v64
    v_exp_f32 v65, v65
    v_exp_f32 v66, v66
    v_exp_f32 v67, v67
    v_cvt_pk_bf16_f32 v96, v64, v65
    v_exp_f32 v68, v68
    v_exp_f32 v69, v69
    v_cvt_pk_bf16_f32 v97, v66, v67
    v_exp_f32 v70, v70
    v_exp_f32 v71, v71
    v_cvt_pk_bf16_f32 v98, v68, v69
    v_exp_f32 v72, v72
    v_exp_f32 v73, v73
    v_cvt_pk_bf16_f32 v99, v70, v71
    v_exp_f32 v74, v74
    v_exp_f32 v75, v75
    v_cvt_pk_bf16_f32 v100, v72, v73
    v_exp_f32 v76, v76
    v_exp_f32 v77, v77
    v_cvt_pk_bf16_f32 v101, v74, v75
    v_exp_f32 v78, v78
    v_exp_f32 v79, v79
    v_cvt_pk_bf16_f32 v102, v76, v77
    v_cvt_pk_bf16_f32 v103, v78, v79
    v_exp_f32 v80, v80
    v_exp_f32 v81, v81
    v_exp_f32 v82, v82
    v_exp_f32 v83, v83
    v_cvt_pk_bf16_f32 v104, v80, v81
    v_exp_f32 v84, v84
    v_exp_f32 v85, v85
    v_cvt_pk_bf16_f32 v105, v82, v83
    v_exp_f32 v86, v86
    v_exp_f32 v87, v87
    v_cvt_pk_bf16_f32 v106, v84, v85
    v_exp_f32 v88, v88
    v_exp_f32 v89, v89
    v_cvt_pk_bf16_f32 v107, v86, v87
    v_exp_f32 v90, v90
    v_exp_f32 v91, v91
    v_cvt_pk_bf16_f32 v108, v88, v89
    v_exp_f32 v92, v92
    v_exp_f32 v93, v93
    v_cvt_pk_bf16_f32 v109, v90, v91
    v_exp_f32 v94, v94
    v_exp_f32 v95, v95
    v_cvt_pk_bf16_f32 v110, v92, v93
    v_cvt_pk_bf16_f32 v111, v94, v95
    s_nop 1
    v_mfma_f32_32x32x16_bf16 v[112:127], v[168:171], v[96:99], v[112:127]
    v_mfma_f32_16x16x32_bf16 v[144:147], v[184:187], v[96:99], v[144:147]
    v_mfma_f32_32x32x16_bf16 v[112:127], v[172:175], v[100:103], v[112:127]
    v_mfma_f32_16x16x32_bf16 v[144:147], v[184:187], v[100:103], v[144:147]
    v_mfma_f32_32x32x16_bf16 v[128:143], v[168:171], v[104:107], v[128:143]
    v_mfma_f32_16x16x32_bf16 v[148:151], v[184:187], v[104:107], v[148:151]
    v_mfma_f32_32x32x16_bf16 v[128:143], v[172:175], v[108:111], v[128:143]
    v_mfma_f32_16x16x32_bf16 v[148:151], v[184:187], v[108:111], v[148:151]
    s_add_u32 s39, s39, 4096
    s_cmp_lt_u32 s39, 0x40000
    s_cbranch_scc1 at_slow_pv
    s_nop 11
    s_branch at_fin
.section .rodata,"a"
.p2align 6
.amdhsa_kernel gemm1_kernel
  .amdhsa_next_free_vgpr 448
  .amdhsa_next_free_sgpr 102
  .amdhsa_accum_offset 256
  .amdhsa_group_segment_fixed_size 0
  .amdhsa_kernarg_size 88
  .amdhsa_user_sgpr_count 2
  .amdhsa_user_sgpr_kernarg_segment_ptr 1
  .amdhsa_system_sgpr_workgroup_id_x 1
.end_amdhsa_kernel
.p2align 6
.amdhsa_kernel fused_kernel
  .amdhsa_next_free_vgpr 256
  .amdhsa_next_free_sgpr 102
  .amdhsa_accum_offset 192
  .amdhsa_group_segment_fixed_size 0
  .amdhsa_kernarg_size 88
  .amdhsa_user_sgpr_count 2
  .amdhsa_user_sgpr_kernarg_segment_ptr 1
  .amdhsa_system_sgpr_workgroup_id_x 1
.end_amdhsa_kernel
```
